```python
import torch

def _softmax(x, axis=-1):
    return torch.softmax(x, dim=axis)
def _gelu(x):
    return torch.nn.functional.gelu(x, approximate="tanh")
def _silu(x):
    return torch.nn.functional.silu(x)
def _sigmoid(x):
    return torch.sigmoid(x)
def _layernorm(x, axis=-1, eps=1e-5):
    m = x.mean(dim=axis, keepdim=True)
    v = x.var(dim=axis, keepdim=True, unbiased=False)
    return (x - m) / torch.sqrt(v + eps)
def _scatter_add(tgt, idx, src, axis=0):
    return tgt.clone().index_add_(axis, idx, src)
def _segment_sum(src, seg, n):
    out = torch.zeros((n,) + src.shape[1:], dtype=src.dtype)
    return out.index_add_(0, seg, src)
def _pad(x, pw):
    flat = tuple(v for pair in reversed(pw) for v in pair)
    return torch.nn.functional.pad(x, flat)

kernel_name = 'interleave_layers__sliding_local_dilated__dense_activation_mish__prompt'

def setup_inputs():

    _w = (lambda a: (lambda t: t.to(torch.bfloat16) if t.is_floating_point() else t)(torch.as_tensor(a)))
    def _A_setup():
        B, S, D = 1, 2048, 512
        return {
            "x": _w((lambda *s: torch.randn(*s, dtype=torch.bfloat16) * 0.05)(B, S, D)),
            "wqkv": _w((lambda *s: torch.randn(*s, dtype=torch.bfloat16) * 0.05)(D, 3 * D)),
            "wo": _w((lambda *s: torch.randn(*s, dtype=torch.bfloat16) * 0.05)(D, D)),
        }
    _A_in = _A_setup()

    def _B_setup():
        B, S, D, F = 1, 2048, 512, 1376
        return {
            "x": _w((lambda *s: torch.randn(*s, dtype=torch.bfloat16) * 0.05)(B, S, D)),
            "w1": _w((lambda *s: torch.randn(*s, dtype=torch.bfloat16) * 0.8)(D, F) * (D ** -0.5)),
            "b1": _w((lambda *s: torch.randn(*s, dtype=torch.bfloat16) * 0.8)(F)),
            "w2": _w((lambda *s: torch.randn(*s, dtype=torch.bfloat16) * 0.8)(F, D) * (F ** -0.5)),
        }
    _B_in = _B_setup()

    return {
        "A_x": _A_in["x"],
        "A_wqkv": _A_in["wqkv"],
        "A_wo": _A_in["wo"],
        "B_x": _B_in["x"],
        "B_w1": _B_in["w1"],
        "B_b1": _B_in["b1"],
        "B_w2": _B_in["w2"],
    }

def reference(A_x, A_wqkv, A_wo, B_x, B_w1, B_b1, B_w2):
    def _A_ref(x, wqkv, wo):
        B, S, D = x.shape
        H = 32; Dh = D // H
        W, dil = 8, 2
        qkv = (lambda x, *d: x.permute(*d))((x @ wqkv).reshape(B, S, 3, H, Dh), 2, 0, 3, 1, 4)
        q, k, v = qkv[0], qkv[1], qkv[2]
        scale = Dh ** -0.5
        pos = torch.arange(S)
        off = torch.arange(W) * dil
        idx = pos[:, None] - off[None, :]
        mask = idx >= 0
        idx_c = torch.where(mask, idx, 0).reshape(-1)
        kg = k[:, :, idx_c, :].reshape(B, H, S, W, Dh)
        vg = v[:, :, idx_c, :].reshape(B, H, S, W, Dh)
        logits = torch.einsum("bhsd,bhswd->bhsw", q, kg) * scale
        logits = torch.where(mask[None, None, :, :], logits, -1e9)
        attn = _softmax(logits, axis=-1)
        o = torch.einsum("bhsw,bhswd->bhsd", attn, vg)
        return (lambda x, *d: x.permute(*d))(o, 0, 2, 1, 3).reshape(B, S, D) @ wo

    def _B_ref(x, w1, b1, w2):
        h = torch.einsum("bsd,df->bsf", x, w1) + b1
        sp = torch.log1p(torch.exp(-torch.abs(h))) + torch.where(h > 0, h, torch.zeros_like(h))
        act = h * torch.tanh(sp)
        return torch.einsum("bsf,fd->bsd", act, w2)

    x = A_x
    x = x + _A_ref(_layernorm(x, axis=-1), A_wqkv, A_wo)
    x = x + _B_ref(_layernorm(x, axis=-1), B_w1, B_b1, B_w2)
    x = x + _A_ref(_layernorm(x, axis=-1), A_wqkv, A_wo)
    x = x + _B_ref(_layernorm(x, axis=-1), B_w1, B_b1, B_w2)
    return x
```

```asm
; @launch grid=(256,1,1) block=(512,1,1) lds=163840
.amdgcn_target "amdgcn-amd-amdhsa--gfx950"
.text
.globl interleave_layers__sliding_local_dilated__dense_activation_mish__prompt_kernel
.p2align 8
.type interleave_layers__sliding_local_dilated__dense_activation_mish__prompt_kernel,@function
interleave_layers__sliding_local_dilated__dense_activation_mish__prompt_kernel:
    s_cmpk_ge_u32 s2, 256
    s_cbranch_scc1 L_end
    s_load_dwordx16 s[64:79], s[0:1], 0
    s_getpc_b64 s[54:55]
    v_lshrrev_b32 v1, 3, v0
    v_and_b32 v2, 7, v0
    v_add_lshl_u32 v1, v1, v2, 7
    s_bfm_b64 exec, 8, 0
    global_load_dword v3, v1, s[54:55]
    s_lshr_b32 s53, s2, 3
    s_and_b32 s52, s2, 7
    s_lshl_b32 s52, s52, 5
    s_add_u32 s52, s52, s53
    v_lshl_add_u32 v2, s52, 13, v1
    s_min_u32 s53, s53, 23
    s_lshl_b32 s53, s53, 16
    v_lshl_add_u32 v4, v1, 3, s53
    s_waitcnt lgkmcnt(0)
    global_load_dword v3, v4, s[66:67] offset:384
    global_load_dword v3, v2, s[64:65]
    s_mov_b64 exec, -1
    s_load_dwordx4 s[80:83], s[0:1], 64
    v_lshrrev_b32 v1, 6, v0
    s_and_b32 s52, s2, 7
    s_lshr_b32 s53, s2, 3
    v_readfirstlane_b32 s46, v1
    s_and_b32 s45, s53, 7
    s_lshr_b32 s53, s53, 3
    s_add_u32 s91, s52, s45
    s_lshl_b32 s52, s52, 2
    s_add_u32 s44, s52, s53
    s_and_b32 s51, s46, 1
    v_and_b32 v0, 63, v0
    s_cmp_lt_u32 s46, 4
    s_cbranch_scc1 L_C
    s_cmp_lt_u32 s46, 6
    s_cbranch_scc1 L_LA
L_LB:
    v_bfe_u32 v1, v0, 3, 2
    v_lshrrev_b32 v2, 5, v0
    v_lshl_add_u32 v1, v2, 3, v1
    s_lshl_b32 s52, s51, 2
    v_add_u32 v1, s52, v1
    v_bfe_u32 v4, v0, 4, 1
    v_lshl_add_u32 v2, v4, 1, v2
    v_lshlrev_b32 v2, 1, v2
    v_and_b32 v4, 7, v0
    v_xor_b32 v2, v2, v4
    v_lshlrev_b32 v2, 4, v2
    v_mul_u32_u24 v6, 3072, v1
    s_mul_i32 s52, s45, 128
    v_add3_u32 v6, v6, v2, s52
    v_add_u32 v7, 48128, v6
    s_lshl_b32 s59, s51, 11
    s_mov_b64 s[12:13], s[66:67]
    s_mov_b32 s14, 0x180000
    s_mov_b32 s15, 0x20000
    s_add_u32 s86, s91, 0
    s_and_b32 s86, s86, 7
    s_mul_i32 s86, s86, 0x30000
    s_add_u32 m0, s59, 0x3000
    s_add_u32 s56, s86, 0x0
    buffer_load_dwordx4 v6, s[12:15], s56 offen lds
    buffer_load_dwordx4 v7, s[12:15], s56 offen offset:1024 lds
    s_add_u32 m0, s59, 0x4000
    s_add_u32 s56, s86, 0x400
    buffer_load_dwordx4 v6, s[12:15], s56 offen lds
    buffer_load_dwordx4 v7, s[12:15], s56 offen offset:1024 lds
    s_add_u32 m0, s59, 0x5000
    s_add_u32 s56, s86, 0x800
    buffer_load_dwordx4 v6, s[12:15], s56 offen lds
    buffer_load_dwordx4 v7, s[12:15], s56 offen offset:1024 lds
    s_add_u32 m0, s59, 0x6000
    s_add_u32 s56, s86, 0x18000
    buffer_load_dwordx4 v6, s[12:15], s56 offen lds
    buffer_load_dwordx4 v7, s[12:15], s56 offen offset:1024 lds
    s_add_u32 m0, s59, 0x7000
    s_add_u32 s56, s86, 0x18400
    buffer_load_dwordx4 v6, s[12:15], s56 offen lds
    buffer_load_dwordx4 v7, s[12:15], s56 offen offset:1024 lds
    s_add_u32 m0, s59, 0x8000
    s_add_u32 s56, s86, 0x18800
    buffer_load_dwordx4 v6, s[12:15], s56 offen lds
    buffer_load_dwordx4 v7, s[12:15], s56 offen offset:1024 lds
    s_add_u32 s86, s91, 1
    s_and_b32 s86, s86, 7
    s_mul_i32 s86, s86, 0x30000
    s_add_u32 m0, s59, 0xc000
    s_add_u32 s56, s86, 0x0
    buffer_load_dwordx4 v6, s[12:15], s56 offen lds
    buffer_load_dwordx4 v7, s[12:15], s56 offen offset:1024 lds
    s_add_u32 m0, s59, 0xd000
    s_add_u32 s56, s86, 0x400
    buffer_load_dwordx4 v6, s[12:15], s56 offen lds
    buffer_load_dwordx4 v7, s[12:15], s56 offen offset:1024 lds
    s_add_u32 m0, s59, 0xe000
    s_add_u32 s56, s86, 0x800
    buffer_load_dwordx4 v6, s[12:15], s56 offen lds
    buffer_load_dwordx4 v7, s[12:15], s56 offen offset:1024 lds
    s_add_u32 m0, s59, 0xf000
    s_add_u32 s56, s86, 0x18000
    buffer_load_dwordx4 v6, s[12:15], s56 offen lds
    buffer_load_dwordx4 v7, s[12:15], s56 offen offset:1024 lds
    s_add_u32 m0, s59, 0x10000
    s_add_u32 s56, s86, 0x18400
    buffer_load_dwordx4 v6, s[12:15], s56 offen lds
    buffer_load_dwordx4 v7, s[12:15], s56 offen offset:1024 lds
    s_add_u32 m0, s59, 0x11000
    s_add_u32 s56, s86, 0x18800
    buffer_load_dwordx4 v6, s[12:15], s56 offen lds
    buffer_load_dwordx4 v7, s[12:15], s56 offen offset:1024 lds
    s_add_u32 s86, s91, 2
    s_and_b32 s86, s86, 7
    s_mul_i32 s86, s86, 0x30000
    s_add_u32 m0, s59, 0x15000
    s_add_u32 s56, s86, 0x0
    buffer_load_dwordx4 v6, s[12:15], s56 offen lds
    buffer_load_dwordx4 v7, s[12:15], s56 offen offset:1024 lds
    s_add_u32 m0, s59, 0x16000
    s_add_u32 s56, s86, 0x400
    buffer_load_dwordx4 v6, s[12:15], s56 offen lds
    buffer_load_dwordx4 v7, s[12:15], s56 offen offset:1024 lds
    s_add_u32 m0, s59, 0x17000
    s_add_u32 s56, s86, 0x800
    buffer_load_dwordx4 v6, s[12:15], s56 offen lds
    buffer_load_dwordx4 v7, s[12:15], s56 offen offset:1024 lds
    s_mul_i32 s47, s44, 0x50000
    s_sub_u32 s49, s44, 1
    s_max_i32 s49, s49, 0
    s_mul_i32 s50, s49, 0x50000
    s_mov_b32 s48, 1
    s_mov_b32 s58, 0
    s_cmp_eq_u32 s45, 7
    s_cselect_b32 s62, 0x40000000, 0
    s_waitcnt lgkmcnt(0)
    s_mov_b64 s[4:5], s[64:65]
    s_mov_b32 s6, 0x200000
    s_mov_b32 s7, 0x20000
    s_mov_b64 s[8:9], s[82:83]
    s_mov_b32 s10, 0xa00000
    s_mov_b32 s11, 0x20000
    s_mov_b64 s[16:17], s[68:69]
    s_mov_b32 s18, 0x80000
    s_mov_b32 s19, 0x20000
    s_mov_b64 s[20:21], s[72:73]
    s_mov_b32 s22, 0x158000
    s_mov_b32 s23, 0x20000
    s_mov_b64 s[24:25], s[76:77]
    s_mov_b32 s26, 0x158000
    s_mov_b32 s27, 0x20000
    s_mov_b64 s[28:29], s[78:79]
    s_mov_b32 s30, 0x200000
    s_mov_b32 s31, 0x20000
    s_mov_b64 s[32:33], s[74:75]
    s_mov_b32 s34, 0xac0
    s_mov_b32 s35, 0x20000
    s_mov_b64 s[36:37], s[80:81]
    v_mul_u32_u24 v8, 1024, v1
    s_mul_i32 s52, s45, 128
    v_add3_u32 v8, v8, v2, s52
    v_add_u32 v9, 15360, v8
    v_mul_u32_u24 v10, 2752, v1
    s_mul_i32 s52, s45, 384
    v_add3_u32 v10, v10, v2, s52
    v_add_u32 v11, 43008, v10
    s_sub_u32 s52, s46, 4
    s_lshl_b32 s52, s52, 10
    v_lshlrev_b32 v12, 4, v0
    v_add_u32 v12, s52, v12
    v_add_u32 v13, 0xd000, v12
    v_add_u32 v14, 0x1a000, v12
    s_waitcnt vmcnt(18)
    s_barrier
    s_branch L_LB2
L_LA:
    v_lshrrev_b32 v4, 3, v0
    v_and_b32 v5, 7, v0
    v_xor_b32 v5, v5, v4
    v_lshlrev_b32 v5, 4, v5
    v_lshl_add_u32 v4, v4, 10, v5
    s_lshl_b32 s52, s44, 16
    s_lshl_b32 s53, s51, 15
    s_add_u32 s53, s53, s52
    v_add_u32 v20, s53, v4
    v_add_u32 v21, 7168, v20
    v_add_u32 v22, 14336, v20
    v_add_u32 v23, 21504, v20
    s_sub_u32 s52, s52, 0x4000
    s_max_i32 s52, s52, 0
    s_lshl_b32 s53, s51, 13
    s_add_u32 s52, s52, s53
    v_add_u32 v8, s52, v4
    s_lshl_b32 s59, s51, 12
    s_lshl_b32 s60, s51, 10
    s_mov_b64 s[4:5], s[64:65]
    s_mov_b32 s6, 0x200000
    s_mov_b32 s7, 0x20000
    s_add_u32 m0, s59, 0x800
    s_add_u32 s86, s91, 0
    s_and_b32 s86, s86, 7
    s_lshl_b32 s56, s86, 7
    buffer_load_dwordx4 v20, s[4:7], s56 offen offset:0 lds
    buffer_load_dwordx4 v21, s[4:7], s56 offen offset:1024 lds
    buffer_load_dwordx4 v22, s[4:7], s56 offen offset:2048 lds
    buffer_load_dwordx4 v23, s[4:7], s56 offen offset:3072 lds
    s_add_u32 m0, s60, 0x0
    s_nop 0
    buffer_load_dwordx4 v8, s[4:7], s56 offen lds
    s_add_u32 m0, s59, 0x9800
    s_add_u32 s86, s91, 1
    s_and_b32 s86, s86, 7
    s_lshl_b32 s56, s86, 7
    buffer_load_dwordx4 v20, s[4:7], s56 offen offset:0 lds
    buffer_load_dwordx4 v21, s[4:7], s56 offen offset:1024 lds
    buffer_load_dwordx4 v22, s[4:7], s56 offen offset:2048 lds
    buffer_load_dwordx4 v23, s[4:7], s56 offen offset:3072 lds
    s_add_u32 m0, s60, 0x9000
    s_nop 0
    buffer_load_dwordx4 v8, s[4:7], s56 offen lds
    s_add_u32 m0, s59, 0x12800
    s_add_u32 s86, s91, 2
    s_and_b32 s86, s86, 7
    s_lshl_b32 s56, s86, 7
    buffer_load_dwordx4 v20, s[4:7], s56 offen offset:0 lds
    buffer_load_dwordx4 v21, s[4:7], s56 offen offset:1024 lds
    buffer_load_dwordx4 v22, s[4:7], s56 offen offset:2048 lds
    buffer_load_dwordx4 v23, s[4:7], s56 offen offset:3072 lds
    s_add_u32 m0, s60, 0x12000
    s_nop 0
    buffer_load_dwordx4 v8, s[4:7], s56 offen lds
    s_mul_i32 s47, s44, 0x50000
    s_sub_u32 s49, s44, 1
    s_max_i32 s49, s49, 0
    s_mul_i32 s50, s49, 0x50000
    s_mov_b32 s48, 1
    s_mov_b32 s58, 0
    s_cmp_eq_u32 s45, 7
    s_cselect_b32 s62, 0x40000000, 0
    s_waitcnt lgkmcnt(0)
    s_mov_b64 s[8:9], s[82:83]
    s_mov_b32 s10, 0xa00000
    s_mov_b32 s11, 0x20000
    s_mov_b64 s[12:13], s[66:67]
    s_mov_b32 s14, 0x180000
    s_mov_b32 s15, 0x20000
    s_mov_b64 s[16:17], s[68:69]
    s_mov_b32 s18, 0x80000
    s_mov_b32 s19, 0x20000
    s_mov_b64 s[20:21], s[72:73]
    s_mov_b32 s22, 0x158000
    s_mov_b32 s23, 0x20000
    s_mov_b64 s[24:25], s[76:77]
    s_mov_b32 s26, 0x158000
    s_mov_b32 s27, 0x20000
    s_mov_b64 s[28:29], s[78:79]
    s_mov_b32 s30, 0x200000
    s_mov_b32 s31, 0x20000
    s_mov_b64 s[32:33], s[74:75]
    s_mov_b32 s34, 0xac0
    s_mov_b32 s35, 0x20000
    s_mov_b64 s[36:37], s[80:81]
    v_lshlrev_b32 v9, 4, v0
    v_add_u32 v9, s59, v9
    v_and_b32 v10, 31, v0
    v_lshlrev_b32 v10, 2, v10
    v_add_u32 v10, s47, v10
    v_and_b32 v4, 15, v0
    s_add_u32 s52, s50, 0x400
    v_mul_u32_u24 v11, 4, v4
    v_add_u32 v11, s52, v11
    v_lshlrev_b32 v13, 4, v0
    v_lshlrev_b32 v14, 7, v0
    v_and_b32 v15, 7, v0
    v_lshlrev_b32 v15, 4, v15
    v_lshrrev_b32 v4, 4, v0
    v_lshl_add_u32 v15, v4, 2, v15
    s_lshl_b32 s52, s51, 8
    s_add_u32 s52, s52, 0x27800
    v_add_u32 v16, s52, v15
    s_lshl1_add_u32 s61, s45, s51
    s_lshl_b32 s61, s61, 9
    s_add_u32 s61, s61, s47
    s_add_u32 s61, s61, 0x8000
    s_lshl_b32 s52, s44, 3
    s_lshl_b32 s53, s49, 3
    v_mov_b32 v4, s52
    v_mov_b32 v5, s53
    v_cmp_gt_u32 vcc, 32, v0
    v_mov_b32 v6, 0x01010101
    s_nop 0
    v_cndmask_b32 v24, v5, v4, vcc
    s_sub_u32 s52, s46, 4
    s_lshl_b32 s52, s52, 10
    v_lshlrev_b32 v44, 4, v0
    v_add_u32 v44, s52, v44
    v_add_u32 v45, 0xd000, v44
    v_add_u32 v46, 0x1a000, v44
    s_waitcnt vmcnt(10)
    s_barrier
    s_branch L_LA2
L_C:
    s_setprio 1
    s_getpc_b64 s[54:55]
L_pc:
    s_sub_u32 s54, s54, L_pc-interleave_layers__sliding_local_dilated__dense_activation_mish__prompt_kernel
    s_subb_u32 s55, s55, 0
    s_lshr_b32 s52, s2, 3
    s_lshl_b32 s52, s52, 2
    s_add_u32 s52, s52, s46
    s_lshl_b32 s52, s52, 7
    v_lshlrev_b32 v9, 14, v0
    v_add_u32 v9, s52, v9
    v_min_u32 v9, L_end-interleave_layers__sliding_local_dilated__dense_activation_mish__prompt_kernel, v9
    s_mov_b64 exec, 15
    global_load_dword v50, v9, s[54:55]
    s_mov_b64 exec, -1
    s_lshl_b32 s52, s45, 2
    s_add_u32 s52, s52, s46
    s_lshl_b32 s52, s52, 2
    v_lshlrev_b32 v8, 2, v0
    v_add_u32 v8, s52, v8
    v_mov_b32 v16, s52
    s_lshl_b32 s52, s45, 7
    s_lshl2_add_u32 s52, s51, s52
    s_add_u32 s52, s52, 0x400
    v_writelane_b32 v16, s52, 1
    v_writelane_b32 v8, s52, 4
    s_add_u32 s52, s52, 4
    v_writelane_b32 v8, s52, 5
    v_mov_b32 v11, 0
    s_lshr_b32 s52, s46, 1
    s_lshl_b32 s52, s52, 15
    s_lshl_b32 s53, s51, 6
    s_add_u32 s52, s52, s53
    s_lshl_b32 s53, s44, 16
    s_add_u32 s52, s52, s53
    s_lshl_b32 s53, s45, 7
    s_add_u32 s52, s52, s53
    v_and_b32 v7, 3, v0
    v_lshrrev_b32 v15, 2, v0
    v_lshlrev_b32 v15, 10, v15
    v_lshl_add_u32 v15, v7, 4, v15
    v_add_u32 v15, s52, v15
    s_mul_i32 s47, s44, 0x50000
    s_sub_u32 s49, s44, 1
    s_max_i32 s49, s49, 0
    s_mul_i32 s50, s49, 0x50000
    s_mov_b32 s48, 1
    s_mov_b32 s58, 0
    s_cmp_eq_u32 s45, 7
    s_cselect_b32 s62, 0x40000000, 0
    s_waitcnt lgkmcnt(0)
    s_mov_b64 s[4:5], s[64:65]
    s_mov_b32 s6, 0x200000
    s_mov_b32 s7, 0x20000
    s_mov_b64 s[8:9], s[82:83]
    s_mov_b32 s10, 0xa00000
    s_mov_b32 s11, 0x20000
    s_mov_b64 s[12:13], s[66:67]
    s_mov_b32 s14, 0x180000
    s_mov_b32 s15, 0x20000
    s_mov_b64 s[16:17], s[68:69]
    s_mov_b32 s18, 0x80000
    s_mov_b32 s19, 0x20000
    s_mov_b64 s[20:21], s[72:73]
    s_mov_b32 s22, 0x158000
    s_mov_b32 s23, 0x20000
    s_mov_b64 s[24:25], s[76:77]
    s_mov_b32 s26, 0x158000
    s_mov_b32 s27, 0x20000
    s_mov_b64 s[28:29], s[78:79]
    s_mov_b32 s30, 0x200000
    s_mov_b32 s31, 0x20000
    s_mov_b64 s[32:33], s[74:75]
    s_mov_b32 s34, 0xac0
    s_mov_b32 s35, 0x20000
    s_mov_b64 s[36:37], s[80:81]
    v_lshlrev_b32 v24, 7, v0
    s_lshl_b32 s53, s44, 5
    s_lshl_b32 s55, s45, 2
    s_add_u32 s53, s53, s55
    s_add_u32 s53, s53, s46
    s_lshl_b32 s53, s53, 11
    s_mov_b64 exec, -1
    v_and_b32 v4, 15, v0
    v_lshrrev_b32 v5, 4, v0
    v_bfe_u32 v6, v0, 2, 2
    v_and_b32 v10, 1, v5
    v_lshrrev_b32 v20, 1, v5
    s_lshr_b32 s53, s46, 1
    s_lshl_b32 s54, s53, 12
    s_lshl_b32 s55, s51, 10
    s_add_u32 s55, s55, s54
    v_lshlrev_b32 v9, 11, v10
    v_lshl_add_u32 v23, v20, 8, v9
    v_lshl_add_u32 v23, v4, 4, v23
    v_add_u32 v23, s55, v23
    s_lshl1_add_u32 s52, s45, s51
    s_lshl_b32 s52, s52, 7
    s_add_u32 s52, s52, s54
    v_lshl_add_u32 v9, v20, 6, v9
    v_lshl_add_u32 v9, v4, 2, v9
    v_add_u32 v19, s52, v9
    s_lshr_b32 s53, s46, 1
    s_lshl_b32 s52, s53, 10
    s_lshl_b32 s55, s51, 9
    s_add_u32 s52, s52, s55
    v_lshlrev_b32 v9, 11, v10
    v_lshl_add_u32 v9, v20, 8, v9
    v_lshl_add_u32 v9, v4, 4, v9
    v_add_u32 v14, s52, v9
    v_and_b32 v21, 2, v6
    v_lshlrev_b32 v9, 7, v6
    v_lshl_add_u32 v9, v7, 3, v9
    v_or_b32 v12, v21, v10
    v_xor_b32 v12, s46, v12
    v_lshl_add_u32 v12, v12, 5, v9
    v_lshl_add_u32 v12, v5, 9, v12
    v_or_b32 v13, v21, v20
    v_xor_b32 v13, v13, v10
    s_lshl_b32 s52, s51, 1
    v_xor_b32 v13, s52, v13
    v_lshl_add_u32 v13, v13, 5, v9
    v_lshl_add_u32 v13, v20, 9, v13
    s_lshl_b32 s52, s51, 12
    v_add_u32 v13, s52, v13
    v_lshlrev_b32 v17, 2, v4
    v_add_u32 v17, 0x27800, v17
    v_lshlrev_b32 v18, 4, v5
    v_add_u32 v18, 0x27800, v18
    v_and_b32 v22, 31, v0
    v_lshlrev_b32 v22, 2, v22
    v_add_u32 v22, s47, v22
    .p2align 3
    v_mov_b32 v100, 0x3f803f80
    v_mov_b32 v101, 0x3f803f80
    v_mov_b32 v102, 0x3f803f80
    v_mov_b32 v103, 0x3f803f80
    v_lshlrev_b32 v20, 2, v5
    v_sub_u32 v20, v4, v20
    v_mov_b32 v21, 0xf149f2ca
    v_mov_b32 v116, 0
    v_mov_b32 v117, 0
    v_mov_b32 v118, 0
    v_mov_b32 v119, 0
    v_subrev_u32 v9, 0, v20
    v_and_b32 v9, 0x80000001, v9
    v_mov_b32 v10, 0xffff
    v_cmp_eq_u32 vcc, 0, v9
    s_nop 1
    v_cndmask_b32_e64 v112, v21, 0, vcc
    v_cndmask_b32 v118, v118, v10, vcc
    v_cmp_eq_u32 vcc, 0x80000000, v9
    s_nop 1
    v_cndmask_b32_e64 v104, v21, 0, vcc
    v_cndmask_b32 v116, v116, v10, vcc
    v_subrev_u32 v9, 1, v20
    v_and_b32 v9, 0x80000001, v9
    v_mov_b32 v10, 0xffff0000
    v_cmp_eq_u32 vcc, 0, v9
    s_nop 1
    v_cndmask_b32_e64 v113, v21, 0, vcc
    v_cndmask_b32 v118, v118, v10, vcc
    v_cmp_eq_u32 vcc, 0x80000000, v9
    s_nop 1
    v_cndmask_b32_e64 v105, v21, 0, vcc
    v_cndmask_b32 v116, v116, v10, vcc
    v_subrev_u32 v9, 2, v20
    v_and_b32 v9, 0x80000001, v9
    v_mov_b32 v10, 0xffff
    v_cmp_eq_u32 vcc, 0, v9
    s_nop 1
    v_cndmask_b32_e64 v114, v21, 0, vcc
    v_cndmask_b32 v119, v119, v10, vcc
    v_cmp_eq_u32 vcc, 0x80000000, v9
    s_nop 1
    v_cndmask_b32_e64 v106, v21, 0, vcc
    v_cndmask_b32 v117, v117, v10, vcc
    v_subrev_u32 v9, 3, v20
    v_and_b32 v9, 0x80000001, v9
    v_mov_b32 v10, 0xffff0000
    v_cmp_eq_u32 vcc, 0, v9
    s_nop 1
    v_cndmask_b32_e64 v115, v21, 0, vcc
    v_cndmask_b32 v119, v119, v10, vcc
    v_cmp_eq_u32 vcc, 0x80000000, v9
    s_nop 1
    v_cndmask_b32_e64 v107, v21, 0, vcc
    v_cndmask_b32 v117, v117, v10, vcc
    s_cmp_eq_u32 s44, 0
    s_cselect_b64 vcc, -1, 0
    v_cndmask_b32 v108, v104, v21, vcc
    v_cndmask_b32 v109, v105, v21, vcc
    v_cndmask_b32 v110, v106, v21, vcc
    v_cndmask_b32 v111, v107, v21, vcc
    s_mov_b32 s86, 0xbfb17218
    s_mov_b32 s87, 0xbfb17218
    s_mov_b32 s88, 0x3eb8aa3b
    s_mov_b32 s89, 0x3eb8aa3b
    v_mov_b32 v24, v12
    v_add_u32 v25, 0xd000, v24
    v_add_u32 v26, 0x1a000, v24
    v_and_b32 v8, 7, v0
    v_lshrrev_b32 v9, 4, v0
    v_xor_b32 v8, v8, v9
    v_lshlrev_b32 v8, 4, v8
    v_and_b32 v9, 15, v0
    v_lshl_add_u32 v27, v9, 7, v8
    v_xor_b32 v30, 64, v27
    s_lshl_b32 s52, s46, 11
    s_mov_b32 s40, 0xfffefffe
    s_mov_b32 s41, 0xfffefffe
    .p2align 3
    v_mov_b32 v188, 0x3f803f80
    v_mov_b32 v189, 0x3f803f80
    v_mov_b32 v190, 0x3f803f80
    v_mov_b32 v191, 0x3f803f80
    v_mov_b32 v224, 0x3f803f80
    v_mov_b32 v225, 0x3f803f80
    v_mov_b32 v226, 0x3f803f80
    v_mov_b32 v227, 0x3f803f80
    v_add_u32 v33, s52, v27
    .p2align 3
    v_add_u32 v28, 0xd000, v27
    v_add_u32 v29, 0x1a000, v27
    v_add_u32 v34, 0xd000, v33
    v_add_u32 v35, 0x1a000, v33
    v_add_u32 v36, s52, v30
    .p2align 3
    v_add_u32 v31, 0xd000, v30
    v_add_u32 v32, 0x1a000, v30
    v_add_u32 v37, 0xd000, v36
    v_add_u32 v38, 0x1a000, v36
    s_barrier
    s_mov_b64 exec, s[40:41]
    ds_read_b128 v[188:191], v27 offset:0
    s_mov_b64 exec, -1
    ds_read_b64_tr_b16 v[180:181], v24 offset:16384
    ds_read_b64_tr_b16 v[182:183], v24 offset:18432
    ds_read_b64_tr_b16 v[184:185], v24 offset:20480
    ds_read_b64_tr_b16 v[186:187], v24 offset:22528
    ds_read_b64_tr_b16 v[176:177], v24 offset:12288
    ds_read_b64_tr_b16 v[178:179], v24 offset:14336
    ds_read_b128 v[192:195], v27 offset:2048
    ds_read_b128 v[196:199], v27 offset:4096
    ds_read_b128 v[200:203], v27 offset:6144
    ds_read_b128 v[204:207], v27 offset:8192
    ds_read_b128 v[208:211], v33 offset:2048
    s_waitcnt lgkmcnt(5)
    v_mfma_f32_16x16x32_bf16 v[136:139], v[180:183], v[188:191], 0
    s_mov_b64 exec, s[40:41]
    ds_read_b128 v[224:227], v30 offset:0
    s_mov_b64 exec, -1
    v_mfma_f32_16x16x32_bf16 v[156:159], v[188:191], v[184:187], 0
    ds_read_b64_tr_b16 v[216:217], v24 offset:28672
    s_waitcnt lgkmcnt(5)
    v_mfma_f32_16x16x32_bf16 v[140:143], v[180:183], v[192:195], 0
    ds_read_b64_tr_b16 v[218:219], v24 offset:30720
    v_mfma_f32_16x16x32_bf16 v[160:163], v[192:195], v[184:187], 0
    ds_read_b64_tr_b16 v[220:221], v24 offset:32768
    v_mfma_f32_16x16x32_bf16 v[120:123], v[176:179], v[192:195], 0
    ds_read_b64_tr_b16 v[222:223], v24 offset:34816
    v_mfma_f32_16x16x32_bf16 v[144:147], v[180:183], v[196:199], 0
    ds_read_b64_tr_b16 v[212:213], v24 offset:24576
    v_mfma_f32_16x16x32_bf16 v[164:167], v[196:199], v[184:187], 0
    ds_read_b64_tr_b16 v[214:215], v24 offset:26624
    v_mfma_f32_16x16x32_bf16 v[124:127], v[176:179], v[196:199], 0
    ds_read_b128 v[228:231], v30 offset:2048
    s_waitcnt lgkmcnt(9)
    v_mfma_f32_16x16x32_bf16 v[148:151], v[180:183], v[200:203], 0
    ds_read_b128 v[232:235], v30 offset:4096
    v_mfma_f32_16x16x32_bf16 v[168:171], v[200:203], v[184:187], 0
    ds_read_b128 v[236:239], v30 offset:6144
    v_mfma_f32_16x16x32_bf16 v[128:131], v[176:179], v[200:203], 0
    ds_read_b128 v[240:243], v30 offset:8192
    v_mfma_f32_16x16x32_bf16 v[152:155], v[180:183], v[204:207], 0
    ds_read_b128 v[244:247], v36 offset:2048
    v_mfma_f32_16x16x32_bf16 v[172:175], v[204:207], v[184:187], 0
    v_mfma_f32_16x16x32_bf16 v[132:135], v[176:179], v[204:207], 0
    s_waitcnt lgkmcnt(12)
    v_mfma_f32_16x16x32_bf16 v[76:79], v[208:211], v[208:211], 0
    v_mfma_f32_16x16x32_bf16 v[80:83], v[100:103], v[208:211], 0
    v_mfma_f32_16x16x32_bf16 v[84:87], v[188:191], v[188:191], 0
    v_mfma_f32_16x16x32_bf16 v[64:67], v[176:179], v[100:103], 0
    s_waitcnt lgkmcnt(5)
    v_mfma_f32_16x16x32_bf16 v[136:139], v[216:219], v[224:227], v[136:139]
    v_mfma_f32_16x16x32_bf16 v[156:159], v[224:227], v[220:223], v[156:159]
    s_waitcnt lgkmcnt(3)
    v_mfma_f32_16x16x32_bf16 v[140:143], v[216:219], v[228:231], v[140:143]
    s_waitcnt lgkmcnt(0)
    s_barrier
    v_mfma_f32_16x16x32_bf16 v[160:163], v[228:231], v[220:223], v[160:163]
    s_mov_b64 exec, s[40:41]
    ds_read_b128 v[188:191], v27 offset:36864
    s_mov_b64 exec, -1
    v_mfma_f32_16x16x32_bf16 v[120:123], v[212:215], v[228:231], v[120:123]
    ds_read_b64_tr_b16 v[180:181], v25 offset:0
    v_mfma_f32_16x16x32_bf16 v[144:147], v[216:219], v[232:235], v[144:147]
    ds_read_b64_tr_b16 v[182:183], v25 offset:2048
    v_mfma_f32_16x16x32_bf16 v[164:167], v[232:235], v[220:223], v[164:167]
    ds_read_b64_tr_b16 v[184:185], v25 offset:4096
    v_mfma_f32_16x16x32_bf16 v[124:127], v[212:215], v[232:235], v[124:127]
    ds_read_b64_tr_b16 v[186:187], v25 offset:6144
    v_mfma_f32_16x16x32_bf16 v[148:151], v[216:219], v[236:239], v[148:151]
    ds_read_b64_tr_b16 v[176:177], v24 offset:49152
    v_mfma_f32_16x16x32_bf16 v[168:171], v[236:239], v[220:223], v[168:171]
    ds_read_b64_tr_b16 v[178:179], v24 offset:51200
    v_mfma_f32_16x16x32_bf16 v[128:131], v[212:215], v[236:239], v[128:131]
    ds_read_b128 v[192:195], v27 offset:38912
    v_mfma_f32_16x16x32_bf16 v[152:155], v[216:219], v[240:243], v[152:155]
    ds_read_b128 v[196:199], v27 offset:40960
    v_mfma_f32_16x16x32_bf16 v[172:175], v[240:243], v[220:223], v[172:175]
    ds_read_b128 v[200:203], v27 offset:43008
    v_mfma_f32_16x16x32_bf16 v[132:135], v[212:215], v[240:243], v[132:135]
    ds_read_b128 v[204:207], v27 offset:45056
    v_mfma_f32_16x16x32_bf16 v[76:79], v[244:247], v[244:247], v[76:79]
    ds_read_b128 v[208:211], v33 offset:38912
    v_mfma_f32_16x16x32_bf16 v[80:83], v[100:103], v[244:247], v[80:83]
    v_mfma_f32_16x16x32_bf16 v[84:87], v[224:227], v[224:227], v[84:87]
    v_mfma_f32_16x16x32_bf16 v[64:67], v[212:215], v[100:103], v[64:67]
    s_waitcnt lgkmcnt(5)
    v_mfma_f32_16x16x32_bf16 v[136:139], v[180:183], v[188:191], v[136:139]
    s_mov_b64 exec, s[40:41]
    ds_read_b128 v[224:227], v30 offset:36864
    s_mov_b64 exec, -1
    v_mfma_f32_16x16x32_bf16 v[156:159], v[188:191], v[184:187], v[156:159]
    ds_read_b64_tr_b16 v[216:217], v25 offset:12288
    s_waitcnt lgkmcnt(5)
    v_mfma_f32_16x16x32_bf16 v[140:143], v[180:183], v[192:195], v[140:143]
    ds_read_b64_tr_b16 v[218:219], v25 offset:14336
    v_mfma_f32_16x16x32_bf16 v[160:163], v[192:195], v[184:187], v[160:163]
    ds_read_b64_tr_b16 v[220:221], v25 offset:16384
    v_mfma_f32_16x16x32_bf16 v[120:123], v[176:179], v[192:195], v[120:123]
    ds_read_b64_tr_b16 v[222:223], v25 offset:18432
    v_mfma_f32_16x16x32_bf16 v[144:147], v[180:183], v[196:199], v[144:147]
    ds_read_b64_tr_b16 v[212:213], v25 offset:8192
    v_mfma_f32_16x16x32_bf16 v[164:167], v[196:199], v[184:187], v[164:167]
    ds_read_b64_tr_b16 v[214:215], v25 offset:10240
    v_mfma_f32_16x16x32_bf16 v[124:127], v[176:179], v[196:199], v[124:127]
    ds_read_b128 v[228:231], v30 offset:38912
    s_waitcnt lgkmcnt(9)
    v_mfma_f32_16x16x32_bf16 v[148:151], v[180:183], v[200:203], v[148:151]
    ds_read_b128 v[232:235], v30 offset:40960
    v_mfma_f32_16x16x32_bf16 v[168:171], v[200:203], v[184:187], v[168:171]
    ds_read_b128 v[236:239], v30 offset:43008
    v_mfma_f32_16x16x32_bf16 v[128:131], v[176:179], v[200:203], v[128:131]
    ds_read_b128 v[240:243], v30 offset:45056
    v_mfma_f32_16x16x32_bf16 v[152:155], v[180:183], v[204:207], v[152:155]
    ds_read_b128 v[244:247], v36 offset:38912
    v_mfma_f32_16x16x32_bf16 v[172:175], v[204:207], v[184:187], v[172:175]
    v_mfma_f32_16x16x32_bf16 v[132:135], v[176:179], v[204:207], v[132:135]
    s_waitcnt lgkmcnt(12)
    v_mfma_f32_16x16x32_bf16 v[76:79], v[208:211], v[208:211], v[76:79]
    v_mfma_f32_16x16x32_bf16 v[80:83], v[100:103], v[208:211], v[80:83]
    v_mfma_f32_16x16x32_bf16 v[84:87], v[188:191], v[188:191], v[84:87]
    v_mfma_f32_16x16x32_bf16 v[64:67], v[176:179], v[100:103], v[64:67]
    s_waitcnt lgkmcnt(5)
    v_mfma_f32_16x16x32_bf16 v[136:139], v[216:219], v[224:227], v[136:139]
    v_mfma_f32_16x16x32_bf16 v[156:159], v[224:227], v[220:223], v[156:159]
    s_waitcnt lgkmcnt(3)
    v_mfma_f32_16x16x32_bf16 v[140:143], v[216:219], v[228:231], v[140:143]
    s_waitcnt lgkmcnt(0)
    s_barrier
    v_mfma_f32_16x16x32_bf16 v[160:163], v[228:231], v[220:223], v[160:163]
    s_mov_b64 exec, s[40:41]
    ds_read_b128 v[188:191], v28 offset:20480
    s_mov_b64 exec, -1
    v_mfma_f32_16x16x32_bf16 v[120:123], v[212:215], v[228:231], v[120:123]
    ds_read_b64_tr_b16 v[180:181], v25 offset:36864
    v_mfma_f32_16x16x32_bf16 v[144:147], v[216:219], v[232:235], v[144:147]
    ds_read_b64_tr_b16 v[182:183], v25 offset:38912
    v_mfma_f32_16x16x32_bf16 v[164:167], v[232:235], v[220:223], v[164:167]
    ds_read_b64_tr_b16 v[184:185], v25 offset:40960
    v_mfma_f32_16x16x32_bf16 v[124:127], v[212:215], v[232:235], v[124:127]
    ds_read_b64_tr_b16 v[186:187], v25 offset:43008
    v_mfma_f32_16x16x32_bf16 v[148:151], v[216:219], v[236:239], v[148:151]
    ds_read_b64_tr_b16 v[176:177], v25 offset:32768
    v_mfma_f32_16x16x32_bf16 v[168:171], v[236:239], v[220:223], v[168:171]
    ds_read_b64_tr_b16 v[178:179], v25 offset:34816
    v_mfma_f32_16x16x32_bf16 v[128:131], v[212:215], v[236:239], v[128:131]
    ds_read_b128 v[192:195], v28 offset:22528
    v_mfma_f32_16x16x32_bf16 v[152:155], v[216:219], v[240:243], v[152:155]
    ds_read_b128 v[196:199], v28 offset:24576
    v_mfma_f32_16x16x32_bf16 v[172:175], v[240:243], v[220:223], v[172:175]
    ds_read_b128 v[200:203], v28 offset:26624
    v_mfma_f32_16x16x32_bf16 v[132:135], v[212:215], v[240:243], v[132:135]
    ds_read_b128 v[204:207], v28 offset:28672
    v_mfma_f32_16x16x32_bf16 v[76:79], v[244:247], v[244:247], v[76:79]
    ds_read_b128 v[208:211], v34 offset:22528
    v_mfma_f32_16x16x32_bf16 v[80:83], v[100:103], v[244:247], v[80:83]
    v_mfma_f32_16x16x32_bf16 v[84:87], v[224:227], v[224:227], v[84:87]
    v_mfma_f32_16x16x32_bf16 v[64:67], v[212:215], v[100:103], v[64:67]
    s_waitcnt lgkmcnt(5)
    v_mfma_f32_16x16x32_bf16 v[136:139], v[180:183], v[188:191], v[136:139]
    s_mov_b64 exec, s[40:41]
    ds_read_b128 v[224:227], v31 offset:20480
    s_mov_b64 exec, -1
    v_mfma_f32_16x16x32_bf16 v[156:159], v[188:191], v[184:187], v[156:159]
    ds_read_b64_tr_b16 v[216:217], v25 offset:49152
    s_waitcnt lgkmcnt(5)
    v_mfma_f32_16x16x32_bf16 v[140:143], v[180:183], v[192:195], v[140:143]
    ds_read_b64_tr_b16 v[218:219], v25 offset:51200
    v_mfma_f32_16x16x32_bf16 v[160:163], v[192:195], v[184:187], v[160:163]
    ds_read_b64_tr_b16 v[220:221], v26 offset:0
    v_mfma_f32_16x16x32_bf16 v[120:123], v[176:179], v[192:195], v[120:123]
    ds_read_b64_tr_b16 v[222:223], v26 offset:2048
    v_mfma_f32_16x16x32_bf16 v[144:147], v[180:183], v[196:199], v[144:147]
    ds_read_b64_tr_b16 v[212:213], v25 offset:45056
    v_mfma_f32_16x16x32_bf16 v[164:167], v[196:199], v[184:187], v[164:167]
    ds_read_b64_tr_b16 v[214:215], v25 offset:47104
    v_mfma_f32_16x16x32_bf16 v[124:127], v[176:179], v[196:199], v[124:127]
    ds_read_b128 v[228:231], v31 offset:22528
    s_waitcnt lgkmcnt(9)
    v_mfma_f32_16x16x32_bf16 v[148:151], v[180:183], v[200:203], v[148:151]
    ds_read_b128 v[232:235], v31 offset:24576
    v_mfma_f32_16x16x32_bf16 v[168:171], v[200:203], v[184:187], v[168:171]
    ds_read_b128 v[236:239], v31 offset:26624
    v_mfma_f32_16x16x32_bf16 v[128:131], v[176:179], v[200:203], v[128:131]
    ds_read_b128 v[240:243], v31 offset:28672
    v_mfma_f32_16x16x32_bf16 v[152:155], v[180:183], v[204:207], v[152:155]
    ds_read_b128 v[244:247], v37 offset:22528
    v_mfma_f32_16x16x32_bf16 v[172:175], v[204:207], v[184:187], v[172:175]
    v_mfma_f32_16x16x32_bf16 v[132:135], v[176:179], v[204:207], v[132:135]
    s_waitcnt lgkmcnt(12)
    v_mfma_f32_16x16x32_bf16 v[76:79], v[208:211], v[208:211], v[76:79]
    v_mfma_f32_16x16x32_bf16 v[80:83], v[100:103], v[208:211], v[80:83]
    v_mfma_f32_16x16x32_bf16 v[84:87], v[188:191], v[188:191], v[84:87]
    v_mfma_f32_16x16x32_bf16 v[64:67], v[176:179], v[100:103], v[64:67]
    s_waitcnt lgkmcnt(5)
    v_mfma_f32_16x16x32_bf16 v[136:139], v[216:219], v[224:227], v[136:139]
    v_mfma_f32_16x16x32_bf16 v[156:159], v[224:227], v[220:223], v[156:159]
    s_waitcnt lgkmcnt(3)
    v_mfma_f32_16x16x32_bf16 v[140:143], v[216:219], v[228:231], v[140:143]
    s_waitcnt lgkmcnt(0)
    s_barrier
    v_mfma_f32_16x16x32_bf16 v[160:163], v[228:231], v[220:223], v[160:163]
    s_mov_b64 exec, s[40:41]
    ds_read_b128 v[188:191], v29 offset:4096
    s_mov_b64 exec, -1
    v_mfma_f32_16x16x32_bf16 v[120:123], v[212:215], v[228:231], v[120:123]
    ds_read_b64_tr_b16 v[180:181], v26 offset:20480
    v_mfma_f32_16x16x32_bf16 v[144:147], v[216:219], v[232:235], v[144:147]
    ds_read_b64_tr_b16 v[182:183], v26 offset:22528
    v_mfma_f32_16x16x32_bf16 v[164:167], v[232:235], v[220:223], v[164:167]
    ds_read_b64_tr_b16 v[184:185], v26 offset:24576
    v_mfma_f32_16x16x32_bf16 v[124:127], v[212:215], v[232:235], v[124:127]
    ds_read_b64_tr_b16 v[186:187], v26 offset:26624
    v_mfma_f32_16x16x32_bf16 v[148:151], v[216:219], v[236:239], v[148:151]
    ds_read_b64_tr_b16 v[176:177], v26 offset:16384
    v_mfma_f32_16x16x32_bf16 v[168:171], v[236:239], v[220:223], v[168:171]
    ds_read_b64_tr_b16 v[178:179], v26 offset:18432
    v_mfma_f32_16x16x32_bf16 v[128:131], v[212:215], v[236:239], v[128:131]
    ds_read_b128 v[192:195], v29 offset:6144
    v_mfma_f32_16x16x32_bf16 v[152:155], v[216:219], v[240:243], v[152:155]
    ds_read_b128 v[196:199], v29 offset:8192
    v_mfma_f32_16x16x32_bf16 v[172:175], v[240:243], v[220:223], v[172:175]
    ds_read_b128 v[200:203], v29 offset:10240
    v_mfma_f32_16x16x32_bf16 v[132:135], v[212:215], v[240:243], v[132:135]
    ds_read_b128 v[204:207], v29 offset:12288
    v_mfma_f32_16x16x32_bf16 v[76:79], v[244:247], v[244:247], v[76:79]
    ds_read_b128 v[208:211], v35 offset:6144
    v_mfma_f32_16x16x32_bf16 v[80:83], v[100:103], v[244:247], v[80:83]
    v_mfma_f32_16x16x32_bf16 v[84:87], v[224:227], v[224:227], v[84:87]
    v_mfma_f32_16x16x32_bf16 v[64:67], v[212:215], v[100:103], v[64:67]
    s_waitcnt lgkmcnt(5)
    v_mfma_f32_16x16x32_bf16 v[136:139], v[180:183], v[188:191], v[136:139]
    s_mov_b64 exec, s[40:41]
    ds_read_b128 v[224:227], v32 offset:4096
    s_mov_b64 exec, -1
    v_mfma_f32_16x16x32_bf16 v[156:159], v[188:191], v[184:187], v[156:159]
    ds_read_b64_tr_b16 v[216:217], v26 offset:32768
    s_waitcnt lgkmcnt(5)
    v_mfma_f32_16x16x32_bf16 v[140:143], v[180:183], v[192:195], v[140:143]
    ds_read_b64_tr_b16 v[218:219], v26 offset:34816
    v_mfma_f32_16x16x32_bf16 v[160:163], v[192:195], v[184:187], v[160:163]
    ds_read_b64_tr_b16 v[220:221], v26 offset:36864
    v_mfma_f32_16x16x32_bf16 v[120:123], v[176:179], v[192:195], v[120:123]
    ds_read_b64_tr_b16 v[222:223], v26 offset:38912
    v_mfma_f32_16x16x32_bf16 v[144:147], v[180:183], v[196:199], v[144:147]
    ds_read_b64_tr_b16 v[212:213], v26 offset:28672
    v_mfma_f32_16x16x32_bf16 v[164:167], v[196:199], v[184:187], v[164:167]
    ds_read_b64_tr_b16 v[214:215], v26 offset:30720
    v_mfma_f32_16x16x32_bf16 v[124:127], v[176:179], v[196:199], v[124:127]
    ds_read_b128 v[228:231], v32 offset:6144
    s_waitcnt lgkmcnt(9)
    v_mfma_f32_16x16x32_bf16 v[148:151], v[180:183], v[200:203], v[148:151]
    ds_read_b128 v[232:235], v32 offset:8192
    v_mfma_f32_16x16x32_bf16 v[168:171], v[200:203], v[184:187], v[168:171]
    ds_read_b128 v[236:239], v32 offset:10240
    v_mfma_f32_16x16x32_bf16 v[128:131], v[176:179], v[200:203], v[128:131]
    ds_read_b128 v[240:243], v32 offset:12288
    v_mfma_f32_16x16x32_bf16 v[152:155], v[180:183], v[204:207], v[152:155]
    ds_read_b128 v[244:247], v38 offset:6144
    v_mfma_f32_16x16x32_bf16 v[172:175], v[204:207], v[184:187], v[172:175]
    v_mfma_f32_16x16x32_bf16 v[132:135], v[176:179], v[204:207], v[132:135]
    s_waitcnt lgkmcnt(12)
    v_mfma_f32_16x16x32_bf16 v[76:79], v[208:211], v[208:211], v[76:79]
    v_mfma_f32_16x16x32_bf16 v[80:83], v[100:103], v[208:211], v[80:83]
    v_mfma_f32_16x16x32_bf16 v[84:87], v[188:191], v[188:191], v[84:87]
    v_mfma_f32_16x16x32_bf16 v[64:67], v[176:179], v[100:103], v[64:67]
    s_waitcnt lgkmcnt(5)
    v_mfma_f32_16x16x32_bf16 v[136:139], v[216:219], v[224:227], v[136:139]
    v_mfma_f32_16x16x32_bf16 v[156:159], v[224:227], v[220:223], v[156:159]
    s_waitcnt lgkmcnt(3)
    v_mfma_f32_16x16x32_bf16 v[140:143], v[216:219], v[228:231], v[140:143]
    s_waitcnt lgkmcnt(0)
    s_barrier
    v_mfma_f32_16x16x32_bf16 v[160:163], v[228:231], v[220:223], v[160:163]
    s_mov_b64 exec, s[40:41]
    ds_read_b128 v[188:191], v29 offset:40960
    s_mov_b64 exec, -1
    v_mfma_f32_16x16x32_bf16 v[120:123], v[212:215], v[228:231], v[120:123]
    ds_read_b64_tr_b16 v[180:181], v24 offset:4096
    v_mfma_f32_16x16x32_bf16 v[144:147], v[216:219], v[232:235], v[144:147]
    ds_read_b64_tr_b16 v[182:183], v24 offset:6144
    v_mfma_f32_16x16x32_bf16 v[164:167], v[232:235], v[220:223], v[164:167]
    ds_read_b64_tr_b16 v[184:185], v24 offset:8192
    v_mfma_f32_16x16x32_bf16 v[124:127], v[212:215], v[232:235], v[124:127]
    ds_read_b64_tr_b16 v[186:187], v24 offset:10240
    v_mfma_f32_16x16x32_bf16 v[148:151], v[216:219], v[236:239], v[148:151]
    ds_read_b64_tr_b16 v[176:177], v24 offset:0
    v_mfma_f32_16x16x32_bf16 v[168:171], v[236:239], v[220:223], v[168:171]
    ds_read_b64_tr_b16 v[178:179], v24 offset:2048
    v_mfma_f32_16x16x32_bf16 v[128:131], v[212:215], v[236:239], v[128:131]
    ds_read_b128 v[192:195], v29 offset:43008
    v_mfma_f32_16x16x32_bf16 v[152:155], v[216:219], v[240:243], v[152:155]
    ds_read_b128 v[196:199], v29 offset:45056
    v_mfma_f32_16x16x32_bf16 v[172:175], v[240:243], v[220:223], v[172:175]
    ds_read_b128 v[200:203], v29 offset:47104
    v_mfma_f32_16x16x32_bf16 v[132:135], v[212:215], v[240:243], v[132:135]
    ds_read_b128 v[204:207], v29 offset:49152
    v_mfma_f32_16x16x32_bf16 v[76:79], v[244:247], v[244:247], v[76:79]
    ds_read_b128 v[208:211], v35 offset:43008
    v_mfma_f32_16x16x32_bf16 v[80:83], v[100:103], v[244:247], v[80:83]
    v_mfma_f32_16x16x32_bf16 v[84:87], v[224:227], v[224:227], v[84:87]
    v_mfma_f32_16x16x32_bf16 v[64:67], v[212:215], v[100:103], v[64:67]
    s_waitcnt lgkmcnt(5)
    v_mfma_f32_16x16x32_bf16 v[136:139], v[180:183], v[188:191], v[136:139]
    s_mov_b64 exec, s[40:41]
    ds_read_b128 v[224:227], v32 offset:40960
    s_mov_b64 exec, -1
    v_mfma_f32_16x16x32_bf16 v[156:159], v[188:191], v[184:187], v[156:159]
    ds_read_b64_tr_b16 v[216:217], v24 offset:16384
    s_waitcnt lgkmcnt(5)
    v_mfma_f32_16x16x32_bf16 v[140:143], v[180:183], v[192:195], v[140:143]
    ds_read_b64_tr_b16 v[218:219], v24 offset:18432
    v_mfma_f32_16x16x32_bf16 v[160:163], v[192:195], v[184:187], v[160:163]
    ds_read_b64_tr_b16 v[220:221], v24 offset:20480
    v_mfma_f32_16x16x32_bf16 v[120:123], v[176:179], v[192:195], v[120:123]
    ds_read_b64_tr_b16 v[222:223], v24 offset:22528
    v_mfma_f32_16x16x32_bf16 v[144:147], v[180:183], v[196:199], v[144:147]
    ds_read_b64_tr_b16 v[212:213], v24 offset:12288
    v_mfma_f32_16x16x32_bf16 v[164:167], v[196:199], v[184:187], v[164:167]
    ds_read_b64_tr_b16 v[214:215], v24 offset:14336
    v_mfma_f32_16x16x32_bf16 v[124:127], v[176:179], v[196:199], v[124:127]
    ds_read_b128 v[228:231], v32 offset:43008
    s_waitcnt lgkmcnt(9)
    v_mfma_f32_16x16x32_bf16 v[148:151], v[180:183], v[200:203], v[148:151]
    ds_read_b128 v[232:235], v32 offset:45056
    v_mfma_f32_16x16x32_bf16 v[168:171], v[200:203], v[184:187], v[168:171]
    ds_read_b128 v[236:239], v32 offset:47104
    v_mfma_f32_16x16x32_bf16 v[128:131], v[176:179], v[200:203], v[128:131]
    ds_read_b128 v[240:243], v32 offset:49152
    v_mfma_f32_16x16x32_bf16 v[152:155], v[180:183], v[204:207], v[152:155]
    ds_read_b128 v[244:247], v38 offset:43008
    v_mfma_f32_16x16x32_bf16 v[172:175], v[204:207], v[184:187], v[172:175]
    v_mfma_f32_16x16x32_bf16 v[132:135], v[176:179], v[204:207], v[132:135]
    s_waitcnt lgkmcnt(12)
    v_mfma_f32_16x16x32_bf16 v[76:79], v[208:211], v[208:211], v[76:79]
    v_mfma_f32_16x16x32_bf16 v[80:83], v[100:103], v[208:211], v[80:83]
    v_mfma_f32_16x16x32_bf16 v[84:87], v[188:191], v[188:191], v[84:87]
    v_mfma_f32_16x16x32_bf16 v[64:67], v[176:179], v[100:103], v[64:67]
    s_waitcnt lgkmcnt(5)
    v_mfma_f32_16x16x32_bf16 v[136:139], v[216:219], v[224:227], v[136:139]
    v_mfma_f32_16x16x32_bf16 v[156:159], v[224:227], v[220:223], v[156:159]
    s_waitcnt lgkmcnt(3)
    v_mfma_f32_16x16x32_bf16 v[140:143], v[216:219], v[228:231], v[140:143]
    s_waitcnt lgkmcnt(0)
    s_barrier
    v_mfma_f32_16x16x32_bf16 v[160:163], v[228:231], v[220:223], v[160:163]
    s_mov_b64 exec, s[40:41]
    ds_read_b128 v[188:191], v27 offset:24576
    s_mov_b64 exec, -1
    v_mfma_f32_16x16x32_bf16 v[120:123], v[212:215], v[228:231], v[120:123]
    ds_read_b64_tr_b16 v[180:181], v24 offset:40960
    v_mfma_f32_16x16x32_bf16 v[144:147], v[216:219], v[232:235], v[144:147]
    ds_read_b64_tr_b16 v[182:183], v24 offset:43008
    v_mfma_f32_16x16x32_bf16 v[164:167], v[232:235], v[220:223], v[164:167]
    ds_read_b64_tr_b16 v[184:185], v24 offset:45056
    v_mfma_f32_16x16x32_bf16 v[124:127], v[212:215], v[232:235], v[124:127]
    ds_read_b64_tr_b16 v[186:187], v24 offset:47104
    v_mfma_f32_16x16x32_bf16 v[148:151], v[216:219], v[236:239], v[148:151]
    ds_read_b64_tr_b16 v[176:177], v24 offset:36864
    v_mfma_f32_16x16x32_bf16 v[168:171], v[236:239], v[220:223], v[168:171]
    ds_read_b64_tr_b16 v[178:179], v24 offset:38912
    v_mfma_f32_16x16x32_bf16 v[128:131], v[212:215], v[236:239], v[128:131]
    ds_read_b128 v[192:195], v27 offset:26624
    v_mfma_f32_16x16x32_bf16 v[152:155], v[216:219], v[240:243], v[152:155]
    ds_read_b128 v[196:199], v27 offset:28672
    v_mfma_f32_16x16x32_bf16 v[172:175], v[240:243], v[220:223], v[172:175]
    ds_read_b128 v[200:203], v27 offset:30720
    v_mfma_f32_16x16x32_bf16 v[132:135], v[212:215], v[240:243], v[132:135]
    ds_read_b128 v[204:207], v27 offset:32768
    v_mfma_f32_16x16x32_bf16 v[76:79], v[244:247], v[244:247], v[76:79]
    ds_read_b128 v[208:211], v33 offset:26624
    v_mfma_f32_16x16x32_bf16 v[80:83], v[100:103], v[244:247], v[80:83]
    v_mfma_f32_16x16x32_bf16 v[84:87], v[224:227], v[224:227], v[84:87]
    v_mfma_f32_16x16x32_bf16 v[64:67], v[212:215], v[100:103], v[64:67]
    s_waitcnt lgkmcnt(5)
    v_mfma_f32_16x16x32_bf16 v[136:139], v[180:183], v[188:191], v[136:139]
    s_mov_b64 exec, s[40:41]
    ds_read_b128 v[224:227], v30 offset:24576
    s_mov_b64 exec, -1
    v_mfma_f32_16x16x32_bf16 v[156:159], v[188:191], v[184:187], v[156:159]
    ds_read_b64_tr_b16 v[216:217], v25 offset:0
    s_waitcnt lgkmcnt(5)
    v_mfma_f32_16x16x32_bf16 v[140:143], v[180:183], v[192:195], v[140:143]
    ds_read_b64_tr_b16 v[218:219], v25 offset:2048
    v_mfma_f32_16x16x32_bf16 v[160:163], v[192:195], v[184:187], v[160:163]
    ds_read_b64_tr_b16 v[220:221], v25 offset:4096
    v_mfma_f32_16x16x32_bf16 v[120:123], v[176:179], v[192:195], v[120:123]
    ds_read_b64_tr_b16 v[222:223], v25 offset:6144
    v_mfma_f32_16x16x32_bf16 v[144:147], v[180:183], v[196:199], v[144:147]
    ds_read_b64_tr_b16 v[212:213], v24 offset:49152
    v_mfma_f32_16x16x32_bf16 v[164:167], v[196:199], v[184:187], v[164:167]
    ds_read_b64_tr_b16 v[214:215], v24 offset:51200
    v_mfma_f32_16x16x32_bf16 v[124:127], v[176:179], v[196:199], v[124:127]
    ds_read_b128 v[228:231], v30 offset:26624
    s_waitcnt lgkmcnt(9)
    v_mfma_f32_16x16x32_bf16 v[148:151], v[180:183], v[200:203], v[148:151]
    ds_read_b128 v[232:235], v30 offset:28672
    v_mfma_f32_16x16x32_bf16 v[168:171], v[200:203], v[184:187], v[168:171]
    ds_read_b128 v[236:239], v30 offset:30720
    v_mfma_f32_16x16x32_bf16 v[128:131], v[176:179], v[200:203], v[128:131]
    ds_read_b128 v[240:243], v30 offset:32768
    v_mfma_f32_16x16x32_bf16 v[152:155], v[180:183], v[204:207], v[152:155]
    ds_read_b128 v[244:247], v36 offset:26624
    v_mfma_f32_16x16x32_bf16 v[172:175], v[204:207], v[184:187], v[172:175]
    v_mfma_f32_16x16x32_bf16 v[132:135], v[176:179], v[204:207], v[132:135]
    s_waitcnt lgkmcnt(12)
    v_mfma_f32_16x16x32_bf16 v[76:79], v[208:211], v[208:211], v[76:79]
    v_mfma_f32_16x16x32_bf16 v[80:83], v[100:103], v[208:211], v[80:83]
    v_mfma_f32_16x16x32_bf16 v[84:87], v[188:191], v[188:191], v[84:87]
    v_mfma_f32_16x16x32_bf16 v[64:67], v[176:179], v[100:103], v[64:67]
    s_waitcnt lgkmcnt(5)
    v_mfma_f32_16x16x32_bf16 v[136:139], v[216:219], v[224:227], v[136:139]
    v_mfma_f32_16x16x32_bf16 v[156:159], v[224:227], v[220:223], v[156:159]
    s_waitcnt lgkmcnt(3)
    v_mfma_f32_16x16x32_bf16 v[140:143], v[216:219], v[228:231], v[140:143]
    s_waitcnt lgkmcnt(0)
    s_barrier
    v_mfma_f32_16x16x32_bf16 v[160:163], v[228:231], v[220:223], v[160:163]
    s_mov_b64 exec, s[40:41]
    ds_read_b128 v[188:191], v28 offset:8192
    s_mov_b64 exec, -1
    v_mfma_f32_16x16x32_bf16 v[120:123], v[212:215], v[228:231], v[120:123]
    ds_read_b64_tr_b16 v[180:181], v25 offset:24576
    v_mfma_f32_16x16x32_bf16 v[144:147], v[216:219], v[232:235], v[144:147]
    ds_read_b64_tr_b16 v[182:183], v25 offset:26624
    v_mfma_f32_16x16x32_bf16 v[164:167], v[232:235], v[220:223], v[164:167]
    ds_read_b64_tr_b16 v[184:185], v25 offset:28672
    v_mfma_f32_16x16x32_bf16 v[124:127], v[212:215], v[232:235], v[124:127]
    ds_read_b64_tr_b16 v[186:187], v25 offset:30720
    v_mfma_f32_16x16x32_bf16 v[148:151], v[216:219], v[236:239], v[148:151]
    ds_read_b64_tr_b16 v[176:177], v25 offset:20480
    v_mfma_f32_16x16x32_bf16 v[168:171], v[236:239], v[220:223], v[168:171]
    ds_read_b64_tr_b16 v[178:179], v25 offset:22528
    v_mfma_f32_16x16x32_bf16 v[128:131], v[212:215], v[236:239], v[128:131]
    ds_read_b128 v[192:195], v28 offset:10240
    v_mfma_f32_16x16x32_bf16 v[152:155], v[216:219], v[240:243], v[152:155]
    ds_read_b128 v[196:199], v28 offset:12288
    v_mfma_f32_16x16x32_bf16 v[172:175], v[240:243], v[220:223], v[172:175]
    ds_read_b128 v[200:203], v28 offset:14336
    v_mfma_f32_16x16x32_bf16 v[132:135], v[212:215], v[240:243], v[132:135]
    ds_read_b128 v[204:207], v28 offset:16384
    v_mfma_f32_16x16x32_bf16 v[76:79], v[244:247], v[244:247], v[76:79]
    ds_read_b128 v[208:211], v34 offset:10240
    v_mfma_f32_16x16x32_bf16 v[80:83], v[100:103], v[244:247], v[80:83]
    v_mfma_f32_16x16x32_bf16 v[84:87], v[224:227], v[224:227], v[84:87]
    v_mfma_f32_16x16x32_bf16 v[64:67], v[212:215], v[100:103], v[64:67]
    s_waitcnt lgkmcnt(5)
    v_mfma_f32_16x16x32_bf16 v[136:139], v[180:183], v[188:191], v[136:139]
    s_mov_b64 exec, s[40:41]
    ds_read_b128 v[224:227], v31 offset:8192
    s_mov_b64 exec, -1
    v_mfma_f32_16x16x32_bf16 v[156:159], v[188:191], v[184:187], v[156:159]
    ds_read_b64_tr_b16 v[216:217], v25 offset:36864
    s_waitcnt lgkmcnt(5)
    v_mfma_f32_16x16x32_bf16 v[140:143], v[180:183], v[192:195], v[140:143]
    ds_read_b64_tr_b16 v[218:219], v25 offset:38912
    v_mfma_f32_16x16x32_bf16 v[160:163], v[192:195], v[184:187], v[160:163]
    ds_read_b64_tr_b16 v[220:221], v25 offset:40960
    v_mfma_f32_16x16x32_bf16 v[120:123], v[176:179], v[192:195], v[120:123]
    ds_read_b64_tr_b16 v[222:223], v25 offset:43008
    v_mfma_f32_16x16x32_bf16 v[144:147], v[180:183], v[196:199], v[144:147]
    ds_read_b64_tr_b16 v[212:213], v25 offset:32768
    v_mfma_f32_16x16x32_bf16 v[164:167], v[196:199], v[184:187], v[164:167]
    ds_read_b64_tr_b16 v[214:215], v25 offset:34816
    v_mfma_f32_16x16x32_bf16 v[124:127], v[176:179], v[196:199], v[124:127]
    ds_read_b128 v[228:231], v31 offset:10240
    s_waitcnt lgkmcnt(9)
    v_mfma_f32_16x16x32_bf16 v[148:151], v[180:183], v[200:203], v[148:151]
    ds_read_b128 v[232:235], v31 offset:12288
    v_mfma_f32_16x16x32_bf16 v[168:171], v[200:203], v[184:187], v[168:171]
    ds_read_b128 v[236:239], v31 offset:14336
    v_mfma_f32_16x16x32_bf16 v[128:131], v[176:179], v[200:203], v[128:131]
    ds_read_b128 v[240:243], v31 offset:16384
    v_mfma_f32_16x16x32_bf16 v[152:155], v[180:183], v[204:207], v[152:155]
    ds_read_b128 v[244:247], v37 offset:10240
    v_mfma_f32_16x16x32_bf16 v[172:175], v[204:207], v[184:187], v[172:175]
    v_mfma_f32_16x16x32_bf16 v[132:135], v[176:179], v[204:207], v[132:135]
    s_waitcnt lgkmcnt(12)
    v_mfma_f32_16x16x32_bf16 v[76:79], v[208:211], v[208:211], v[76:79]
    v_mfma_f32_16x16x32_bf16 v[80:83], v[100:103], v[208:211], v[80:83]
    v_mfma_f32_16x16x32_bf16 v[84:87], v[188:191], v[188:191], v[84:87]
    v_mfma_f32_16x16x32_bf16 v[64:67], v[176:179], v[100:103], v[64:67]
    s_waitcnt lgkmcnt(5)
    v_mfma_f32_16x16x32_bf16 v[136:139], v[216:219], v[224:227], v[136:139]
    v_mfma_f32_16x16x32_bf16 v[156:159], v[224:227], v[220:223], v[156:159]
    s_waitcnt lgkmcnt(3)
    v_mfma_f32_16x16x32_bf16 v[140:143], v[216:219], v[228:231], v[140:143]
    s_waitcnt lgkmcnt(0)
    s_barrier
    v_mfma_f32_16x16x32_bf16 v[160:163], v[228:231], v[220:223], v[160:163]
    s_mov_b64 exec, s[40:41]
    ds_read_b128 v[188:191], v28 offset:45056
    s_mov_b64 exec, -1
    v_mfma_f32_16x16x32_bf16 v[120:123], v[212:215], v[228:231], v[120:123]
    ds_read_b64_tr_b16 v[180:181], v26 offset:8192
    v_mfma_f32_16x16x32_bf16 v[144:147], v[216:219], v[232:235], v[144:147]
    ds_read_b64_tr_b16 v[182:183], v26 offset:10240
    v_mfma_f32_16x16x32_bf16 v[164:167], v[232:235], v[220:223], v[164:167]
    ds_read_b64_tr_b16 v[184:185], v26 offset:12288
    v_mfma_f32_16x16x32_bf16 v[124:127], v[212:215], v[232:235], v[124:127]
    ds_read_b64_tr_b16 v[186:187], v26 offset:14336
    v_mfma_f32_16x16x32_bf16 v[148:151], v[216:219], v[236:239], v[148:151]
    ds_read_b64_tr_b16 v[176:177], v26 offset:4096
    v_mfma_f32_16x16x32_bf16 v[168:171], v[236:239], v[220:223], v[168:171]
    ds_read_b64_tr_b16 v[178:179], v26 offset:6144
    v_mfma_f32_16x16x32_bf16 v[128:131], v[212:215], v[236:239], v[128:131]
    ds_read_b128 v[192:195], v28 offset:47104
    v_mfma_f32_16x16x32_bf16 v[152:155], v[216:219], v[240:243], v[152:155]
    ds_read_b128 v[196:199], v28 offset:49152
    v_mfma_f32_16x16x32_bf16 v[172:175], v[240:243], v[220:223], v[172:175]
    ds_read_b128 v[200:203], v28 offset:51200
    v_mfma_f32_16x16x32_bf16 v[132:135], v[212:215], v[240:243], v[132:135]
    ds_read_b128 v[204:207], v28 offset:53248
    v_mfma_f32_16x16x32_bf16 v[76:79], v[244:247], v[244:247], v[76:79]
    ds_read_b128 v[208:211], v34 offset:47104
    v_mfma_f32_16x16x32_bf16 v[80:83], v[100:103], v[244:247], v[80:83]
    s_movk_i32 s52, 0x4000
    buffer_load_dwordx4 v[56:59], v15, s[4:7], 0 offen
    buffer_load_dwordx4 v[60:63], v15, s[4:7], s52 offen
    v_mfma_f32_16x16x32_bf16 v[84:87], v[224:227], v[224:227], v[84:87]
    v_mfma_f32_16x16x32_bf16 v[64:67], v[212:215], v[100:103], v[64:67]
    s_waitcnt lgkmcnt(5)
    v_mfma_f32_16x16x32_bf16 v[136:139], v[180:183], v[188:191], v[136:139]
    s_mov_b64 exec, s[40:41]
    ds_read_b128 v[224:227], v31 offset:45056
    s_mov_b64 exec, -1
    v_mfma_f32_16x16x32_bf16 v[156:159], v[188:191], v[184:187], v[156:159]
    ds_read_b64_tr_b16 v[216:217], v26 offset:20480
    s_waitcnt lgkmcnt(5)
    v_mfma_f32_16x16x32_bf16 v[140:143], v[180:183], v[192:195], v[140:143]
    ds_read_b64_tr_b16 v[218:219], v26 offset:22528
    v_mfma_f32_16x16x32_bf16 v[160:163], v[192:195], v[184:187], v[160:163]
    ds_read_b64_tr_b16 v[220:221], v26 offset:24576
    v_mfma_f32_16x16x32_bf16 v[120:123], v[176:179], v[192:195], v[120:123]
    ds_read_b64_tr_b16 v[222:223], v26 offset:26624
    v_mfma_f32_16x16x32_bf16 v[144:147], v[180:183], v[196:199], v[144:147]
    ds_read_b64_tr_b16 v[212:213], v26 offset:16384
    v_mfma_f32_16x16x32_bf16 v[164:167], v[196:199], v[184:187], v[164:167]
    ds_read_b64_tr_b16 v[214:215], v26 offset:18432
    v_mfma_f32_16x16x32_bf16 v[124:127], v[176:179], v[196:199], v[124:127]
    ds_read_b128 v[228:231], v31 offset:47104
    s_waitcnt lgkmcnt(9)
    v_mfma_f32_16x16x32_bf16 v[148:151], v[180:183], v[200:203], v[148:151]
    ds_read_b128 v[232:235], v31 offset:49152
    v_mfma_f32_16x16x32_bf16 v[168:171], v[200:203], v[184:187], v[168:171]
    ds_read_b128 v[236:239], v31 offset:51200
    v_mfma_f32_16x16x32_bf16 v[128:131], v[176:179], v[200:203], v[128:131]
    ds_read_b128 v[240:243], v31 offset:53248
    v_mfma_f32_16x16x32_bf16 v[152:155], v[180:183], v[204:207], v[152:155]
    ds_read_b128 v[244:247], v37 offset:47104
    v_mfma_f32_16x16x32_bf16 v[172:175], v[204:207], v[184:187], v[172:175]
    s_mul_i32 s52, s45, 384
    s_lshl_b32 s55, s46, 5
    s_add_u32 s52, s52, s55
    v_lshrrev_b32 v8, 4, v0
    v_lshlrev_b32 v8, 3, v8
    buffer_load_dwordx2 v[40:41], v8, s[32:35], s52 offen offset:0
    buffer_load_dwordx2 v[42:43], v8, s[32:35], s52 offen offset:128
    buffer_load_dwordx2 v[44:45], v8, s[32:35], s52 offen offset:256
    v_mfma_f32_16x16x32_bf16 v[132:135], v[176:179], v[204:207], v[132:135]
    s_waitcnt lgkmcnt(12)
    v_mfma_f32_16x16x32_bf16 v[76:79], v[208:211], v[208:211], v[76:79]
    v_mfma_f32_16x16x32_bf16 v[80:83], v[100:103], v[208:211], v[80:83]
    v_mfma_f32_16x16x32_bf16 v[84:87], v[188:191], v[188:191], v[84:87]
    v_mfma_f32_16x16x32_bf16 v[64:67], v[176:179], v[100:103], v[64:67]
    s_waitcnt lgkmcnt(0)
    v_mfma_f32_16x16x32_bf16 v[76:79], v[244:247], v[244:247], v[76:79]
    v_mfma_f32_16x16x32_bf16 v[80:83], v[100:103], v[244:247], v[80:83]
    v_mfma_f32_16x16x32_bf16 v[84:87], v[224:227], v[224:227], v[84:87]
    s_barrier
    v_mfma_f32_16x16x32_bf16 v[64:67], v[212:215], v[100:103], v[64:67]
    v_mfma_f32_16x16x32_bf16 v[136:139], v[216:219], v[224:227], v[136:139]
    v_mfma_f32_16x16x32_bf16 v[156:159], v[224:227], v[220:223], v[156:159]
    v_mfma_f32_16x16x32_bf16 v[140:143], v[216:219], v[228:231], v[140:143]
    v_mfma_f32_16x16x32_bf16 v[160:163], v[228:231], v[220:223], v[160:163]
    v_mfma_f32_16x16x32_bf16 v[120:123], v[212:215], v[228:231], v[120:123]
    s_mov_b32 s40, 0x22222222
    s_mov_b32 s41, 0x22222222
    s_mov_b32 s42, 0x44444444
    s_mov_b32 s43, 0x44444444
    s_mov_b32 vcc_lo, 0x88888888
    s_mov_b32 vcc_hi, 0x88888888
    s_lshl_b32 s52, s46, 7
    s_lshl_b32 s53, s46, 6
    v_mov_b32 v88, v84
    v_mov_b32 v89, v84
    s_nop 1
    v_permlane16_swap_b32 v88, v89
    v_mov_b32 v89, v88
    s_nop 1
    v_permlane32_swap_b32 v88, v89
    .p2align 3
    v_mov_b32_dpp v68, v136 row_newbcast:0 row_mask:0xf bank_mask:0xf
    v_mov_b32_dpp v69, v137 row_newbcast:0 row_mask:0xf bank_mask:0xf
    v_mov_b32_dpp v70, v138 row_newbcast:0 row_mask:0xf bank_mask:0xf
    v_mov_b32_dpp v71, v139 row_newbcast:0 row_mask:0xf bank_mask:0xf
    v_mov_b32 v72, v156
    v_mov_b32 v73, v156
    s_nop 1
    v_permlane16_swap_b32 v72, v73
    v_mov_b32 v73, v72
    s_nop 1
    v_permlane32_swap_b32 v72, v73
    v_mov_b32 v73, v72
    v_cndmask_b32_e64 v76, v76, v77, s[40:41]
    v_cndmask_b32_e64 v76, v76, v78, s[42:43]
    v_cndmask_b32 v76, v76, v79, vcc
    .p2align 3
    v_mul_f32 v76, 0x3b000000, v76
    v_mul_f32 v80, 0x3b000000, v80
    v_fma_f32 v76, -v80, v80, v76
    v_max_f32 v76, 0, v76
    v_add_f32 v76, 0x3727c5ac, v76
    v_rsq_f32 v78, v76
    s_nop 0
    v_mul_f32 v79, v78, v80
    v_cndmask_b32_e64 v84, v84, v85, s[40:41]
    v_cndmask_b32_e64 v84, v84, v86, s[42:43]
    v_cndmask_b32 v84, v84, v87, vcc
    .p2align 3
    v_mul_f32 v84, 0x3b000000, v84
    v_mul_f32 v88, 0x3b000000, v88
    v_fma_f32 v84, -v88, v88, v84
    v_max_f32 v84, 0, v84
    v_add_f32 v84, 0x3727c5ac, v84
    v_rsq_f32 v86, v84
    s_nop 0
    v_mul_f32 v87, v86, v88
    v_add_u32 v8, s52, v17
    s_mov_b32 exec_lo, 0x00f0000f
    s_mov_b32 exec_hi, 0xf0000f00
    ds_write2_b32 v8, v78, v79 offset0:32 offset1:48
    ds_write2_b32 v17, v86, v87 offset0:0 offset1:16
    s_mov_b64 exec, -1
    v_mfma_f32_16x16x32_bf16 v[144:147], v[216:219], v[232:235], v[144:147]
    v_mfma_f32_16x16x32_bf16 v[164:167], v[232:235], v[220:223], v[164:167]
    v_mfma_f32_16x16x32_bf16 v[124:127], v[212:215], v[232:235], v[124:127]
    v_mfma_f32_16x16x32_bf16 v[148:151], v[216:219], v[236:239], v[148:151]
    v_mfma_f32_16x16x32_bf16 v[168:171], v[236:239], v[220:223], v[168:171]
    v_mfma_f32_16x16x32_bf16 v[128:131], v[212:215], v[236:239], v[128:131]
    v_mfma_f32_16x16x32_bf16 v[152:155], v[216:219], v[240:243], v[152:155]
    v_mfma_f32_16x16x32_bf16 v[172:175], v[240:243], v[220:223], v[172:175]
    v_mfma_f32_16x16x32_bf16 v[132:135], v[212:215], v[240:243], v[132:135]
    s_waitcnt lgkmcnt(0)
    s_barrier
    ds_read2_b32 v[176:177], v17 offset0:0 offset1:16
    ds_read2_b32 v[178:179], v17 offset0:32 offset1:48
    ds_read2_b32 v[180:181], v17 offset0:64 offset1:80
    ds_read2_b32 v[182:183], v17 offset0:96 offset1:112
    ds_read2_b32 v[184:185], v17 offset0:128 offset1:144
    ds_read_b128 v[208:211], v18 offset:0
    ds_read_b128 v[228:231], v18 offset:64
    ds_read_b128 v[212:215], v18 offset:128
    ds_read_b128 v[232:235], v18 offset:192
    ds_read_b128 v[216:219], v18 offset:256
    ds_read_b128 v[236:239], v18 offset:320
    ds_read_b128 v[220:223], v18 offset:384
    ds_read_b128 v[240:243], v18 offset:448
    ds_read_b128 v[224:227], v18 offset:512
    ds_read_b128 v[244:247], v18 offset:576
    s_waitcnt lgkmcnt(10)
    .p2align 3
    v_pk_mul_f32 v[186:187], v[178:179], s[88:89]
    v_pk_mul_f32 v[188:189], v[180:181], s[88:89]
    v_pk_mul_f32 v[190:191], v[182:183], s[88:89]
    v_pk_mul_f32 v[192:193], v[184:185], s[88:89]
    v_pk_mul_f32 v[194:195], v[68:69], v[176:177] op_sel:[0,1] op_sel_hi:[1,1]
    v_pk_mul_f32 v[196:197], v[70:71], v[176:177] op_sel:[0,1] op_sel_hi:[1,1]
    v_pk_mul_f32 v[198:199], v[68:69], v[178:179] op_sel:[0,1] op_sel_hi:[1,1]
    v_pk_mul_f32 v[200:201], v[70:71], v[178:179] op_sel:[0,1] op_sel_hi:[1,1]
    v_pk_fma_f32 v[136:137], v[136:137], v[176:177], v[194:195] op_sel_hi:[1,0,1] neg_lo:[0,0,1] neg_hi:[0,0,1]
    v_pk_fma_f32 v[138:139], v[138:139], v[176:177], v[196:197] op_sel_hi:[1,0,1] neg_lo:[0,0,1] neg_hi:[0,0,1]
    v_pk_fma_f32 v[140:141], v[140:141], v[178:179], v[198:199] op_sel_hi:[1,0,1] neg_lo:[0,0,1] neg_hi:[0,0,1]
    v_pk_fma_f32 v[142:143], v[142:143], v[178:179], v[200:201] op_sel_hi:[1,0,1] neg_lo:[0,0,1] neg_hi:[0,0,1]
    v_cvt_pk_bf16_f32 v136, v136, v137
    v_cvt_pk_bf16_f32 v137, v138, v139
    v_cvt_pk_bf16_f32 v140, v140, v141
    v_cvt_pk_bf16_f32 v141, v142, v143
    v_pk_mul_f32 v[194:195], v[68:69], v[180:181] op_sel:[0,1] op_sel_hi:[1,1]
    v_pk_mul_f32 v[196:197], v[70:71], v[180:181] op_sel:[0,1] op_sel_hi:[1,1]
    v_pk_mul_f32 v[198:199], v[68:69], v[182:183] op_sel:[0,1] op_sel_hi:[1,1]
    v_pk_mul_f32 v[200:201], v[70:71], v[182:183] op_sel:[0,1] op_sel_hi:[1,1]
    v_pk_fma_f32 v[144:145], v[144:145], v[180:181], v[194:195] op_sel_hi:[1,0,1] neg_lo:[0,0,1] neg_hi:[0,0,1]
    v_pk_fma_f32 v[146:147], v[146:147], v[180:181], v[196:197] op_sel_hi:[1,0,1] neg_lo:[0,0,1] neg_hi:[0,0,1]
    v_pk_fma_f32 v[148:149], v[148:149], v[182:183], v[198:199] op_sel_hi:[1,0,1] neg_lo:[0,0,1] neg_hi:[0,0,1]
    v_pk_fma_f32 v[150:151], v[150:151], v[182:183], v[200:201] op_sel_hi:[1,0,1] neg_lo:[0,0,1] neg_hi:[0,0,1]
    v_cvt_pk_bf16_f32 v144, v144, v145
    v_cvt_pk_bf16_f32 v145, v146, v147
    v_cvt_pk_bf16_f32 v148, v148, v149
    v_cvt_pk_bf16_f32 v149, v150, v151
    v_pk_mul_f32 v[194:195], v[68:69], v[184:185] op_sel:[0,1] op_sel_hi:[1,1]
    v_pk_mul_f32 v[196:197], v[70:71], v[184:185] op_sel:[0,1] op_sel_hi:[1,1]
    v_pk_mul_f32 v[198:199], v[64:65], v[186:187] op_sel:[0,1] op_sel_hi:[1,1]
    v_pk_mul_f32 v[200:201], v[66:67], v[186:187] op_sel:[0,1] op_sel_hi:[1,1]
    v_pk_fma_f32 v[152:153], v[152:153], v[184:185], v[194:195] op_sel_hi:[1,0,1] neg_lo:[0,0,1] neg_hi:[0,0,1]
    v_pk_fma_f32 v[154:155], v[154:155], v[184:185], v[196:197] op_sel_hi:[1,0,1] neg_lo:[0,0,1] neg_hi:[0,0,1]
    v_pk_fma_f32 v[120:121], v[120:121], v[186:187], v[198:199] op_sel_hi:[1,0,1] neg_lo:[0,0,1] neg_hi:[0,0,1]
    v_pk_fma_f32 v[122:123], v[122:123], v[186:187], v[200:201] op_sel_hi:[1,0,1] neg_lo:[0,0,1] neg_hi:[0,0,1]
    v_cvt_pk_bf16_f32 v152, v152, v153
    v_cvt_pk_bf16_f32 v153, v154, v155
    v_cvt_pk_bf16_f32 v120, v120, v121
    v_cvt_pk_bf16_f32 v121, v122, v123
    v_pk_mul_f32 v[194:195], v[64:65], v[188:189] op_sel:[0,1] op_sel_hi:[1,1]
    v_pk_mul_f32 v[196:197], v[66:67], v[188:189] op_sel:[0,1] op_sel_hi:[1,1]
    v_pk_mul_f32 v[198:199], v[64:65], v[190:191] op_sel:[0,1] op_sel_hi:[1,1]
    v_pk_mul_f32 v[200:201], v[66:67], v[190:191] op_sel:[0,1] op_sel_hi:[1,1]
    v_pk_fma_f32 v[124:125], v[124:125], v[188:189], v[194:195] op_sel_hi:[1,0,1] neg_lo:[0,0,1] neg_hi:[0,0,1]
    v_pk_fma_f32 v[126:127], v[126:127], v[188:189], v[196:197] op_sel_hi:[1,0,1] neg_lo:[0,0,1] neg_hi:[0,0,1]
    v_pk_fma_f32 v[128:129], v[128:129], v[190:191], v[198:199] op_sel_hi:[1,0,1] neg_lo:[0,0,1] neg_hi:[0,0,1]
    v_pk_fma_f32 v[130:131], v[130:131], v[190:191], v[200:201] op_sel_hi:[1,0,1] neg_lo:[0,0,1] neg_hi:[0,0,1]
    v_cvt_pk_bf16_f32 v124, v124, v125
    v_cvt_pk_bf16_f32 v125, v126, v127
    v_cvt_pk_bf16_f32 v128, v128, v129
    v_cvt_pk_bf16_f32 v129, v130, v131
    v_pk_mul_f32 v[194:195], v[64:65], v[192:193] op_sel:[0,1] op_sel_hi:[1,1]
    v_pk_mul_f32 v[196:197], v[66:67], v[192:193] op_sel:[0,1] op_sel_hi:[1,1]
    v_pk_fma_f32 v[132:133], v[132:133], v[192:193], v[194:195] op_sel_hi:[1,0,1] neg_lo:[0,0,1] neg_hi:[0,0,1]
    v_pk_fma_f32 v[134:135], v[134:135], v[192:193], v[196:197] op_sel_hi:[1,0,1] neg_lo:[0,0,1] neg_hi:[0,0,1]
    v_cvt_pk_bf16_f32 v132, v132, v133
    v_cvt_pk_bf16_f32 v133, v134, v135
    v_mfma_f32_16x16x16_bf16 v[176:179], v[136:137], v[120:121], v[108:111]
    v_mfma_f32_16x16x16_bf16 v[180:183], v[140:141], v[120:121], v[112:115]
    v_mfma_f32_16x16x16_bf16 v[184:187], v[140:141], v[124:125], v[104:107]
    v_mfma_f32_16x16x16_bf16 v[188:191], v[144:145], v[124:125], v[112:115]
    v_mfma_f32_16x16x16_bf16 v[192:195], v[144:145], v[128:129], v[104:107]
    v_mfma_f32_16x16x16_bf16 v[196:199], v[148:149], v[128:129], v[112:115]
    v_mfma_f32_16x16x16_bf16 v[200:203], v[148:149], v[132:133], v[104:107]
    v_mfma_f32_16x16x16_bf16 v[204:207], v[152:153], v[132:133], v[112:115]
    s_waitcnt lgkmcnt(0)
    .p2align 3
    v_pk_mul_f32 v[228:229], v[228:229], v[72:73]
    v_pk_mul_f32 v[230:231], v[230:231], v[72:73]
    v_pk_mul_f32 v[232:233], v[232:233], v[72:73]
    v_pk_mul_f32 v[234:235], v[234:235], v[72:73]
    v_pk_mul_f32 v[236:237], v[236:237], v[72:73]
    v_pk_mul_f32 v[238:239], v[238:239], v[72:73]
    v_pk_mul_f32 v[240:241], v[240:241], v[72:73]
    v_pk_mul_f32 v[242:243], v[242:243], v[72:73]
    v_max3_f32 v136, v176, v177, v180
    v_max3_f32 v137, v178, v179, v182
    v_max3_f32 v138, v184, v185, v188
    v_max3_f32 v139, v186, v187, v190
    v_max3_f32 v140, v192, v193, v196
    v_max3_f32 v141, v194, v195, v198
    v_max3_f32 v142, v200, v201, v204
    v_max3_f32 v143, v202, v203, v206
    v_max_f32 v136, v136, v181
    v_max_f32 v137, v137, v183
    v_max_f32 v138, v138, v189
    v_max_f32 v139, v139, v191
    v_max_f32 v140, v140, v197
    v_max_f32 v141, v141, v199
    v_max_f32 v142, v142, v205
    v_max_f32 v143, v143, v207
    v_max_f32 v144, v136, v137
    v_max_f32 v145, v138, v139
    v_max_f32 v146, v140, v141
    v_max_f32 v147, v142, v143
    v_pk_mul_f32 v[244:245], v[244:245], v[72:73]
    v_pk_mul_f32 v[246:247], v[246:247], v[72:73]
    v_permlane32_swap_b32 v144, v145
    v_permlane32_swap_b32 v146, v147
    v_pk_fma_f32 v[156:157], v[156:157], v[208:209], v[228:229] neg_lo:[0,0,1] neg_hi:[0,0,1]
    v_max_f32 v144, v144, v145
    v_max_f32 v146, v146, v147
    v_pk_fma_f32 v[158:159], v[158:159], v[210:211], v[230:231] neg_lo:[0,0,1] neg_hi:[0,0,1]
    v_pk_fma_f32 v[160:161], v[160:161], v[212:213], v[232:233] neg_lo:[0,0,1] neg_hi:[0,0,1]
    v_permlane16_swap_b32 v144, v146
    v_pk_fma_f32 v[162:163], v[162:163], v[214:215], v[234:235] neg_lo:[0,0,1] neg_hi:[0,0,1]
    v_max_f32 v144, v144, v146
    v_pk_fma_f32 v[164:165], v[164:165], v[216:217], v[236:237] neg_lo:[0,0,1] neg_hi:[0,0,1]
    v_mov_b32 v146, v144
    v_pk_fma_f32 v[166:167], v[166:167], v[218:219], v[238:239] neg_lo:[0,0,1] neg_hi:[0,0,1]
    v_pk_fma_f32 v[168:169], v[168:169], v[220:221], v[240:241] neg_lo:[0,0,1] neg_hi:[0,0,1]
    v_permlane16_swap_b32 v144, v146
    v_pk_fma_f32 v[170:171], v[170:171], v[222:223], v[242:243] neg_lo:[0,0,1] neg_hi:[0,0,1]
    v_mov_b32 v145, v144
    v_mov_b32 v147, v146
    v_pk_fma_f32 v[172:173], v[172:173], v[224:225], v[244:245] neg_lo:[0,0,1] neg_hi:[0,0,1]
    v_pk_fma_f32 v[174:175], v[174:175], v[226:227], v[246:247] neg_lo:[0,0,1] neg_hi:[0,0,1]
    v_permlane32_swap_b32 v144, v145
    v_permlane32_swap_b32 v146, v147
    v_cvt_pk_bf16_f32 v208, v156, v157
    v_sub_f32 v136, v136, v144
    v_sub_f32 v137, v137, v144
    v_sub_f32 v138, v138, v145
    v_sub_f32 v139, v139, v145
    v_sub_f32 v140, v140, v146
    v_sub_f32 v141, v141, v146
    v_sub_f32 v142, v142, v147
    v_sub_f32 v143, v143, v147
    v_exp_f32 v136, v136
    v_exp_f32 v137, v137
    v_exp_f32 v138, v138
    v_exp_f32 v139, v139
    v_exp_f32 v140, v140
    v_exp_f32 v141, v141
    v_exp_f32 v142, v142
    v_exp_f32 v143, v143
    .p2align 3
    v_cvt_pk_bf16_f32 v209, v158, v159
    v_cvt_pk_bf16_f32 v210, v160, v161
    v_cvt_pk_bf16_f32 v211, v162, v163
    v_cvt_pk_bf16_f32 v212, v164, v165
    v_cvt_pk_bf16_f32 v213, v166, v167
    v_cvt_pk_bf16_f32 v214, v168, v169
    v_cvt_pk_bf16_f32 v215, v170, v171
    v_cvt_pk_bf16_f32 v216, v172, v173
    v_cvt_pk_bf16_f32 v217, v174, v175
    v_cvt_pk_bf16_f32 v136, v136, v136
    v_cvt_pk_bf16_f32 v137, v137, v137
    v_cvt_pk_bf16_f32 v138, v138, v138
    v_cvt_pk_bf16_f32 v139, v139, v139
    v_cvt_pk_bf16_f32 v140, v140, v140
    v_cvt_pk_bf16_f32 v141, v141, v141
    v_cvt_pk_bf16_f32 v142, v142, v142
    v_cvt_pk_bf16_f32 v143, v143, v143
    v_and_b32 v176, v116, v136
    v_and_b32 v177, v117, v137
    v_and_b32 v178, v118, v136
    v_and_b32 v179, v119, v137
    v_and_b32 v180, v116, v138
    v_and_b32 v181, v117, v139
    v_and_b32 v182, v118, v138
    v_and_b32 v183, v119, v139
    v_and_b32 v184, v116, v140
    v_and_b32 v185, v117, v141
    v_and_b32 v186, v118, v140
    v_and_b32 v187, v119, v141
    v_and_b32 v188, v116, v142
    v_and_b32 v189, v117, v143
    v_and_b32 v190, v118, v142
    v_and_b32 v191, v119, v143
    s_lshl_b32 s56, s45, 13
    s_add_u32 s56, s56, s47
    v_mfma_f32_16x16x32_bf16 v[156:159], v[100:103], v[176:179], 0
    v_mfma_f32_16x16x32_bf16 v[160:163], v[100:103], v[180:183], 0
    v_mfma_f32_16x16x32_bf16 v[164:167], v[100:103], v[184:187], 0
    v_mfma_f32_16x16x32_bf16 v[168:171], v[100:103], v[188:191], 0
    v_mfma_f32_16x16x32_bf16 v[120:123], v[208:211], v[176:179], 0
    v_mfma_f32_16x16x32_bf16 v[124:127], v[210:213], v[180:183], 0
    v_mfma_f32_16x16x32_bf16 v[128:131], v[212:215], v[184:187], 0
    v_mfma_f32_16x16x32_bf16 v[132:135], v[214:217], v[188:191], 0
    s_add_u32 s56, s56, 0x20000
    s_add_u32 s52, s56, 4096
    s_barrier
    v_mov_b32 v5, 0x27d00
    ds_read_b32 v5, v5
    s_waitcnt lgkmcnt(0)
    v_readfirstlane_b32 s48, v5
    v_rcp_f32 v156, v156
    v_rcp_f32 v160, v160
    v_rcp_f32 v164, v164
    v_rcp_f32 v168, v168
    s_nop 1
    .p2align 3
    v_pk_mul_f32 v[120:121], v[120:121], v[156:157] op_sel_hi:[1,0]
    v_pk_mul_f32 v[122:123], v[122:123], v[156:157] op_sel_hi:[1,0]
    v_pk_mul_f32 v[124:125], v[124:125], v[160:161] op_sel_hi:[1,0]
    v_pk_mul_f32 v[126:127], v[126:127], v[160:161] op_sel_hi:[1,0]
    v_pk_mul_f32 v[128:129], v[128:129], v[164:165] op_sel_hi:[1,0]
    v_pk_mul_f32 v[130:131], v[130:131], v[164:165] op_sel_hi:[1,0]
    v_pk_mul_f32 v[132:133], v[132:133], v[168:169] op_sel_hi:[1,0]
    v_pk_mul_f32 v[134:135], v[134:135], v[168:169] op_sel_hi:[1,0]
    v_cvt_pk_bf16_f32 v192, v120, v121
    v_cvt_pk_bf16_f32 v193, v122, v123
    v_cvt_pk_bf16_f32 v194, v124, v125
    v_cvt_pk_bf16_f32 v195, v126, v127
    v_cvt_pk_bf16_f32 v196, v128, v129
    v_cvt_pk_bf16_f32 v197, v130, v131
    v_cvt_pk_bf16_f32 v198, v132, v133
    v_cvt_pk_bf16_f32 v199, v134, v135
    v_permlane16_swap_b32 v192, v194
    v_permlane16_swap_b32 v193, v195
    v_permlane16_swap_b32 v196, v198
    v_permlane16_swap_b32 v197, v199
    s_cmp_eq_u32 s48, 1
    s_cbranch_scc1 L_sl_1
    buffer_store_dwordx4 v[192:195], v14, s[8:11], s56 offen
    buffer_store_dwordx4 v[196:199], v14, s[8:11], s52 offen
L_sb_2:
    v_mov_b32 v4, 1
    s_waitcnt vmcnt(0)
    s_cmp_eq_u32 s48, 1
    s_cbranch_scc1 L_sl_3
    s_mov_b64 exec, 1
    buffer_store_dword v4, v16, s[8:11], s47 offen
    s_mov_b64 exec, -1
L_sb_4:
    v_and_b32 v5, 15, v0
    v_bfe_u32 v6, v0, 4, 1
    v_lshrrev_b32 v7, 5, v0
    v_lshl_add_u32 v6, v6, 1, v7
    v_lshl_add_u32 v5, v5, 2, v6
    v_lshlrev_b32 v5, 2, v5
    s_waitcnt vmcnt(2)
    ds_bpermute_b32 v208, v5, v56
    ds_bpermute_b32 v209, v5, v57
    ds_bpermute_b32 v210, v5, v58
    ds_bpermute_b32 v211, v5, v59
    ds_bpermute_b32 v212, v5, v60
    ds_bpermute_b32 v213, v5, v61
    ds_bpermute_b32 v214, v5, v62
    ds_bpermute_b32 v215, v5, v63
    s_waitcnt lgkmcnt(0)
    v_permlane16_swap_b32 v208, v212
    v_permlane16_swap_b32 v209, v213
    v_permlane16_swap_b32 v210, v214
    v_permlane16_swap_b32 v211, v215
    s_nop 0
    v_permlane32_swap_b32 v208, v210
    v_permlane32_swap_b32 v209, v211
    v_permlane32_swap_b32 v212, v214
    v_permlane32_swap_b32 v213, v215
    v_lshlrev_b32 v48, 16, v208
    v_and_b32 v49, 0xffff0000, v208
    v_lshlrev_b32 v50, 16, v209
    v_and_b32 v51, 0xffff0000, v209
    v_lshlrev_b32 v52, 16, v210
    v_and_b32 v53, 0xffff0000, v210
    v_lshlrev_b32 v54, 16, v211
    v_and_b32 v55, 0xffff0000, v211
    v_lshlrev_b32 v56, 16, v212
    v_and_b32 v57, 0xffff0000, v212
    v_lshlrev_b32 v58, 16, v213
    v_and_b32 v59, 0xffff0000, v213
    v_lshlrev_b32 v60, 16, v214
    v_and_b32 v61, 0xffff0000, v214
    v_lshlrev_b32 v62, 16, v215
    v_and_b32 v63, 0xffff0000, v215
    v_mov_b32 v24, v13
    v_add_u32 v25, 0xd000, v24
    v_add_u32 v26, 0x1a000, v24
    v_xor_b32 v27, 64, v13
    v_add_u32 v28, 0xd000, v27
    v_add_u32 v29, 0x1a000, v27
    s_barrier
    ds_read_b64_tr_b16 v[216:217], v26 offset:28672
    ds_read_b64_tr_b16 v[218:219], v26 offset:30720
    ds_read_b64_tr_b16 v[220:221], v29 offset:28672
    ds_read_b64_tr_b16 v[222:223], v29 offset:30720
    ds_read_b64_tr_b16 v[224:225], v26 offset:29696
    ds_read_b64_tr_b16 v[226:227], v26 offset:31744
    ds_read_b64_tr_b16 v[228:229], v29 offset:29696
    ds_read_b64_tr_b16 v[230:231], v29 offset:31744
    s_mov_b32 s52, 0x3fb8aa3b
    v_lshlrev_b32 v76, 16, v40
    v_and_b32 v77, 0xffff0000, v40
    v_lshlrev_b32 v78, 16, v41
    v_and_b32 v79, 0xffff0000, v41
    v_lshlrev_b32 v80, 16, v42
    v_and_b32 v81, 0xffff0000, v42
    v_lshlrev_b32 v82, 16, v43
    v_and_b32 v83, 0xffff0000, v43
    v_lshlrev_b32 v84, 16, v44
    v_and_b32 v85, 0xffff0000, v44
    v_lshlrev_b32 v86, 16, v45
    v_and_b32 v87, 0xffff0000, v45
    v_mul_f32 v76, s52, v76
    v_mul_f32 v77, s52, v77
    v_mul_f32 v78, s52, v78
    v_mul_f32 v79, s52, v79
    v_mul_f32 v80, s52, v80
    v_mul_f32 v81, s52, v81
    v_mul_f32 v82, s52, v82
    v_mul_f32 v83, s52, v83
    v_mul_f32 v84, s52, v84
    v_mul_f32 v85, s52, v85
    v_mul_f32 v86, s52, v86
    v_mul_f32 v87, s52, v87
    s_mov_b32 exec_hi, 0
    buffer_load_dword v10, v22, s[8:11], 0 offen sc1
L_poll_5:
    buffer_load_dword v11, v22, s[8:11], 0 offen sc1
    s_waitcnt vmcnt(1)
    v_cmp_gt_u32 vcc, 1, v10
    s_cbranch_vccz L_polld_6
    buffer_load_dword v10, v22, s[8:11], 0 offen sc1
    s_waitcnt vmcnt(1)
    v_cmp_gt_u32 vcc, 1, v11
    s_cbranch_vccz L_polld_6
    s_add_u32 s58, s58, 1
    s_cmp_lt_u32 s58, 0x493e0
    s_cbranch_scc1 L_poll_5
L_polld_6:
    s_mov_b32 exec_hi, -1
    s_add_u32 s57, s47, 0x20000
    buffer_load_dwordx4 v[120:123], v23, s[8:11], s57 offen offset:0 sc1
    buffer_load_dwordx4 v[124:127], v23, s[8:11], s57 offen offset:512 sc1
    s_add_u32 s57, s47, 0x22000
    buffer_load_dwordx4 v[128:131], v23, s[8:11], s57 offen offset:0 sc1
    buffer_load_dwordx4 v[132:135], v23, s[8:11], s57 offen offset:512 sc1
    s_add_u32 s57, s47, 0x24000
    buffer_load_dwordx4 v[136:139], v23, s[8:11], s57 offen offset:0 sc1
    buffer_load_dwordx4 v[140:143], v23, s[8:11], s57 offen offset:512 sc1
    s_add_u32 s57, s47, 0x26000
    buffer_load_dwordx4 v[144:147], v23, s[8:11], s57 offen offset:0 sc1
    buffer_load_dwordx4 v[148:151], v23, s[8:11], s57 offen offset:512 sc1
    s_waitcnt vmcnt(6)
    s_waitcnt lgkmcnt(4)
    v_mfma_f32_32x32x16_bf16 v[48:63], v[216:219], v[120:123], v[48:63]
    s_add_u32 s57, s47, 0x28000
    buffer_load_dwordx4 v[152:155], v23, s[8:11], s57 offen offset:0 sc1
    ds_read_b64_tr_b16 v[232:233], v26 offset:36864
    ds_read_b64_tr_b16 v[234:235], v26 offset:38912
    v_mfma_f32_32x32x16_bf16 v[200:215], v[220:223], v[120:123], 0
    ds_read_b64_tr_b16 v[236:237], v29 offset:36864
    ds_read_b64_tr_b16 v[238:239], v29 offset:38912
    buffer_load_dwordx4 v[156:159], v23, s[8:11], s57 offen offset:512 sc1
    s_waitcnt lgkmcnt(4)
    v_mfma_f32_32x32x16_bf16 v[48:63], v[224:227], v[124:127], v[48:63]
    ds_read_b64_tr_b16 v[240:241], v26 offset:37888
    ds_read_b64_tr_b16 v[242:243], v26 offset:39936
    v_mfma_f32_32x32x16_bf16 v[200:215], v[228:231], v[124:127], v[200:215]
    ds_read_b64_tr_b16 v[244:245], v29 offset:37888
    ds_read_b64_tr_b16 v[246:247], v29 offset:39936
    s_waitcnt vmcnt(6)
    s_waitcnt lgkmcnt(4)
    v_mfma_f32_32x32x16_bf16 v[48:63], v[232:235], v[128:131], v[48:63]
    s_add_u32 s57, s47, 0x2a000
    buffer_load_dwordx4 v[120:123], v23, s[8:11], s57 offen offset:0 sc1
    buffer_load_dwordx4 v[124:127], v23, s[8:11], s57 offen offset:512 sc1
    v_mfma_f32_32x32x16_bf16 v[200:215], v[236:239], v[128:131], v[200:215]
    s_waitcnt lgkmcnt(0)
    s_barrier
    ds_read_b64_tr_b16 v[216:217], v26 offset:45056
    ds_read_b64_tr_b16 v[218:219], v26 offset:47104
    v_mfma_f32_32x32x16_bf16 v[48:63], v[240:243], v[132:135], v[48:63]
    ds_read_b64_tr_b16 v[220:221], v29 offset:45056
    ds_read_b64_tr_b16 v[222:223], v29 offset:47104
    ds_read_b64_tr_b16 v[224:225], v26 offset:46080
    v_mfma_f32_32x32x16_bf16 v[200:215], v[244:247], v[132:135], v[200:215]
    ds_read_b64_tr_b16 v[226:227], v26 offset:48128
    ds_read_b64_tr_b16 v[228:229], v29 offset:46080
    ds_read_b64_tr_b16 v[230:231], v29 offset:48128
    s_waitcnt vmcnt(6)
    s_waitcnt lgkmcnt(4)
    v_mfma_f32_32x32x16_bf16 v[48:63], v[216:219], v[136:139], v[48:63]
    s_add_u32 s57, s47, 0x2c000
    buffer_load_dwordx4 v[128:131], v23, s[8:11], s57 offen offset:0 sc1
    ds_read_b64_tr_b16 v[232:233], v24 offset:0
    ds_read_b64_tr_b16 v[234:235], v24 offset:2048
    v_mfma_f32_32x32x16_bf16 v[200:215], v[220:223], v[136:139], v[200:215]
    ds_read_b64_tr_b16 v[236:237], v27 offset:0
    ds_read_b64_tr_b16 v[238:239], v27 offset:2048
    buffer_load_dwordx4 v[132:135], v23, s[8:11], s57 offen offset:512 sc1
    s_waitcnt lgkmcnt(4)
    v_mfma_f32_32x32x16_bf16 v[48:63], v[224:227], v[140:143], v[48:63]
    ds_read_b64_tr_b16 v[240:241], v24 offset:1024
    ds_read_b64_tr_b16 v[242:243], v24 offset:3072
    v_mfma_f32_32x32x16_bf16 v[200:215], v[228:231], v[140:143], v[200:215]
    ds_read_b64_tr_b16 v[244:245], v27 offset:1024
    ds_read_b64_tr_b16 v[246:247], v27 offset:3072
    s_waitcnt vmcnt(6)
    s_waitcnt lgkmcnt(4)
    v_mfma_f32_32x32x16_bf16 v[48:63], v[232:235], v[144:147], v[48:63]
    s_add_u32 s57, s47, 0x2e000
    buffer_load_dwordx4 v[136:139], v23, s[8:11], s57 offen offset:0 sc1
    buffer_load_dwordx4 v[140:143], v23, s[8:11], s57 offen offset:512 sc1
    v_mfma_f32_32x32x16_bf16 v[200:215], v[236:239], v[144:147], v[200:215]
    s_waitcnt lgkmcnt(0)
    s_barrier
    ds_read_b64_tr_b16 v[216:217], v24 offset:8192
    ds_read_b64_tr_b16 v[218:219], v24 offset:10240
    v_mfma_f32_32x32x16_bf16 v[48:63], v[240:243], v[148:151], v[48:63]
    ds_read_b64_tr_b16 v[220:221], v27 offset:8192
    ds_read_b64_tr_b16 v[222:223], v27 offset:10240
    ds_read_b64_tr_b16 v[224:225], v24 offset:9216
    v_mfma_f32_32x32x16_bf16 v[200:215], v[244:247], v[148:151], v[200:215]
    ds_read_b64_tr_b16 v[226:227], v24 offset:11264
    ds_read_b64_tr_b16 v[228:229], v27 offset:9216
    ds_read_b64_tr_b16 v[230:231], v27 offset:11264
    s_waitcnt vmcnt(6)
    s_waitcnt lgkmcnt(4)
    v_mfma_f32_32x32x16_bf16 v[48:63], v[216:219], v[152:155], v[48:63]
    ds_read_b64_tr_b16 v[232:233], v24 offset:16384
    ds_read_b64_tr_b16 v[234:235], v24 offset:18432
    v_mfma_f32_32x32x16_bf16 v[200:215], v[220:223], v[152:155], v[200:215]
    ds_read_b64_tr_b16 v[236:237], v27 offset:16384
    ds_read_b64_tr_b16 v[238:239], v27 offset:18432
    s_waitcnt lgkmcnt(4)
    v_mfma_f32_32x32x16_bf16 v[48:63], v[224:227], v[156:159], v[48:63]
    ds_read_b64_tr_b16 v[240:241], v24 offset:17408
    ds_read_b64_tr_b16 v[242:243], v24 offset:19456
    v_mfma_f32_32x32x16_bf16 v[200:215], v[228:231], v[156:159], v[200:215]
    ds_read_b64_tr_b16 v[244:245], v27 offset:17408
    ds_read_b64_tr_b16 v[246:247], v27 offset:19456
    s_waitcnt vmcnt(4)
    s_waitcnt lgkmcnt(4)
    v_mfma_f32_32x32x16_bf16 v[48:63], v[232:235], v[120:123], v[48:63]
    v_mfma_f32_32x32x16_bf16 v[200:215], v[236:239], v[120:123], v[200:215]
    s_waitcnt lgkmcnt(0)
    s_barrier
    ds_read_b64_tr_b16 v[216:217], v24 offset:24576
    ds_read_b64_tr_b16 v[218:219], v24 offset:26624
    v_mfma_f32_32x32x16_bf16 v[48:63], v[240:243], v[124:127], v[48:63]
    ds_read_b64_tr_b16 v[220:221], v27 offset:24576
    ds_read_b64_tr_b16 v[222:223], v27 offset:26624
    ds_read_b64_tr_b16 v[224:225], v24 offset:25600
    v_mfma_f32_32x32x16_bf16 v[200:215], v[244:247], v[124:127], v[200:215]
    ds_read_b64_tr_b16 v[226:227], v24 offset:27648
    ds_read_b64_tr_b16 v[228:229], v27 offset:25600
    ds_read_b64_tr_b16 v[230:231], v27 offset:27648
    s_waitcnt vmcnt(2)
    s_waitcnt lgkmcnt(4)
    v_mfma_f32_32x32x16_bf16 v[48:63], v[216:219], v[128:131], v[48:63]
    ds_read_b64_tr_b16 v[236:237], v27 offset:32768
    ds_read_b64_tr_b16 v[238:239], v27 offset:34816
    v_mfma_f32_32x32x16_bf16 v[200:215], v[220:223], v[128:131], v[200:215]
    ds_read_b64_tr_b16 v[244:245], v27 offset:33792
    ds_read_b64_tr_b16 v[246:247], v27 offset:35840
    s_waitcnt lgkmcnt(4)
    v_mfma_f32_32x32x16_bf16 v[48:63], v[224:227], v[132:135], v[48:63]
    ds_read_b64_tr_b16 v[232:233], v24 offset:32768
    ds_read_b64_tr_b16 v[234:235], v24 offset:34816
    v_mfma_f32_32x32x16_bf16 v[200:215], v[228:231], v[132:135], v[200:215]
    ds_read_b64_tr_b16 v[240:241], v24 offset:33792
    ds_read_b64_tr_b16 v[242:243], v24 offset:35840
    s_waitcnt vmcnt(0)
    s_waitcnt lgkmcnt(4)
    v_mfma_f32_32x32x16_bf16 v[200:215], v[236:239], v[136:139], v[200:215]
    v_mfma_f32_32x32x16_bf16 v[200:215], v[244:247], v[140:143], v[200:215]
    s_cmp_lt_u32 s46, 2
    s_mov_b32 s53, 0x18000
    s_cselect_b32 s53, 0x10000, s53
    s_lshl_b32 s52, s51, 12
    v_lshlrev_b32 v9, 4, v0
    v_add_u32 v9, s53, v9
    s_waitcnt lgkmcnt(0)
    v_mfma_f32_32x32x16_bf16 v[48:63], v[232:235], v[136:139], v[48:63]
    v_add_u32 v8, s52, v9
    s_xor_b32 s52, s52, 0x1000
    v_add_u32 v9, s52, v9
    v_mfma_f32_32x32x16_bf16 v[48:63], v[240:243], v[140:143], v[48:63]
    s_nop 0
    ds_write_b128 v8, v[200:203] offset:0
    ds_write_b128 v8, v[204:207] offset:1024
    ds_write_b128 v8, v[208:211] offset:2048
    ds_write_b128 v8, v[212:215] offset:3072
    s_waitcnt lgkmcnt(0)
    s_barrier
    ds_read_b128 v[200:203], v9 offset:0
    ds_read_b128 v[204:207], v9 offset:1024
    ds_read_b128 v[208:211], v9 offset:2048
    ds_read_b128 v[212:215], v9 offset:3072
    s_lshl_b32 s56, s45, 13
    s_add_u32 s56, s56, s47
    s_add_u32 s56, s56, 0x10000
    s_add_u32 s53, s47, 0x1000
    s_waitcnt lgkmcnt(3)
    v_pk_add_f32 v[48:49], v[48:49], v[200:201]
    v_pk_add_f32 v[50:51], v[50:51], v[202:203]
    s_waitcnt lgkmcnt(2)
    v_pk_add_f32 v[52:53], v[52:53], v[204:205]
    v_pk_add_f32 v[54:55], v[54:55], v[206:207]
    s_waitcnt lgkmcnt(1)
    v_pk_add_f32 v[56:57], v[56:57], v[208:209]
    v_pk_add_f32 v[58:59], v[58:59], v[210:211]
    s_waitcnt lgkmcnt(0)
    .p2align 3
    v_pk_add_f32 v[60:61], v[60:61], v[212:213]
    v_pk_add_f32 v[62:63], v[62:63], v[214:215]
    v_cvt_pk_bf16_f32 v184, v48, v49
    v_cvt_pk_bf16_f32 v185, v50, v51
    v_cvt_pk_bf16_f32 v186, v52, v53
    v_cvt_pk_bf16_f32 v187, v54, v55
    v_cvt_pk_bf16_f32 v188, v56, v57
    v_cvt_pk_bf16_f32 v189, v58, v59
    v_cvt_pk_bf16_f32 v190, v60, v61
    v_cvt_pk_bf16_f32 v191, v62, v63
    v_permlane32_swap_b32 v184, v186
    v_permlane32_swap_b32 v185, v187
    v_permlane32_swap_b32 v188, v190
    v_permlane32_swap_b32 v189, v191
    s_cmp_eq_u32 s48, 1
    s_cbranch_scc1 L_sl_7
    buffer_store_dwordx4 v[184:187], v23, s[8:11], s56 offen offset:0
    buffer_store_dwordx4 v[188:191], v23, s[8:11], s56 offen offset:512
L_sb_8:
    .p2align 3
    v_pk_add_f32 v[192:193], v[48:49], v[50:51]
    v_pk_mul_f32 v[194:195], v[48:49], v[48:49]
    v_pk_add_f32 v[196:197], v[56:57], v[58:59]
    v_pk_mul_f32 v[198:199], v[56:57], v[56:57]
    v_pk_fma_f32 v[194:195], v[50:51], v[50:51], v[194:195]
    v_pk_fma_f32 v[198:199], v[58:59], v[58:59], v[198:199]
    v_pk_add_f32 v[192:193], v[192:193], v[52:53]
    v_pk_fma_f32 v[194:195], v[52:53], v[52:53], v[194:195]
    v_pk_add_f32 v[196:197], v[196:197], v[60:61]
    v_pk_fma_f32 v[198:199], v[60:61], v[60:61], v[198:199]
    v_pk_add_f32 v[192:193], v[192:193], v[54:55]
    v_pk_fma_f32 v[194:195], v[54:55], v[54:55], v[194:195]
    v_pk_add_f32 v[196:197], v[196:197], v[62:63]
    v_pk_fma_f32 v[198:199], v[62:63], v[62:63], v[198:199]
    v_pk_add_f32 v[192:193], v[192:193], v[196:197]
    v_pk_add_f32 v[194:195], v[194:195], v[198:199]
    v_add_f32 v192, v192, v193
    v_add_f32 v194, v194, v195
    s_nop 1
    v_permlane32_swap_b32 v192, v194
    v_add_f32 v192, v192, v194
    s_cmp_eq_u32 s48, 1
    s_cbranch_scc1 L_sl_9
    buffer_store_dword v192, v19, s[8:11], s53 offen
L_sb_10:
    s_barrier
    v_mov_b32 v24, v12
    v_add_u32 v25, 0xd000, v24
    v_add_u32 v26, 0x1a000, v24
    v_lshlrev_b32 v27, 4, v0
    v_add_u32 v28, 0xd000, v27
    v_add_u32 v29, 0x1a000, v27
    v_mov_b32 v4, 3
    s_waitcnt vmcnt(0)
    s_cmp_eq_u32 s48, 1
    s_cbranch_scc1 L_sl_11
    s_mov_b64 exec, 1
    buffer_store_dword v4, v16, s[8:11], s47 offen
    s_mov_b64 exec, -1
L_sb_12:
    s_barrier
    ds_read_b64_tr_b16 v[176:177], v24 offset:40960
    ds_read_b64_tr_b16 v[178:179], v24 offset:43008
    ds_read_b64_tr_b16 v[180:181], v24 offset:45056
    ds_read_b64_tr_b16 v[182:183], v24 offset:47104
    ds_read_b64_tr_b16 v[184:185], v24 offset:49152
    ds_read_b64_tr_b16 v[186:187], v24 offset:51200
    ds_read_b64_tr_b16 v[188:189], v25 offset:0
    ds_read_b64_tr_b16 v[190:191], v25 offset:2048
    ds_read_b64_tr_b16 v[192:193], v25 offset:4096
    ds_read_b64_tr_b16 v[194:195], v25 offset:6144
    ds_read_b64_tr_b16 v[196:197], v25 offset:8192
    ds_read_b64_tr_b16 v[198:199], v25 offset:10240
    s_waitcnt lgkmcnt(6)
    v_mfma_f32_16x16x32_bf16 v[88:91], v[176:179], v[100:103], 0
    v_mfma_f32_16x16x32_bf16 v[92:95], v[180:183], v[100:103], 0
    v_mfma_f32_16x16x32_bf16 v[96:99], v[184:187], v[100:103], 0
    ds_read_b64_tr_b16 v[200:201], v25 offset:20480
    ds_read_b64_tr_b16 v[202:203], v25 offset:22528
    ds_read_b64_tr_b16 v[204:205], v25 offset:24576
    ds_read_b64_tr_b16 v[206:207], v25 offset:26624
    ds_read_b64_tr_b16 v[208:209], v25 offset:28672
    ds_read_b64_tr_b16 v[210:211], v25 offset:30720
    s_waitcnt lgkmcnt(6)
    v_mfma_f32_16x16x32_bf16 v[88:91], v[188:191], v[100:103], v[88:91]
    v_mfma_f32_16x16x32_bf16 v[92:95], v[192:195], v[100:103], v[92:95]
    v_mfma_f32_16x16x32_bf16 v[96:99], v[196:199], v[100:103], v[96:99]
    ds_read_b64_tr_b16 v[176:177], v25 offset:32768
    ds_read_b64_tr_b16 v[178:179], v25 offset:34816
    ds_read_b64_tr_b16 v[180:181], v25 offset:36864
    ds_read_b64_tr_b16 v[182:183], v25 offset:38912
    ds_read_b64_tr_b16 v[184:185], v25 offset:40960
    ds_read_b64_tr_b16 v[186:187], v25 offset:43008
    s_waitcnt lgkmcnt(6)
    v_mfma_f32_16x16x32_bf16 v[88:91], v[200:203], v[100:103], v[88:91]
    v_mfma_f32_16x16x32_bf16 v[92:95], v[204:207], v[100:103], v[92:95]
    v_mfma_f32_16x16x32_bf16 v[96:99], v[208:211], v[100:103], v[96:99]
    ds_read_b64_tr_b16 v[188:189], v26 offset:0
    ds_read_b64_tr_b16 v[190:191], v26 offset:2048
    ds_read_b64_tr_b16 v[192:193], v26 offset:4096
    ds_read_b64_tr_b16 v[194:195], v26 offset:6144
    ds_read_b64_tr_b16 v[196:197], v26 offset:8192
    ds_read_b64_tr_b16 v[198:199], v26 offset:10240
    s_waitcnt lgkmcnt(6)
    v_mfma_f32_16x16x32_bf16 v[88:91], v[176:179], v[100:103], v[88:91]
    v_mfma_f32_16x16x32_bf16 v[92:95], v[180:183], v[100:103], v[92:95]
    v_mfma_f32_16x16x32_bf16 v[96:99], v[184:187], v[100:103], v[96:99]
    ds_read_b64_tr_b16 v[200:201], v26 offset:12288
    ds_read_b64_tr_b16 v[202:203], v26 offset:14336
    ds_read_b64_tr_b16 v[204:205], v26 offset:16384
    ds_read_b64_tr_b16 v[206:207], v26 offset:18432
    ds_read_b64_tr_b16 v[208:209], v26 offset:20480
    ds_read_b64_tr_b16 v[210:211], v26 offset:22528
    s_waitcnt lgkmcnt(6)
    v_mfma_f32_16x16x32_bf16 v[88:91], v[188:191], v[100:103], v[88:91]
    v_mfma_f32_16x16x32_bf16 v[92:95], v[192:195], v[100:103], v[92:95]
    v_mfma_f32_16x16x32_bf16 v[96:99], v[196:199], v[100:103], v[96:99]
    s_waitcnt lgkmcnt(0)
    v_mfma_f32_16x16x32_bf16 v[88:91], v[200:203], v[100:103], v[88:91]
    v_mfma_f32_16x16x32_bf16 v[92:95], v[204:207], v[100:103], v[92:95]
    v_mfma_f32_16x16x32_bf16 v[96:99], v[208:211], v[100:103], v[96:99]
    s_barrier
    ds_read_b128 v[188:191], v28 offset:12288
    ds_read_b64_tr_b16 v[176:177], v24 offset:40960
    ds_read_b64_tr_b16 v[178:179], v24 offset:43008
    ds_read_b64_tr_b16 v[180:181], v24 offset:45056
    ds_read_b64_tr_b16 v[182:183], v24 offset:47104
    ds_read_b64_tr_b16 v[184:185], v24 offset:49152
    ds_read_b64_tr_b16 v[186:187], v24 offset:51200
    ds_read_b128 v[192:195], v28 offset:14336
    ds_read_b128 v[196:199], v28 offset:16384
    ds_read_b128 v[200:203], v28 offset:18432
    s_waitcnt lgkmcnt(3)
    v_mfma_f32_16x16x32_bf16 v[120:123], v[176:179], v[188:191], 0
    ds_read_b128 v[224:227], v28 offset:13312
    v_mfma_f32_16x16x32_bf16 v[136:139], v[180:183], v[188:191], 0
    ds_read_b64_tr_b16 v[212:213], v25 offset:0
    v_mfma_f32_16x16x32_bf16 v[152:155], v[184:187], v[188:191], 0
    ds_read_b64_tr_b16 v[214:215], v25 offset:2048
    s_waitcnt lgkmcnt(4)
    v_mfma_f32_16x16x32_bf16 v[124:127], v[176:179], v[192:195], 0
    ds_read_b64_tr_b16 v[216:217], v25 offset:4096
    v_mfma_f32_16x16x32_bf16 v[140:143], v[180:183], v[192:195], 0
    ds_read_b64_tr_b16 v[218:219], v25 offset:6144
    v_mfma_f32_16x16x32_bf16 v[156:159], v[184:187], v[192:195], 0
    ds_read_b64_tr_b16 v[220:221], v25 offset:8192
    v_mfma_f32_16x16x32_bf16 v[128:131], v[176:179], v[196:199], 0
    ds_read_b64_tr_b16 v[222:223], v25 offset:10240
    v_mfma_f32_16x16x32_bf16 v[144:147], v[180:183], v[196:199], 0
    ds_read_b128 v[228:231], v28 offset:15360
    v_mfma_f32_16x16x32_bf16 v[160:163], v[184:187], v[196:199], 0
    ds_read_b128 v[232:235], v28 offset:17408
    s_waitcnt lgkmcnt(9)
    v_mfma_f32_16x16x32_bf16 v[132:135], v[176:179], v[200:203], 0
    ds_read_b128 v[236:239], v28 offset:19456
    v_mfma_f32_16x16x32_bf16 v[148:151], v[180:183], v[200:203], 0
    v_mfma_f32_16x16x32_bf16 v[164:167], v[184:187], v[200:203], 0
    s_waitcnt lgkmcnt(3)
    v_mfma_f32_16x16x32_bf16 v[120:123], v[212:215], v[224:227], v[120:123]
    v_mfma_f32_16x16x32_bf16 v[136:139], v[216:219], v[224:227], v[136:139]
    v_mfma_f32_16x16x32_bf16 v[152:155], v[220:223], v[224:227], v[152:155]
    s_waitcnt lgkmcnt(0)
    s_barrier
    ds_read_b128 v[188:191], v28 offset:45056
    v_mfma_f32_16x16x32_bf16 v[124:127], v[212:215], v[228:231], v[124:127]
    ds_read_b64_tr_b16 v[176:177], v25 offset:20480
    v_mfma_f32_16x16x32_bf16 v[140:143], v[216:219], v[228:231], v[140:143]
    ds_read_b64_tr_b16 v[178:179], v25 offset:22528
    v_mfma_f32_16x16x32_bf16 v[156:159], v[220:223], v[228:231], v[156:159]
    ds_read_b64_tr_b16 v[180:181], v25 offset:24576
    v_mfma_f32_16x16x32_bf16 v[128:131], v[212:215], v[232:235], v[128:131]
    ds_read_b64_tr_b16 v[182:183], v25 offset:26624
    v_mfma_f32_16x16x32_bf16 v[144:147], v[216:219], v[232:235], v[144:147]
    ds_read_b64_tr_b16 v[184:185], v25 offset:28672
    v_mfma_f32_16x16x32_bf16 v[160:163], v[220:223], v[232:235], v[160:163]
    ds_read_b64_tr_b16 v[186:187], v25 offset:30720
    v_mfma_f32_16x16x32_bf16 v[132:135], v[212:215], v[236:239], v[132:135]
    ds_read_b128 v[192:195], v28 offset:47104
    v_mfma_f32_16x16x32_bf16 v[148:151], v[216:219], v[236:239], v[148:151]
    ds_read_b128 v[196:199], v28 offset:49152
    v_mfma_f32_16x16x32_bf16 v[164:167], v[220:223], v[236:239], v[164:167]
    ds_read_b128 v[200:203], v28 offset:51200
    s_waitcnt lgkmcnt(3)
    v_mfma_f32_16x16x32_bf16 v[120:123], v[176:179], v[188:191], v[120:123]
    ds_read_b128 v[224:227], v28 offset:46080
    v_mfma_f32_16x16x32_bf16 v[136:139], v[180:183], v[188:191], v[136:139]
    ds_read_b64_tr_b16 v[212:213], v25 offset:32768
    v_mfma_f32_16x16x32_bf16 v[152:155], v[184:187], v[188:191], v[152:155]
    ds_read_b64_tr_b16 v[214:215], v25 offset:34816
    s_waitcnt lgkmcnt(4)
    v_mfma_f32_16x16x32_bf16 v[124:127], v[176:179], v[192:195], v[124:127]
    ds_read_b64_tr_b16 v[216:217], v25 offset:36864
    v_mfma_f32_16x16x32_bf16 v[140:143], v[180:183], v[192:195], v[140:143]
    ds_read_b64_tr_b16 v[218:219], v25 offset:38912
    v_mfma_f32_16x16x32_bf16 v[156:159], v[184:187], v[192:195], v[156:159]
    ds_read_b64_tr_b16 v[220:221], v25 offset:40960
    v_mfma_f32_16x16x32_bf16 v[128:131], v[176:179], v[196:199], v[128:131]
    ds_read_b64_tr_b16 v[222:223], v25 offset:43008
    v_mfma_f32_16x16x32_bf16 v[144:147], v[180:183], v[196:199], v[144:147]
    ds_read_b128 v[228:231], v28 offset:48128
    v_mfma_f32_16x16x32_bf16 v[160:163], v[184:187], v[196:199], v[160:163]
    ds_read_b128 v[232:235], v28 offset:50176
    s_waitcnt lgkmcnt(9)
    v_mfma_f32_16x16x32_bf16 v[132:135], v[176:179], v[200:203], v[132:135]
    ds_read_b128 v[236:239], v28 offset:52224
    v_mfma_f32_16x16x32_bf16 v[148:151], v[180:183], v[200:203], v[148:151]
    v_mfma_f32_16x16x32_bf16 v[164:167], v[184:187], v[200:203], v[164:167]
    s_waitcnt lgkmcnt(3)
    v_mfma_f32_16x16x32_bf16 v[120:123], v[212:215], v[224:227], v[120:123]
    v_mfma_f32_16x16x32_bf16 v[136:139], v[216:219], v[224:227], v[136:139]
    v_mfma_f32_16x16x32_bf16 v[152:155], v[220:223], v[224:227], v[152:155]
    s_waitcnt lgkmcnt(0)
    s_barrier
    ds_read_b128 v[188:191], v29 offset:24576
    v_mfma_f32_16x16x32_bf16 v[124:127], v[212:215], v[228:231], v[124:127]
    ds_read_b64_tr_b16 v[176:177], v26 offset:0
    v_mfma_f32_16x16x32_bf16 v[140:143], v[216:219], v[228:231], v[140:143]
    ds_read_b64_tr_b16 v[178:179], v26 offset:2048
    v_mfma_f32_16x16x32_bf16 v[156:159], v[220:223], v[228:231], v[156:159]
    ds_read_b64_tr_b16 v[180:181], v26 offset:4096
    v_mfma_f32_16x16x32_bf16 v[128:131], v[212:215], v[232:235], v[128:131]
    ds_read_b64_tr_b16 v[182:183], v26 offset:6144
    v_mfma_f32_16x16x32_bf16 v[144:147], v[216:219], v[232:235], v[144:147]
    ds_read_b64_tr_b16 v[184:185], v26 offset:8192
    v_mfma_f32_16x16x32_bf16 v[160:163], v[220:223], v[232:235], v[160:163]
    ds_read_b64_tr_b16 v[186:187], v26 offset:10240
    v_mfma_f32_16x16x32_bf16 v[132:135], v[212:215], v[236:239], v[132:135]
    ds_read_b128 v[192:195], v29 offset:26624
    v_mfma_f32_16x16x32_bf16 v[148:151], v[216:219], v[236:239], v[148:151]
    ds_read_b128 v[196:199], v29 offset:28672
    v_mfma_f32_16x16x32_bf16 v[164:167], v[220:223], v[236:239], v[164:167]
    ds_read_b128 v[200:203], v29 offset:30720
    s_waitcnt lgkmcnt(3)
    v_mfma_f32_16x16x32_bf16 v[120:123], v[176:179], v[188:191], v[120:123]
    ds_read_b128 v[224:227], v29 offset:25600
    v_mfma_f32_16x16x32_bf16 v[136:139], v[180:183], v[188:191], v[136:139]
    ds_read_b64_tr_b16 v[212:213], v26 offset:12288
    v_mfma_f32_16x16x32_bf16 v[152:155], v[184:187], v[188:191], v[152:155]
    ds_read_b64_tr_b16 v[214:215], v26 offset:14336
    s_waitcnt lgkmcnt(4)
    v_mfma_f32_16x16x32_bf16 v[124:127], v[176:179], v[192:195], v[124:127]
    ds_read_b64_tr_b16 v[216:217], v26 offset:16384
    v_mfma_f32_16x16x32_bf16 v[140:143], v[180:183], v[192:195], v[140:143]
    ds_read_b64_tr_b16 v[218:219], v26 offset:18432
    v_mfma_f32_16x16x32_bf16 v[156:159], v[184:187], v[192:195], v[156:159]
    ds_read_b64_tr_b16 v[220:221], v26 offset:20480
    v_mfma_f32_16x16x32_bf16 v[128:131], v[176:179], v[196:199], v[128:131]
    ds_read_b64_tr_b16 v[222:223], v26 offset:22528
    v_mfma_f32_16x16x32_bf16 v[144:147], v[180:183], v[196:199], v[144:147]
    ds_read_b128 v[228:231], v29 offset:27648
    v_mfma_f32_16x16x32_bf16 v[160:163], v[184:187], v[196:199], v[160:163]
    ds_read_b128 v[232:235], v29 offset:29696
    s_waitcnt lgkmcnt(9)
    v_mfma_f32_16x16x32_bf16 v[132:135], v[176:179], v[200:203], v[132:135]
    ds_read_b128 v[236:239], v29 offset:31744
    v_mfma_f32_16x16x32_bf16 v[148:151], v[180:183], v[200:203], v[148:151]
    v_mfma_f32_16x16x32_bf16 v[164:167], v[184:187], v[200:203], v[164:167]
    s_waitcnt lgkmcnt(3)
    v_mfma_f32_16x16x32_bf16 v[120:123], v[212:215], v[224:227], v[120:123]
    v_mfma_f32_16x16x32_bf16 v[136:139], v[216:219], v[224:227], v[136:139]
    v_mfma_f32_16x16x32_bf16 v[152:155], v[220:223], v[224:227], v[152:155]
    s_waitcnt lgkmcnt(0)
    s_barrier
    ds_read_b128 v[188:191], v27 offset:4096
    v_mfma_f32_16x16x32_bf16 v[124:127], v[212:215], v[228:231], v[124:127]
    ds_read_b64_tr_b16 v[176:177], v26 offset:32768
    v_mfma_f32_16x16x32_bf16 v[140:143], v[216:219], v[228:231], v[140:143]
    ds_read_b64_tr_b16 v[178:179], v26 offset:34816
    v_mfma_f32_16x16x32_bf16 v[156:159], v[220:223], v[228:231], v[156:159]
    ds_read_b64_tr_b16 v[180:181], v26 offset:36864
    v_mfma_f32_16x16x32_bf16 v[128:131], v[212:215], v[232:235], v[128:131]
    ds_read_b64_tr_b16 v[182:183], v26 offset:38912
    v_mfma_f32_16x16x32_bf16 v[144:147], v[216:219], v[232:235], v[144:147]
    ds_read_b64_tr_b16 v[184:185], v26 offset:40960
    v_mfma_f32_16x16x32_bf16 v[160:163], v[220:223], v[232:235], v[160:163]
    ds_read_b64_tr_b16 v[186:187], v26 offset:43008
    v_mfma_f32_16x16x32_bf16 v[132:135], v[212:215], v[236:239], v[132:135]
    ds_read_b128 v[192:195], v27 offset:6144
    v_mfma_f32_16x16x32_bf16 v[148:151], v[216:219], v[236:239], v[148:151]
    ds_read_b128 v[196:199], v27 offset:8192
    v_mfma_f32_16x16x32_bf16 v[164:167], v[220:223], v[236:239], v[164:167]
    ds_read_b128 v[200:203], v27 offset:10240
    s_waitcnt lgkmcnt(3)
    v_mfma_f32_16x16x32_bf16 v[120:123], v[176:179], v[188:191], v[120:123]
    ds_read_b128 v[224:227], v27 offset:5120
    v_mfma_f32_16x16x32_bf16 v[136:139], v[180:183], v[188:191], v[136:139]
    ds_read_b64_tr_b16 v[212:213], v26 offset:45056
    v_mfma_f32_16x16x32_bf16 v[152:155], v[184:187], v[188:191], v[152:155]
    ds_read_b64_tr_b16 v[214:215], v26 offset:47104
    s_waitcnt lgkmcnt(4)
    v_mfma_f32_16x16x32_bf16 v[124:127], v[176:179], v[192:195], v[124:127]
    ds_read_b64_tr_b16 v[216:217], v26 offset:49152
    v_mfma_f32_16x16x32_bf16 v[140:143], v[180:183], v[192:195], v[140:143]
    ds_read_b64_tr_b16 v[218:219], v26 offset:51200
    v_mfma_f32_16x16x32_bf16 v[156:159], v[184:187], v[192:195], v[156:159]
    ds_read_b64_tr_b16 v[220:221], v24 offset:0
    v_mfma_f32_16x16x32_bf16 v[128:131], v[176:179], v[196:199], v[128:131]
    ds_read_b64_tr_b16 v[222:223], v24 offset:2048
    v_mfma_f32_16x16x32_bf16 v[144:147], v[180:183], v[196:199], v[144:147]
    ds_read_b128 v[228:231], v27 offset:7168
    v_mfma_f32_16x16x32_bf16 v[160:163], v[184:187], v[196:199], v[160:163]
    ds_read_b128 v[232:235], v27 offset:9216
    s_waitcnt lgkmcnt(9)
    v_mfma_f32_16x16x32_bf16 v[132:135], v[176:179], v[200:203], v[132:135]
    ds_read_b128 v[236:239], v27 offset:11264
    v_mfma_f32_16x16x32_bf16 v[148:151], v[180:183], v[200:203], v[148:151]
    v_mfma_f32_16x16x32_bf16 v[164:167], v[184:187], v[200:203], v[164:167]
    v_mfma_f32_16x16x32_bf16 v[88:91], v[176:179], v[100:103], v[88:91]
    v_mfma_f32_16x16x32_bf16 v[92:95], v[180:183], v[100:103], v[92:95]
    v_mfma_f32_16x16x32_bf16 v[96:99], v[184:187], v[100:103], v[96:99]
    s_waitcnt lgkmcnt(3)
    v_mfma_f32_16x16x32_bf16 v[120:123], v[212:215], v[224:227], v[120:123]
    v_mfma_f32_16x16x32_bf16 v[136:139], v[216:219], v[224:227], v[136:139]
    v_mfma_f32_16x16x32_bf16 v[152:155], v[220:223], v[224:227], v[152:155]
    s_waitcnt lgkmcnt(0)
    s_barrier
    v_mfma_f32_16x16x32_bf16 v[124:127], v[212:215], v[228:231], v[124:127]
    ds_read_b128 v[188:191], v27 offset:36864
    v_mfma_f32_16x16x32_bf16 v[140:143], v[216:219], v[228:231], v[140:143]
    ds_read_b64_tr_b16 v[176:177], v24 offset:12288
    v_mfma_f32_16x16x32_bf16 v[156:159], v[220:223], v[228:231], v[156:159]
    ds_read_b64_tr_b16 v[178:179], v24 offset:14336
    v_mfma_f32_16x16x32_bf16 v[128:131], v[212:215], v[232:235], v[128:131]
    ds_read_b64_tr_b16 v[180:181], v24 offset:16384
    v_mfma_f32_16x16x32_bf16 v[144:147], v[216:219], v[232:235], v[144:147]
    ds_read_b64_tr_b16 v[182:183], v24 offset:18432
    v_mfma_f32_16x16x32_bf16 v[160:163], v[220:223], v[232:235], v[160:163]
    ds_read_b64_tr_b16 v[184:185], v24 offset:20480
    v_mfma_f32_16x16x32_bf16 v[132:135], v[212:215], v[236:239], v[132:135]
    ds_read_b64_tr_b16 v[186:187], v24 offset:22528
    v_mfma_f32_16x16x32_bf16 v[148:151], v[216:219], v[236:239], v[148:151]
    ds_read_b128 v[192:195], v27 offset:38912
    v_mfma_f32_16x16x32_bf16 v[164:167], v[220:223], v[236:239], v[164:167]
    ds_read_b128 v[196:199], v27 offset:40960
    v_mfma_f32_16x16x32_bf16 v[88:91], v[212:215], v[100:103], v[88:91]
    ds_read_b128 v[200:203], v27 offset:43008
    v_mfma_f32_16x16x32_bf16 v[92:95], v[216:219], v[100:103], v[92:95]
    v_mfma_f32_16x16x32_bf16 v[96:99], v[220:223], v[100:103], v[96:99]
    s_waitcnt lgkmcnt(3)
    v_mfma_f32_16x16x32_bf16 v[120:123], v[176:179], v[188:191], v[120:123]
    ds_read_b128 v[224:227], v27 offset:37888
    v_mfma_f32_16x16x32_bf16 v[136:139], v[180:183], v[188:191], v[136:139]
    ds_read_b64_tr_b16 v[212:213], v24 offset:24576
    v_mfma_f32_16x16x32_bf16 v[152:155], v[184:187], v[188:191], v[152:155]
    ds_read_b64_tr_b16 v[214:215], v24 offset:26624
    s_waitcnt lgkmcnt(4)
    v_mfma_f32_16x16x32_bf16 v[124:127], v[176:179], v[192:195], v[124:127]
    ds_read_b64_tr_b16 v[216:217], v24 offset:28672
    v_mfma_f32_16x16x32_bf16 v[140:143], v[180:183], v[192:195], v[140:143]
    ds_read_b64_tr_b16 v[218:219], v24 offset:30720
    v_mfma_f32_16x16x32_bf16 v[156:159], v[184:187], v[192:195], v[156:159]
    ds_read_b64_tr_b16 v[220:221], v24 offset:32768
    v_mfma_f32_16x16x32_bf16 v[128:131], v[176:179], v[196:199], v[128:131]
    ds_read_b64_tr_b16 v[222:223], v24 offset:34816
    v_mfma_f32_16x16x32_bf16 v[144:147], v[180:183], v[196:199], v[144:147]
    ds_read_b128 v[228:231], v27 offset:39936
    v_mfma_f32_16x16x32_bf16 v[160:163], v[184:187], v[196:199], v[160:163]
    ds_read_b128 v[232:235], v27 offset:41984
    s_waitcnt lgkmcnt(9)
    v_mfma_f32_16x16x32_bf16 v[132:135], v[176:179], v[200:203], v[132:135]
    ds_read_b128 v[236:239], v27 offset:44032
    v_mfma_f32_16x16x32_bf16 v[148:151], v[180:183], v[200:203], v[148:151]
    v_mfma_f32_16x16x32_bf16 v[164:167], v[184:187], v[200:203], v[164:167]
    v_mfma_f32_16x16x32_bf16 v[88:91], v[176:179], v[100:103], v[88:91]
    v_mfma_f32_16x16x32_bf16 v[92:95], v[180:183], v[100:103], v[92:95]
    v_mfma_f32_16x16x32_bf16 v[96:99], v[184:187], v[100:103], v[96:99]
    s_waitcnt lgkmcnt(3)
    v_mfma_f32_16x16x32_bf16 v[120:123], v[212:215], v[224:227], v[120:123]
    v_mfma_f32_16x16x32_bf16 v[136:139], v[216:219], v[224:227], v[136:139]
    v_mfma_f32_16x16x32_bf16 v[152:155], v[220:223], v[224:227], v[152:155]
    s_waitcnt lgkmcnt(0)
    s_barrier
    v_mfma_f32_16x16x32_bf16 v[124:127], v[212:215], v[228:231], v[124:127]
    ds_read_b128 v[188:191], v28 offset:16384
    v_mfma_f32_16x16x32_bf16 v[140:143], v[216:219], v[228:231], v[140:143]
    ds_read_b64_tr_b16 v[176:177], v24 offset:45056
    v_mfma_f32_16x16x32_bf16 v[156:159], v[220:223], v[228:231], v[156:159]
    ds_read_b64_tr_b16 v[178:179], v24 offset:47104
    v_mfma_f32_16x16x32_bf16 v[128:131], v[212:215], v[232:235], v[128:131]
    ds_read_b64_tr_b16 v[180:181], v24 offset:49152
    v_mfma_f32_16x16x32_bf16 v[144:147], v[216:219], v[232:235], v[144:147]
    ds_read_b64_tr_b16 v[182:183], v24 offset:51200
    v_mfma_f32_16x16x32_bf16 v[160:163], v[220:223], v[232:235], v[160:163]
    ds_read_b64_tr_b16 v[184:185], v25 offset:0
    v_mfma_f32_16x16x32_bf16 v[132:135], v[212:215], v[236:239], v[132:135]
    ds_read_b64_tr_b16 v[186:187], v25 offset:2048
    v_mfma_f32_16x16x32_bf16 v[148:151], v[216:219], v[236:239], v[148:151]
    ds_read_b128 v[192:195], v28 offset:18432
    v_mfma_f32_16x16x32_bf16 v[164:167], v[220:223], v[236:239], v[164:167]
    ds_read_b128 v[196:199], v28 offset:20480
    v_mfma_f32_16x16x32_bf16 v[88:91], v[212:215], v[100:103], v[88:91]
    ds_read_b128 v[200:203], v28 offset:22528
    v_mfma_f32_16x16x32_bf16 v[92:95], v[216:219], v[100:103], v[92:95]
    v_mfma_f32_16x16x32_bf16 v[96:99], v[220:223], v[100:103], v[96:99]
    s_waitcnt lgkmcnt(3)
    v_mfma_f32_16x16x32_bf16 v[120:123], v[176:179], v[188:191], v[120:123]
    ds_read_b128 v[224:227], v28 offset:17408
    v_mfma_f32_16x16x32_bf16 v[136:139], v[180:183], v[188:191], v[136:139]
    ds_read_b64_tr_b16 v[212:213], v25 offset:4096
    v_mfma_f32_16x16x32_bf16 v[152:155], v[184:187], v[188:191], v[152:155]
    ds_read_b64_tr_b16 v[214:215], v25 offset:6144
    s_waitcnt lgkmcnt(4)
    v_mfma_f32_16x16x32_bf16 v[124:127], v[176:179], v[192:195], v[124:127]
    ds_read_b64_tr_b16 v[216:217], v25 offset:8192
    v_mfma_f32_16x16x32_bf16 v[140:143], v[180:183], v[192:195], v[140:143]
    ds_read_b64_tr_b16 v[218:219], v25 offset:10240
    v_mfma_f32_16x16x32_bf16 v[156:159], v[184:187], v[192:195], v[156:159]
    ds_read_b64_tr_b16 v[220:221], v25 offset:12288
    v_mfma_f32_16x16x32_bf16 v[128:131], v[176:179], v[196:199], v[128:131]
    ds_read_b64_tr_b16 v[222:223], v25 offset:14336
    v_mfma_f32_16x16x32_bf16 v[144:147], v[180:183], v[196:199], v[144:147]
    ds_read_b128 v[228:231], v28 offset:19456
    v_mfma_f32_16x16x32_bf16 v[160:163], v[184:187], v[196:199], v[160:163]
    ds_read_b128 v[232:235], v28 offset:21504
    s_waitcnt lgkmcnt(9)
    v_mfma_f32_16x16x32_bf16 v[132:135], v[176:179], v[200:203], v[132:135]
    ds_read_b128 v[236:239], v28 offset:23552
    v_mfma_f32_16x16x32_bf16 v[148:151], v[180:183], v[200:203], v[148:151]
    v_mfma_f32_16x16x32_bf16 v[164:167], v[184:187], v[200:203], v[164:167]
    v_mfma_f32_16x16x32_bf16 v[88:91], v[176:179], v[100:103], v[88:91]
    v_mfma_f32_16x16x32_bf16 v[92:95], v[180:183], v[100:103], v[92:95]
    v_mfma_f32_16x16x32_bf16 v[96:99], v[184:187], v[100:103], v[96:99]
    s_waitcnt lgkmcnt(3)
    v_mfma_f32_16x16x32_bf16 v[120:123], v[212:215], v[224:227], v[120:123]
    v_mfma_f32_16x16x32_bf16 v[136:139], v[216:219], v[224:227], v[136:139]
    v_mfma_f32_16x16x32_bf16 v[152:155], v[220:223], v[224:227], v[152:155]
    s_waitcnt lgkmcnt(0)
    s_barrier
    v_mfma_f32_16x16x32_bf16 v[124:127], v[212:215], v[228:231], v[124:127]
    ds_read_b128 v[188:191], v28 offset:49152
    v_mfma_f32_16x16x32_bf16 v[140:143], v[216:219], v[228:231], v[140:143]
    ds_read_b64_tr_b16 v[176:177], v25 offset:24576
    v_mfma_f32_16x16x32_bf16 v[156:159], v[220:223], v[228:231], v[156:159]
    ds_read_b64_tr_b16 v[178:179], v25 offset:26624
    v_mfma_f32_16x16x32_bf16 v[128:131], v[212:215], v[232:235], v[128:131]
    ds_read_b64_tr_b16 v[180:181], v25 offset:28672
    v_mfma_f32_16x16x32_bf16 v[144:147], v[216:219], v[232:235], v[144:147]
    ds_read_b64_tr_b16 v[182:183], v25 offset:30720
    v_mfma_f32_16x16x32_bf16 v[160:163], v[220:223], v[232:235], v[160:163]
    ds_read_b64_tr_b16 v[184:185], v25 offset:32768
    v_mfma_f32_16x16x32_bf16 v[132:135], v[212:215], v[236:239], v[132:135]
    ds_read_b64_tr_b16 v[186:187], v25 offset:34816
    v_mfma_f32_16x16x32_bf16 v[148:151], v[216:219], v[236:239], v[148:151]
    ds_read_b128 v[192:195], v28 offset:51200
    v_mfma_f32_16x16x32_bf16 v[164:167], v[220:223], v[236:239], v[164:167]
    ds_read_b128 v[196:199], v28 offset:53248
    v_mfma_f32_16x16x32_bf16 v[88:91], v[212:215], v[100:103], v[88:91]
    ds_read_b128 v[200:203], v28 offset:55296
    v_mfma_f32_16x16x32_bf16 v[92:95], v[216:219], v[100:103], v[92:95]
    v_mfma_f32_16x16x32_bf16 v[96:99], v[220:223], v[100:103], v[96:99]
    s_waitcnt lgkmcnt(3)
    v_mfma_f32_16x16x32_bf16 v[120:123], v[176:179], v[188:191], v[120:123]
    ds_read_b128 v[224:227], v28 offset:50176
    v_mfma_f32_16x16x32_bf16 v[136:139], v[180:183], v[188:191], v[136:139]
    ds_read_b64_tr_b16 v[212:213], v25 offset:36864
    v_mfma_f32_16x16x32_bf16 v[152:155], v[184:187], v[188:191], v[152:155]
    ds_read_b64_tr_b16 v[214:215], v25 offset:38912
    s_waitcnt lgkmcnt(4)
    v_mfma_f32_16x16x32_bf16 v[124:127], v[176:179], v[192:195], v[124:127]
    ds_read_b64_tr_b16 v[216:217], v25 offset:40960
    v_mfma_f32_16x16x32_bf16 v[140:143], v[180:183], v[192:195], v[140:143]
    ds_read_b64_tr_b16 v[218:219], v25 offset:43008
    v_mfma_f32_16x16x32_bf16 v[156:159], v[184:187], v[192:195], v[156:159]
    ds_read_b64_tr_b16 v[220:221], v25 offset:45056
    v_mfma_f32_16x16x32_bf16 v[128:131], v[176:179], v[196:199], v[128:131]
    ds_read_b64_tr_b16 v[222:223], v25 offset:47104
    v_mfma_f32_16x16x32_bf16 v[144:147], v[180:183], v[196:199], v[144:147]
    ds_read_b128 v[228:231], v28 offset:52224
    v_mfma_f32_16x16x32_bf16 v[160:163], v[184:187], v[196:199], v[160:163]
    ds_read_b128 v[232:235], v28 offset:54272
    s_waitcnt lgkmcnt(9)
    v_mfma_f32_16x16x32_bf16 v[132:135], v[176:179], v[200:203], v[132:135]
    ds_read_b128 v[236:239], v28 offset:56320
    v_mfma_f32_16x16x32_bf16 v[148:151], v[180:183], v[200:203], v[148:151]
    v_mfma_f32_16x16x32_bf16 v[164:167], v[184:187], v[200:203], v[164:167]
    v_mfma_f32_16x16x32_bf16 v[88:91], v[176:179], v[100:103], v[88:91]
    v_mfma_f32_16x16x32_bf16 v[92:95], v[180:183], v[100:103], v[92:95]
    v_mfma_f32_16x16x32_bf16 v[96:99], v[184:187], v[100:103], v[96:99]
    s_waitcnt lgkmcnt(3)
    v_mfma_f32_16x16x32_bf16 v[120:123], v[212:215], v[224:227], v[120:123]
    v_mfma_f32_16x16x32_bf16 v[136:139], v[216:219], v[224:227], v[136:139]
    v_mfma_f32_16x16x32_bf16 v[152:155], v[220:223], v[224:227], v[152:155]
    s_waitcnt lgkmcnt(0)
    s_barrier
    v_mfma_f32_16x16x32_bf16 v[124:127], v[212:215], v[228:231], v[124:127]
    ds_read_b128 v[188:191], v29 offset:28672
    v_mfma_f32_16x16x32_bf16 v[140:143], v[216:219], v[228:231], v[140:143]
    ds_read_b64_tr_b16 v[176:177], v26 offset:4096
    v_mfma_f32_16x16x32_bf16 v[156:159], v[220:223], v[228:231], v[156:159]
    ds_read_b64_tr_b16 v[178:179], v26 offset:6144
    v_mfma_f32_16x16x32_bf16 v[128:131], v[212:215], v[232:235], v[128:131]
    ds_read_b64_tr_b16 v[180:181], v26 offset:8192
    v_mfma_f32_16x16x32_bf16 v[144:147], v[216:219], v[232:235], v[144:147]
    ds_read_b64_tr_b16 v[182:183], v26 offset:10240
    v_mfma_f32_16x16x32_bf16 v[160:163], v[220:223], v[232:235], v[160:163]
    ds_read_b64_tr_b16 v[184:185], v26 offset:12288
    v_mfma_f32_16x16x32_bf16 v[132:135], v[212:215], v[236:239], v[132:135]
    ds_read_b64_tr_b16 v[186:187], v26 offset:14336
    v_mfma_f32_16x16x32_bf16 v[148:151], v[216:219], v[236:239], v[148:151]
    ds_read_b128 v[192:195], v29 offset:30720
    v_mfma_f32_16x16x32_bf16 v[164:167], v[220:223], v[236:239], v[164:167]
    ds_read_b128 v[196:199], v29 offset:32768
    v_mfma_f32_16x16x32_bf16 v[88:91], v[212:215], v[100:103], v[88:91]
    ds_read_b128 v[200:203], v29 offset:34816
    v_mfma_f32_16x16x32_bf16 v[92:95], v[216:219], v[100:103], v[92:95]
    v_mfma_f32_16x16x32_bf16 v[96:99], v[220:223], v[100:103], v[96:99]
    s_waitcnt lgkmcnt(3)
    v_mfma_f32_16x16x32_bf16 v[120:123], v[176:179], v[188:191], v[120:123]
    ds_read_b128 v[224:227], v29 offset:29696
    v_mfma_f32_16x16x32_bf16 v[136:139], v[180:183], v[188:191], v[136:139]
    ds_read_b64_tr_b16 v[212:213], v26 offset:16384
    v_mfma_f32_16x16x32_bf16 v[152:155], v[184:187], v[188:191], v[152:155]
    ds_read_b64_tr_b16 v[214:215], v26 offset:18432
    s_waitcnt lgkmcnt(4)
    v_mfma_f32_16x16x32_bf16 v[124:127], v[176:179], v[192:195], v[124:127]
    ds_read_b64_tr_b16 v[216:217], v26 offset:20480
    v_mfma_f32_16x16x32_bf16 v[140:143], v[180:183], v[192:195], v[140:143]
    ds_read_b64_tr_b16 v[218:219], v26 offset:22528
    v_mfma_f32_16x16x32_bf16 v[156:159], v[184:187], v[192:195], v[156:159]
    ds_read_b64_tr_b16 v[220:221], v26 offset:24576
    v_mfma_f32_16x16x32_bf16 v[128:131], v[176:179], v[196:199], v[128:131]
    ds_read_b64_tr_b16 v[222:223], v26 offset:26624
    v_mfma_f32_16x16x32_bf16 v[144:147], v[180:183], v[196:199], v[144:147]
    ds_read_b128 v[228:231], v29 offset:31744
    v_mfma_f32_16x16x32_bf16 v[160:163], v[184:187], v[196:199], v[160:163]
    ds_read_b128 v[232:235], v29 offset:33792
    s_waitcnt lgkmcnt(9)
    v_mfma_f32_16x16x32_bf16 v[132:135], v[176:179], v[200:203], v[132:135]
    ds_read_b128 v[236:239], v29 offset:35840
    v_mfma_f32_16x16x32_bf16 v[148:151], v[180:183], v[200:203], v[148:151]
    v_mfma_f32_16x16x32_bf16 v[164:167], v[184:187], v[200:203], v[164:167]
    v_mfma_f32_16x16x32_bf16 v[88:91], v[176:179], v[100:103], v[88:91]
    v_mfma_f32_16x16x32_bf16 v[92:95], v[180:183], v[100:103], v[92:95]
    v_mfma_f32_16x16x32_bf16 v[96:99], v[184:187], v[100:103], v[96:99]
    s_waitcnt lgkmcnt(3)
    v_mfma_f32_16x16x32_bf16 v[88:91], v[212:215], v[100:103], v[88:91]
    v_mfma_f32_16x16x32_bf16 v[92:95], v[216:219], v[100:103], v[92:95]
    v_mfma_f32_16x16x32_bf16 v[96:99], v[220:223], v[100:103], v[96:99]
    s_waitcnt lgkmcnt(0)
    s_barrier
    v_mfma_f32_16x16x32_bf16 v[120:123], v[212:215], v[224:227], v[120:123]
    ds_read2_b32 v[176:177], v17 offset0:0 offset1:16
    v_mfma_f32_16x16x32_bf16 v[136:139], v[216:219], v[224:227], v[136:139]
    ds_read2_b32 v[178:179], v17 offset0:32 offset1:48
    v_mfma_f32_16x16x32_bf16 v[152:155], v[220:223], v[224:227], v[152:155]
    ds_read2_b32 v[180:181], v17 offset0:64 offset1:80
    v_mfma_f32_16x16x32_bf16 v[124:127], v[212:215], v[228:231], v[124:127]
    ds_read2_b32 v[182:183], v17 offset0:96 offset1:112
    v_mfma_f32_16x16x32_bf16 v[140:143], v[216:219], v[228:231], v[140:143]
    v_mov_b32 v184, 0x3f317218
    v_mfma_f32_16x16x32_bf16 v[156:159], v[220:223], v[228:231], v[156:159]
    v_mov_b32 v185, 0x3f317218
    v_mfma_f32_16x16x32_bf16 v[128:131], v[212:215], v[232:235], v[128:131]
    s_mul_i32 s56, s45, 0x6000
    v_mfma_f32_16x16x32_bf16 v[144:147], v[216:219], v[232:235], v[144:147]
    s_add_u32 s56, s56, s47
    s_add_u32 s56, s56, 0x20000
    v_mfma_f32_16x16x32_bf16 v[160:163], v[220:223], v[232:235], v[160:163]
    v_mfma_f32_16x16x32_bf16 v[132:135], v[212:215], v[236:239], v[132:135]
    v_mfma_f32_16x16x32_bf16 v[148:151], v[216:219], v[236:239], v[148:151]
    v_mfma_f32_16x16x32_bf16 v[164:167], v[220:223], v[236:239], v[164:167]
    s_waitcnt lgkmcnt(0)
    .p2align 3
    v_pk_fma_f32 v[232:233], v[88:89], v[176:177], v[76:77] op_sel:[0,1,0] op_sel_hi:[1,1,1] neg_lo:[1,0,0] neg_hi:[1,0,0]
    v_pk_fma_f32 v[234:235], v[90:91], v[176:177], v[78:79] op_sel:[0,1,0] op_sel_hi:[1,1,1] neg_lo:[1,0,0] neg_hi:[1,0,0]
    v_pk_fma_f32 v[236:237], v[88:89], v[178:179], v[76:77] op_sel:[0,1,0] op_sel_hi:[1,1,1] neg_lo:[1,0,0] neg_hi:[1,0,0]
    v_pk_fma_f32 v[238:239], v[90:91], v[178:179], v[78:79] op_sel:[0,1,0] op_sel_hi:[1,1,1] neg_lo:[1,0,0] neg_hi:[1,0,0]
    v_pk_fma_f32 v[240:241], v[88:89], v[180:181], v[76:77] op_sel:[0,1,0] op_sel_hi:[1,1,1] neg_lo:[1,0,0] neg_hi:[1,0,0]
    v_pk_fma_f32 v[242:243], v[90:91], v[180:181], v[78:79] op_sel:[0,1,0] op_sel_hi:[1,1,1] neg_lo:[1,0,0] neg_hi:[1,0,0]
    v_pk_fma_f32 v[244:245], v[88:89], v[182:183], v[76:77] op_sel:[0,1,0] op_sel_hi:[1,1,1] neg_lo:[1,0,0] neg_hi:[1,0,0]
    v_pk_fma_f32 v[246:247], v[90:91], v[182:183], v[78:79] op_sel:[0,1,0] op_sel_hi:[1,1,1] neg_lo:[1,0,0] neg_hi:[1,0,0]
    v_pk_fma_f32 v[120:121], v[120:121], v[176:177], v[232:233] op_sel_hi:[1,0,1]
    v_pk_fma_f32 v[122:123], v[122:123], v[176:177], v[234:235] op_sel_hi:[1,0,1]
    v_pk_fma_f32 v[124:125], v[124:125], v[178:179], v[236:237] op_sel_hi:[1,0,1]
    v_pk_fma_f32 v[126:127], v[126:127], v[178:179], v[238:239] op_sel_hi:[1,0,1]
    v_pk_fma_f32 v[128:129], v[128:129], v[180:181], v[240:241] op_sel_hi:[1,0,1]
    v_pk_fma_f32 v[130:131], v[130:131], v[180:181], v[242:243] op_sel_hi:[1,0,1]
    v_pk_fma_f32 v[132:133], v[132:133], v[182:183], v[244:245] op_sel_hi:[1,0,1]
    v_pk_fma_f32 v[134:135], v[134:135], v[182:183], v[246:247] op_sel_hi:[1,0,1]
    v_exp_f32 v232, v120
    v_exp_f32 v233, v121
    v_exp_f32 v234, v122
    v_exp_f32 v235, v123
    v_exp_f32 v236, v124
    v_exp_f32 v237, v125
    v_exp_f32 v238, v126
    v_exp_f32 v239, v127
    v_exp_f32 v240, v128
    v_exp_f32 v241, v129
    v_exp_f32 v242, v130
    v_exp_f32 v243, v131
    v_exp_f32 v244, v132
    v_exp_f32 v245, v133
    v_exp_f32 v246, v134
    v_exp_f32 v247, v135
    .p2align 3
    v_pk_add_f32 v[232:233], v[232:233], 1.0 op_sel_hi:[1,0]
    v_pk_add_f32 v[234:235], v[234:235], 1.0 op_sel_hi:[1,0]
    v_pk_add_f32 v[236:237], v[236:237], 1.0 op_sel_hi:[1,0]
    v_pk_add_f32 v[238:239], v[238:239], 1.0 op_sel_hi:[1,0]
    v_pk_add_f32 v[240:241], v[240:241], 1.0 op_sel_hi:[1,0]
    v_pk_add_f32 v[242:243], v[242:243], 1.0 op_sel_hi:[1,0]
    v_pk_add_f32 v[244:245], v[244:245], 1.0 op_sel_hi:[1,0]
    v_pk_add_f32 v[246:247], v[246:247], 1.0 op_sel_hi:[1,0]
    v_pk_fma_f32 v[232:233], v[232:233], v[232:233], 1.0 op_sel_hi:[1,1,0]
    v_pk_fma_f32 v[234:235], v[234:235], v[234:235], 1.0 op_sel_hi:[1,1,0]
    v_pk_fma_f32 v[236:237], v[236:237], v[236:237], 1.0 op_sel_hi:[1,1,0]
    v_pk_fma_f32 v[238:239], v[238:239], v[238:239], 1.0 op_sel_hi:[1,1,0]
    v_pk_fma_f32 v[240:241], v[240:241], v[240:241], 1.0 op_sel_hi:[1,1,0]
    v_pk_fma_f32 v[242:243], v[242:243], v[242:243], 1.0 op_sel_hi:[1,1,0]
    v_pk_fma_f32 v[244:245], v[244:245], v[244:245], 1.0 op_sel_hi:[1,1,0]
    v_pk_fma_f32 v[246:247], v[246:247], v[246:247], 1.0 op_sel_hi:[1,1,0]
    v_rcp_f32 v232, v232
    v_rcp_f32 v233, v233
    v_rcp_f32 v234, v234
    v_rcp_f32 v235, v235
    v_rcp_f32 v236, v236
    v_rcp_f32 v237, v237
    v_rcp_f32 v238, v238
    v_rcp_f32 v239, v239
    v_rcp_f32 v240, v240
    v_rcp_f32 v241, v241
    v_rcp_f32 v242, v242
    v_rcp_f32 v243, v243
    v_rcp_f32 v244, v244
    v_rcp_f32 v245, v245
    v_rcp_f32 v246, v246
    v_rcp_f32 v247, v247
    .p2align 3
    v_pk_fma_f32 v[232:233], v[232:233], s[86:87], v[184:185]
    v_pk_fma_f32 v[234:235], v[234:235], s[86:87], v[184:185]
    v_pk_fma_f32 v[236:237], v[236:237], s[86:87], v[184:185]
    v_pk_fma_f32 v[238:239], v[238:239], s[86:87], v[184:185]
    v_pk_fma_f32 v[240:241], v[240:241], s[86:87], v[184:185]
    v_pk_fma_f32 v[242:243], v[242:243], s[86:87], v[184:185]
    v_pk_fma_f32 v[244:245], v[244:245], s[86:87], v[184:185]
    v_pk_fma_f32 v[246:247], v[246:247], s[86:87], v[184:185]
    v_pk_mul_f32 v[120:121], v[120:121], v[232:233]
    v_pk_mul_f32 v[122:123], v[122:123], v[234:235]
    v_pk_mul_f32 v[124:125], v[124:125], v[236:237]
    v_pk_mul_f32 v[126:127], v[126:127], v[238:239]
    v_pk_mul_f32 v[128:129], v[128:129], v[240:241]
    v_pk_mul_f32 v[130:131], v[130:131], v[242:243]
    v_pk_mul_f32 v[132:133], v[132:133], v[244:245]
    v_pk_mul_f32 v[134:135], v[134:135], v[246:247]
    v_cvt_pk_bf16_f32 v188, v120, v121
    v_cvt_pk_bf16_f32 v189, v122, v123
    v_cvt_pk_bf16_f32 v190, v124, v125
    v_cvt_pk_bf16_f32 v191, v126, v127
    v_cvt_pk_bf16_f32 v192, v128, v129
    v_cvt_pk_bf16_f32 v193, v130, v131
    v_cvt_pk_bf16_f32 v194, v132, v133
    v_cvt_pk_bf16_f32 v195, v134, v135
    s_add_u32 s52, s56, 0
    s_add_u32 s53, s56, 4096
    v_permlane16_swap_b32 v188, v190
    v_permlane16_swap_b32 v189, v191
    v_permlane16_swap_b32 v192, v194
    v_permlane16_swap_b32 v193, v195
    s_cmp_eq_u32 s48, 1
    s_cbranch_scc1 L_sl_13
    buffer_store_dwordx4 v[188:191], v14, s[8:11], s52 offen
    buffer_store_dwordx4 v[192:195], v14, s[8:11], s53 offen
L_sb_14:
    .p2align 3
    v_pk_fma_f32 v[232:233], v[92:93], v[176:177], v[80:81] op_sel:[0,1,0] op_sel_hi:[1,1,1] neg_lo:[1,0,0] neg_hi:[1,0,0]
    v_pk_fma_f32 v[234:235], v[94:95], v[176:177], v[82:83] op_sel:[0,1,0] op_sel_hi:[1,1,1] neg_lo:[1,0,0] neg_hi:[1,0,0]
    v_pk_fma_f32 v[236:237], v[92:93], v[178:179], v[80:81] op_sel:[0,1,0] op_sel_hi:[1,1,1] neg_lo:[1,0,0] neg_hi:[1,0,0]
    v_pk_fma_f32 v[238:239], v[94:95], v[178:179], v[82:83] op_sel:[0,1,0] op_sel_hi:[1,1,1] neg_lo:[1,0,0] neg_hi:[1,0,0]
    v_pk_fma_f32 v[240:241], v[92:93], v[180:181], v[80:81] op_sel:[0,1,0] op_sel_hi:[1,1,1] neg_lo:[1,0,0] neg_hi:[1,0,0]
    v_pk_fma_f32 v[242:243], v[94:95], v[180:181], v[82:83] op_sel:[0,1,0] op_sel_hi:[1,1,1] neg_lo:[1,0,0] neg_hi:[1,0,0]
    v_pk_fma_f32 v[244:245], v[92:93], v[182:183], v[80:81] op_sel:[0,1,0] op_sel_hi:[1,1,1] neg_lo:[1,0,0] neg_hi:[1,0,0]
    v_pk_fma_f32 v[246:247], v[94:95], v[182:183], v[82:83] op_sel:[0,1,0] op_sel_hi:[1,1,1] neg_lo:[1,0,0] neg_hi:[1,0,0]
    v_pk_fma_f32 v[136:137], v[136:137], v[176:177], v[232:233] op_sel_hi:[1,0,1]
    v_pk_fma_f32 v[138:139], v[138:139], v[176:177], v[234:235] op_sel_hi:[1,0,1]
    v_pk_fma_f32 v[140:141], v[140:141], v[178:179], v[236:237] op_sel_hi:[1,0,1]
    v_pk_fma_f32 v[142:143], v[142:143], v[178:179], v[238:239] op_sel_hi:[1,0,1]
    v_pk_fma_f32 v[144:145], v[144:145], v[180:181], v[240:241] op_sel_hi:[1,0,1]
    v_pk_fma_f32 v[146:147], v[146:147], v[180:181], v[242:243] op_sel_hi:[1,0,1]
    v_pk_fma_f32 v[148:149], v[148:149], v[182:183], v[244:245] op_sel_hi:[1,0,1]
    v_pk_fma_f32 v[150:151], v[150:151], v[182:183], v[246:247] op_sel_hi:[1,0,1]
    v_exp_f32 v232, v136
    v_exp_f32 v233, v137
    v_exp_f32 v234, v138
    v_exp_f32 v235, v139
    v_exp_f32 v236, v140
    v_exp_f32 v237, v141
    v_exp_f32 v238, v142
    v_exp_f32 v239, v143
    v_exp_f32 v240, v144
    v_exp_f32 v241, v145
    v_exp_f32 v242, v146
    v_exp_f32 v243, v147
    v_exp_f32 v244, v148
    v_exp_f32 v245, v149
    v_exp_f32 v246, v150
    v_exp_f32 v247, v151
    .p2align 3
    v_pk_add_f32 v[232:233], v[232:233], 1.0 op_sel_hi:[1,0]
    v_pk_add_f32 v[234:235], v[234:235], 1.0 op_sel_hi:[1,0]
    v_pk_add_f32 v[236:237], v[236:237], 1.0 op_sel_hi:[1,0]
    v_pk_add_f32 v[238:239], v[238:239], 1.0 op_sel_hi:[1,0]
    v_pk_add_f32 v[240:241], v[240:241], 1.0 op_sel_hi:[1,0]
    v_pk_add_f32 v[242:243], v[242:243], 1.0 op_sel_hi:[1,0]
    v_pk_add_f32 v[244:245], v[244:245], 1.0 op_sel_hi:[1,0]
    v_pk_add_f32 v[246:247], v[246:247], 1.0 op_sel_hi:[1,0]
    v_pk_fma_f32 v[232:233], v[232:233], v[232:233], 1.0 op_sel_hi:[1,1,0]
    v_pk_fma_f32 v[234:235], v[234:235], v[234:235], 1.0 op_sel_hi:[1,1,0]
    v_pk_fma_f32 v[236:237], v[236:237], v[236:237], 1.0 op_sel_hi:[1,1,0]
    v_pk_fma_f32 v[238:239], v[238:239], v[238:239], 1.0 op_sel_hi:[1,1,0]
    v_pk_fma_f32 v[240:241], v[240:241], v[240:241], 1.0 op_sel_hi:[1,1,0]
    v_pk_fma_f32 v[242:243], v[242:243], v[242:243], 1.0 op_sel_hi:[1,1,0]
    v_pk_fma_f32 v[244:245], v[244:245], v[244:245], 1.0 op_sel_hi:[1,1,0]
    v_pk_fma_f32 v[246:247], v[246:247], v[246:247], 1.0 op_sel_hi:[1,1,0]
    v_rcp_f32 v232, v232
    v_rcp_f32 v233, v233
    v_rcp_f32 v234, v234
    v_rcp_f32 v235, v235
    v_rcp_f32 v236, v236
    v_rcp_f32 v237, v237
    v_rcp_f32 v238, v238
    v_rcp_f32 v239, v239
    v_rcp_f32 v240, v240
    v_rcp_f32 v241, v241
    v_rcp_f32 v242, v242
    v_rcp_f32 v243, v243
    v_rcp_f32 v244, v244
    v_rcp_f32 v245, v245
    v_rcp_f32 v246, v246
    v_rcp_f32 v247, v247
    .p2align 3
    v_pk_fma_f32 v[232:233], v[232:233], s[86:87], v[184:185]
    v_pk_fma_f32 v[234:235], v[234:235], s[86:87], v[184:185]
    v_pk_fma_f32 v[236:237], v[236:237], s[86:87], v[184:185]
    v_pk_fma_f32 v[238:239], v[238:239], s[86:87], v[184:185]
    v_pk_fma_f32 v[240:241], v[240:241], s[86:87], v[184:185]
    v_pk_fma_f32 v[242:243], v[242:243], s[86:87], v[184:185]
    v_pk_fma_f32 v[244:245], v[244:245], s[86:87], v[184:185]
    v_pk_fma_f32 v[246:247], v[246:247], s[86:87], v[184:185]
    v_pk_mul_f32 v[136:137], v[136:137], v[232:233]
    v_pk_mul_f32 v[138:139], v[138:139], v[234:235]
    v_pk_mul_f32 v[140:141], v[140:141], v[236:237]
    v_pk_mul_f32 v[142:143], v[142:143], v[238:239]
    v_pk_mul_f32 v[144:145], v[144:145], v[240:241]
    v_pk_mul_f32 v[146:147], v[146:147], v[242:243]
    v_pk_mul_f32 v[148:149], v[148:149], v[244:245]
    v_pk_mul_f32 v[150:151], v[150:151], v[246:247]
    v_cvt_pk_bf16_f32 v196, v136, v137
    v_cvt_pk_bf16_f32 v197, v138, v139
    v_cvt_pk_bf16_f32 v198, v140, v141
    v_cvt_pk_bf16_f32 v199, v142, v143
    v_cvt_pk_bf16_f32 v200, v144, v145
    v_cvt_pk_bf16_f32 v201, v146, v147
    v_cvt_pk_bf16_f32 v202, v148, v149
    v_cvt_pk_bf16_f32 v203, v150, v151
    s_add_u32 s52, s56, 8192
    s_add_u32 s53, s56, 12288
    v_permlane16_swap_b32 v196, v198
    v_permlane16_swap_b32 v197, v199
    v_permlane16_swap_b32 v200, v202
    v_permlane16_swap_b32 v201, v203
    s_cmp_eq_u32 s48, 1
    s_cbranch_scc1 L_sl_15
    buffer_store_dwordx4 v[196:199], v14, s[8:11], s52 offen
    buffer_store_dwordx4 v[200:203], v14, s[8:11], s53 offen
L_sb_16:
    v_mov_b32 v4, 4
    s_waitcnt vmcnt(2)
    s_cmp_eq_u32 s48, 1
    s_cbranch_scc1 L_sl_17
    s_mov_b64 exec, 1
    buffer_store_dword v4, v16, s[8:11], s47 offen
    s_mov_b64 exec, -1
L_sb_18:
    .p2align 3
    v_pk_fma_f32 v[232:233], v[96:97], v[176:177], v[84:85] op_sel:[0,1,0] op_sel_hi:[1,1,1] neg_lo:[1,0,0] neg_hi:[1,0,0]
    v_pk_fma_f32 v[234:235], v[98:99], v[176:177], v[86:87] op_sel:[0,1,0] op_sel_hi:[1,1,1] neg_lo:[1,0,0] neg_hi:[1,0,0]
    v_pk_fma_f32 v[236:237], v[96:97], v[178:179], v[84:85] op_sel:[0,1,0] op_sel_hi:[1,1,1] neg_lo:[1,0,0] neg_hi:[1,0,0]
    v_pk_fma_f32 v[238:239], v[98:99], v[178:179], v[86:87] op_sel:[0,1,0] op_sel_hi:[1,1,1] neg_lo:[1,0,0] neg_hi:[1,0,0]
    v_pk_fma_f32 v[240:241], v[96:97], v[180:181], v[84:85] op_sel:[0,1,0] op_sel_hi:[1,1,1] neg_lo:[1,0,0] neg_hi:[1,0,0]
    v_pk_fma_f32 v[242:243], v[98:99], v[180:181], v[86:87] op_sel:[0,1,0] op_sel_hi:[1,1,1] neg_lo:[1,0,0] neg_hi:[1,0,0]
    v_pk_fma_f32 v[244:245], v[96:97], v[182:183], v[84:85] op_sel:[0,1,0] op_sel_hi:[1,1,1] neg_lo:[1,0,0] neg_hi:[1,0,0]
    v_pk_fma_f32 v[246:247], v[98:99], v[182:183], v[86:87] op_sel:[0,1,0] op_sel_hi:[1,1,1] neg_lo:[1,0,0] neg_hi:[1,0,0]
    v_pk_fma_f32 v[152:153], v[152:153], v[176:177], v[232:233] op_sel_hi:[1,0,1]
    v_pk_fma_f32 v[154:155], v[154:155], v[176:177], v[234:235] op_sel_hi:[1,0,1]
    v_pk_fma_f32 v[156:157], v[156:157], v[178:179], v[236:237] op_sel_hi:[1,0,1]
    v_pk_fma_f32 v[158:159], v[158:159], v[178:179], v[238:239] op_sel_hi:[1,0,1]
    v_pk_fma_f32 v[160:161], v[160:161], v[180:181], v[240:241] op_sel_hi:[1,0,1]
    v_pk_fma_f32 v[162:163], v[162:163], v[180:181], v[242:243] op_sel_hi:[1,0,1]
    v_pk_fma_f32 v[164:165], v[164:165], v[182:183], v[244:245] op_sel_hi:[1,0,1]
    v_pk_fma_f32 v[166:167], v[166:167], v[182:183], v[246:247] op_sel_hi:[1,0,1]
    v_exp_f32 v232, v152
    v_exp_f32 v233, v153
    v_exp_f32 v234, v154
    v_exp_f32 v235, v155
    v_exp_f32 v236, v156
    v_exp_f32 v237, v157
    v_exp_f32 v238, v158
    v_exp_f32 v239, v159
    v_exp_f32 v240, v160
    v_exp_f32 v241, v161
    v_exp_f32 v242, v162
    v_exp_f32 v243, v163
    v_exp_f32 v244, v164
    v_exp_f32 v245, v165
    v_exp_f32 v246, v166
    v_exp_f32 v247, v167
    .p2align 3
    v_pk_add_f32 v[232:233], v[232:233], 1.0 op_sel_hi:[1,0]
    v_pk_add_f32 v[234:235], v[234:235], 1.0 op_sel_hi:[1,0]
    v_pk_add_f32 v[236:237], v[236:237], 1.0 op_sel_hi:[1,0]
    v_pk_add_f32 v[238:239], v[238:239], 1.0 op_sel_hi:[1,0]
    v_pk_add_f32 v[240:241], v[240:241], 1.0 op_sel_hi:[1,0]
    v_pk_add_f32 v[242:243], v[242:243], 1.0 op_sel_hi:[1,0]
    v_pk_add_f32 v[244:245], v[244:245], 1.0 op_sel_hi:[1,0]
    v_pk_add_f32 v[246:247], v[246:247], 1.0 op_sel_hi:[1,0]
    v_pk_fma_f32 v[232:233], v[232:233], v[232:233], 1.0 op_sel_hi:[1,1,0]
    v_pk_fma_f32 v[234:235], v[234:235], v[234:235], 1.0 op_sel_hi:[1,1,0]
    v_pk_fma_f32 v[236:237], v[236:237], v[236:237], 1.0 op_sel_hi:[1,1,0]
    v_pk_fma_f32 v[238:239], v[238:239], v[238:239], 1.0 op_sel_hi:[1,1,0]
    v_pk_fma_f32 v[240:241], v[240:241], v[240:241], 1.0 op_sel_hi:[1,1,0]
    v_pk_fma_f32 v[242:243], v[242:243], v[242:243], 1.0 op_sel_hi:[1,1,0]
    v_pk_fma_f32 v[244:245], v[244:245], v[244:245], 1.0 op_sel_hi:[1,1,0]
    v_pk_fma_f32 v[246:247], v[246:247], v[246:247], 1.0 op_sel_hi:[1,1,0]
    v_rcp_f32 v232, v232
    v_rcp_f32 v233, v233
    v_rcp_f32 v234, v234
    v_rcp_f32 v235, v235
    v_rcp_f32 v236, v236
    v_rcp_f32 v237, v237
    v_rcp_f32 v238, v238
    v_rcp_f32 v239, v239
    v_rcp_f32 v240, v240
    v_rcp_f32 v241, v241
    v_rcp_f32 v242, v242
    v_rcp_f32 v243, v243
    v_rcp_f32 v244, v244
    v_rcp_f32 v245, v245
    v_rcp_f32 v246, v246
    v_rcp_f32 v247, v247
    buffer_load_dword v10, v22, s[8:11], 0 offen sc1
    v_mov_b32 v24, v13
    v_add_u32 v25, 0xd000, v24
    v_add_u32 v26, 0x1a000, v24
    v_xor_b32 v27, 64, v13
    .p2align 3
    v_add_u32 v28, 0xd000, v27
    v_add_u32 v29, 0x1a000, v27
    v_pk_fma_f32 v[232:233], v[232:233], s[86:87], v[184:185]
    v_pk_fma_f32 v[234:235], v[234:235], s[86:87], v[184:185]
    v_pk_fma_f32 v[236:237], v[236:237], s[86:87], v[184:185]
    v_pk_fma_f32 v[238:239], v[238:239], s[86:87], v[184:185]
    v_pk_fma_f32 v[240:241], v[240:241], s[86:87], v[184:185]
    v_pk_fma_f32 v[242:243], v[242:243], s[86:87], v[184:185]
    v_pk_fma_f32 v[244:245], v[244:245], s[86:87], v[184:185]
    v_pk_fma_f32 v[246:247], v[246:247], s[86:87], v[184:185]
    v_pk_mul_f32 v[152:153], v[152:153], v[232:233]
    v_pk_mul_f32 v[154:155], v[154:155], v[234:235]
    v_pk_mul_f32 v[156:157], v[156:157], v[236:237]
    v_pk_mul_f32 v[158:159], v[158:159], v[238:239]
    v_pk_mul_f32 v[160:161], v[160:161], v[240:241]
    v_pk_mul_f32 v[162:163], v[162:163], v[242:243]
    v_pk_mul_f32 v[164:165], v[164:165], v[244:245]
    v_pk_mul_f32 v[166:167], v[166:167], v[246:247]
    v_cvt_pk_bf16_f32 v204, v152, v153
    v_cvt_pk_bf16_f32 v205, v154, v155
    v_cvt_pk_bf16_f32 v206, v156, v157
    v_cvt_pk_bf16_f32 v207, v158, v159
    v_cvt_pk_bf16_f32 v208, v160, v161
    v_cvt_pk_bf16_f32 v209, v162, v163
    v_cvt_pk_bf16_f32 v210, v164, v165
    v_cvt_pk_bf16_f32 v211, v166, v167
    s_add_u32 s52, s56, 16384
    s_add_u32 s53, s56, 20480
    v_permlane16_swap_b32 v204, v206
    v_permlane16_swap_b32 v205, v207
    v_permlane16_swap_b32 v208, v210
    v_permlane16_swap_b32 v209, v211
    s_cmp_eq_u32 s48, 1
    s_cbranch_scc1 L_sl_19
    buffer_store_dwordx4 v[204:207], v14, s[8:11], s52 offen
    buffer_store_dwordx4 v[208:211], v14, s[8:11], s53 offen
L_sb_20:
    v_mov_b32 v4, 5
    s_waitcnt vmcnt(4)
    s_cmp_eq_u32 s48, 1
    s_cbranch_scc1 L_sl_21
    s_mov_b64 exec, 1
    buffer_store_dword v4, v16, s[8:11], s47 offen
    s_mov_b64 exec, -1
L_sb_22:
    s_waitcnt vmcnt(3)
    v_cmp_gt_u32 vcc, 4, v10
    s_nop 1
    s_cbranch_vccnz L_pl_23
L_pb_24:
    s_add_u32 s57, s47, 0x20000
    buffer_load_dwordx4 v[120:123], v23, s[8:11], s57 offen offset:0 sc1
    buffer_load_dwordx4 v[124:127], v23, s[8:11], s57 offen offset:512 sc1
    s_add_u32 s57, s47, 0x26000
    buffer_load_dwordx4 v[128:131], v23, s[8:11], s57 offen offset:0 sc1
    buffer_load_dwordx4 v[132:135], v23, s[8:11], s57 offen offset:512 sc1
    s_add_u32 s57, s47, 0x2c000
    buffer_load_dwordx4 v[136:139], v23, s[8:11], s57 offen offset:0 sc1
    buffer_load_dwordx4 v[140:143], v23, s[8:11], s57 offen offset:512 sc1
    s_add_u32 s57, s47, 0x32000
    buffer_load_dwordx4 v[144:147], v23, s[8:11], s57 offen offset:0 sc1
    buffer_load_dwordx4 v[148:151], v23, s[8:11], s57 offen offset:512 sc1
    s_barrier
    ds_read_b64_tr_b16 v[216:217], v26 offset:36864
    ds_read_b64_tr_b16 v[218:219], v26 offset:38912
    ds_read_b64_tr_b16 v[220:221], v29 offset:36864
    ds_read_b64_tr_b16 v[222:223], v29 offset:38912
    ds_read_b64_tr_b16 v[224:225], v26 offset:37888
    ds_read_b64_tr_b16 v[226:227], v26 offset:39936
    ds_read_b64_tr_b16 v[228:229], v29 offset:37888
    ds_read_b64_tr_b16 v[230:231], v29 offset:39936
    s_waitcnt vmcnt(6)
    s_waitcnt lgkmcnt(4)
    v_mfma_f32_32x32x16_bf16 v[48:63], v[216:219], v[120:123], v[48:63]
    s_add_u32 s57, s47, 0x38000
    buffer_load_dwordx4 v[152:155], v23, s[8:11], s57 offen offset:0 sc1
    ds_read_b64_tr_b16 v[232:233], v26 offset:45056
    ds_read_b64_tr_b16 v[234:235], v26 offset:47104
    v_mfma_f32_32x32x16_bf16 v[200:215], v[220:223], v[120:123], 0
    ds_read_b64_tr_b16 v[236:237], v29 offset:45056
    ds_read_b64_tr_b16 v[238:239], v29 offset:47104
    buffer_load_dwordx4 v[156:159], v23, s[8:11], s57 offen offset:512 sc1
    s_waitcnt lgkmcnt(4)
    v_mfma_f32_32x32x16_bf16 v[48:63], v[224:227], v[124:127], v[48:63]
    ds_read_b64_tr_b16 v[240:241], v26 offset:46080
    ds_read_b64_tr_b16 v[242:243], v26 offset:48128
    ds_read_b64_tr_b16 v[244:245], v29 offset:46080
    v_mfma_f32_32x32x16_bf16 v[200:215], v[228:231], v[124:127], v[200:215]
    ds_read_b64_tr_b16 v[246:247], v29 offset:48128
    buffer_load_dword v10, v22, s[8:11], 0 offen sc1
    s_waitcnt vmcnt(7)
    s_waitcnt lgkmcnt(4)
    v_mfma_f32_32x32x16_bf16 v[48:63], v[232:235], v[128:131], v[48:63]
    s_add_u32 s57, s47, 0x3e000
    buffer_load_dwordx4 v[120:123], v23, s[8:11], s57 offen offset:0 sc1
    buffer_load_dwordx4 v[124:127], v23, s[8:11], s57 offen offset:512 sc1
    v_mfma_f32_32x32x16_bf16 v[200:215], v[236:239], v[128:131], v[200:215]
    s_waitcnt lgkmcnt(0)
    s_barrier
    ds_read_b64_tr_b16 v[216:217], v24 offset:0
    ds_read_b64_tr_b16 v[218:219], v24 offset:2048
    ds_read_b64_tr_b16 v[220:221], v27 offset:0
    v_mfma_f32_32x32x16_bf16 v[48:63], v[240:243], v[132:135], v[48:63]
    ds_read_b64_tr_b16 v[222:223], v27 offset:2048
    ds_read_b64_tr_b16 v[224:225], v24 offset:1024
    ds_read_b64_tr_b16 v[226:227], v24 offset:3072
    v_mfma_f32_32x32x16_bf16 v[200:215], v[244:247], v[132:135], v[200:215]
    ds_read_b64_tr_b16 v[228:229], v27 offset:1024
    ds_read_b64_tr_b16 v[230:231], v27 offset:3072
    v_mov_b32 v4, 6
    s_cmp_eq_u32 s48, 1
    s_cbranch_scc1 L_sl_27
    s_mov_b64 exec, 1
    buffer_store_dword v4, v16, s[8:11], s47 offen
    s_mov_b64 exec, -1
L_sb_28:
    s_waitcnt vmcnt(8)
    s_waitcnt lgkmcnt(4)
    v_mfma_f32_32x32x16_bf16 v[48:63], v[216:219], v[136:139], v[48:63]
    s_add_u32 s57, s47, 0x44000
    buffer_load_dwordx4 v[128:131], v23, s[8:11], s57 offen offset:0 sc1
    ds_read_b64_tr_b16 v[232:233], v24 offset:8192
    ds_read_b64_tr_b16 v[234:235], v24 offset:10240
    v_mfma_f32_32x32x16_bf16 v[200:215], v[220:223], v[136:139], v[200:215]
    ds_read_b64_tr_b16 v[236:237], v27 offset:8192
    ds_read_b64_tr_b16 v[238:239], v27 offset:10240
    buffer_load_dwordx4 v[132:135], v23, s[8:11], s57 offen offset:512 sc1
    s_waitcnt lgkmcnt(4)
    v_mfma_f32_32x32x16_bf16 v[48:63], v[224:227], v[140:143], v[48:63]
    ds_read_b64_tr_b16 v[240:241], v24 offset:9216
    ds_read_b64_tr_b16 v[242:243], v24 offset:11264
    v_mfma_f32_32x32x16_bf16 v[200:215], v[228:231], v[140:143], v[200:215]
    ds_read_b64_tr_b16 v[244:245], v27 offset:9216
    ds_read_b64_tr_b16 v[246:247], v27 offset:11264
    s_waitcnt vmcnt(8)
    s_waitcnt lgkmcnt(4)
    v_mfma_f32_32x32x16_bf16 v[48:63], v[232:235], v[144:147], v[48:63]
    s_add_u32 s57, s47, 0x4a000
    buffer_load_dwordx4 v[136:139], v23, s[8:11], s57 offen offset:0 sc1
    buffer_load_dwordx4 v[140:143], v23, s[8:11], s57 offen offset:512 sc1
    v_mfma_f32_32x32x16_bf16 v[200:215], v[236:239], v[144:147], v[200:215]
    s_waitcnt lgkmcnt(0)
    s_barrier
    ds_read_b64_tr_b16 v[216:217], v24 offset:16384
    ds_read_b64_tr_b16 v[218:219], v24 offset:18432
    ds_read_b64_tr_b16 v[220:221], v27 offset:16384
    v_mfma_f32_32x32x16_bf16 v[48:63], v[240:243], v[148:151], v[48:63]
    ds_read_b64_tr_b16 v[222:223], v27 offset:18432
    ds_read_b64_tr_b16 v[224:225], v24 offset:17408
    ds_read_b64_tr_b16 v[226:227], v24 offset:19456
    v_mfma_f32_32x32x16_bf16 v[200:215], v[244:247], v[148:151], v[200:215]
    ds_read_b64_tr_b16 v[228:229], v27 offset:17408
    ds_read_b64_tr_b16 v[230:231], v27 offset:19456
    s_waitcnt vmcnt(7)
    v_cmp_gt_u32 vcc, 5, v10
    s_cbranch_vccnz L_pl_29
L_pb_30:
    s_waitcnt lgkmcnt(4)
    v_mfma_f32_32x32x16_bf16 v[48:63], v[216:219], v[152:155], v[48:63]
    s_add_u32 s57, s47, 0x22000
    buffer_load_dwordx4 v[144:147], v23, s[8:11], s57 offen offset:0 sc1
    ds_read_b64_tr_b16 v[232:233], v24 offset:24576
    ds_read_b64_tr_b16 v[234:235], v24 offset:26624
    v_mfma_f32_32x32x16_bf16 v[200:215], v[220:223], v[152:155], v[200:215]
    ds_read_b64_tr_b16 v[236:237], v27 offset:24576
    ds_read_b64_tr_b16 v[238:239], v27 offset:26624
    buffer_load_dwordx4 v[148:151], v23, s[8:11], s57 offen offset:512 sc1
    s_waitcnt lgkmcnt(4)
    v_mfma_f32_32x32x16_bf16 v[48:63], v[224:227], v[156:159], v[48:63]
    ds_read_b64_tr_b16 v[240:241], v24 offset:25600
    ds_read_b64_tr_b16 v[242:243], v24 offset:27648
    v_mfma_f32_32x32x16_bf16 v[200:215], v[228:231], v[156:159], v[200:215]
    ds_read_b64_tr_b16 v[244:245], v27 offset:25600
    ds_read_b64_tr_b16 v[246:247], v27 offset:27648
    s_waitcnt vmcnt(7)
    s_waitcnt lgkmcnt(4)
    v_mfma_f32_32x32x16_bf16 v[48:63], v[232:235], v[120:123], v[48:63]
    s_add_u32 s57, s47, 0x28000
    buffer_load_dwordx4 v[152:155], v23, s[8:11], s57 offen offset:0 sc1
    buffer_load_dwordx4 v[156:159], v23, s[8:11], s57 offen offset:512 sc1
    v_mfma_f32_32x32x16_bf16 v[200:215], v[236:239], v[120:123], v[200:215]
    s_waitcnt lgkmcnt(0)
    s_barrier
    ds_read_b64_tr_b16 v[216:217], v24 offset:32768
    ds_read_b64_tr_b16 v[218:219], v24 offset:34816
    ds_read_b64_tr_b16 v[220:221], v27 offset:32768
    v_mfma_f32_32x32x16_bf16 v[48:63], v[240:243], v[124:127], v[48:63]
    ds_read_b64_tr_b16 v[222:223], v27 offset:34816
    ds_read_b64_tr_b16 v[224:225], v24 offset:33792
    ds_read_b64_tr_b16 v[226:227], v24 offset:35840
    v_mfma_f32_32x32x16_bf16 v[200:215], v[244:247], v[124:127], v[200:215]
    ds_read_b64_tr_b16 v[228:229], v27 offset:33792
    ds_read_b64_tr_b16 v[230:231], v27 offset:35840
    buffer_load_dword v10, v22, s[8:11], 0 offen sc1
    s_waitcnt vmcnt(7)
    s_waitcnt lgkmcnt(4)
    v_mfma_f32_32x32x16_bf16 v[48:63], v[216:219], v[128:131], v[48:63]
    s_add_u32 s57, s47, 0x2e000
    buffer_load_dwordx4 v[120:123], v23, s[8:11], s57 offen offset:0 sc1
    ds_read_b64_tr_b16 v[232:233], v24 offset:40960
    ds_read_b64_tr_b16 v[234:235], v24 offset:43008
    v_mfma_f32_32x32x16_bf16 v[200:215], v[220:223], v[128:131], v[200:215]
    ds_read_b64_tr_b16 v[236:237], v27 offset:40960
    ds_read_b64_tr_b16 v[238:239], v27 offset:43008
    buffer_load_dwordx4 v[124:127], v23, s[8:11], s57 offen offset:512 sc1
    s_waitcnt lgkmcnt(4)
    v_mfma_f32_32x32x16_bf16 v[48:63], v[224:227], v[132:135], v[48:63]
    ds_read_b64_tr_b16 v[240:241], v24 offset:41984
    ds_read_b64_tr_b16 v[242:243], v24 offset:44032
    v_mfma_f32_32x32x16_bf16 v[200:215], v[228:231], v[132:135], v[200:215]
    ds_read_b64_tr_b16 v[244:245], v27 offset:41984
    ds_read_b64_tr_b16 v[246:247], v27 offset:44032
    s_waitcnt vmcnt(7)
    s_waitcnt lgkmcnt(4)
    v_mfma_f32_32x32x16_bf16 v[48:63], v[232:235], v[136:139], v[48:63]
    s_add_u32 s57, s47, 0x34000
    buffer_load_dwordx4 v[128:131], v23, s[8:11], s57 offen offset:0 sc1
    buffer_load_dwordx4 v[132:135], v23, s[8:11], s57 offen offset:512 sc1
    v_mfma_f32_32x32x16_bf16 v[200:215], v[236:239], v[136:139], v[200:215]
    s_waitcnt lgkmcnt(0)
    s_barrier
    ds_read_b64_tr_b16 v[216:217], v24 offset:49152
    ds_read_b64_tr_b16 v[218:219], v24 offset:51200
    v_mfma_f32_32x32x16_bf16 v[48:63], v[240:243], v[140:143], v[48:63]
    ds_read_b64_tr_b16 v[220:221], v27 offset:49152
    ds_read_b64_tr_b16 v[222:223], v27 offset:51200
    ds_read_b64_tr_b16 v[224:225], v24 offset:50176
    v_mfma_f32_32x32x16_bf16 v[200:215], v[244:247], v[140:143], v[200:215]
    ds_read_b64_tr_b16 v[226:227], v24 offset:52224
    ds_read_b64_tr_b16 v[228:229], v27 offset:50176
    ds_read_b64_tr_b16 v[230:231], v27 offset:52224
    s_waitcnt vmcnt(7)
    s_waitcnt lgkmcnt(4)
    v_mfma_f32_32x32x16_bf16 v[48:63], v[216:219], v[144:147], v[48:63]
    s_add_u32 s57, s47, 0x3a000
    buffer_load_dwordx4 v[136:139], v23, s[8:11], s57 offen offset:0 sc1
    ds_read_b64_tr_b16 v[232:233], v25 offset:4096
    ds_read_b64_tr_b16 v[234:235], v25 offset:6144
    v_mfma_f32_32x32x16_bf16 v[200:215], v[220:223], v[144:147], v[200:215]
    ds_read_b64_tr_b16 v[236:237], v28 offset:4096
    ds_read_b64_tr_b16 v[238:239], v28 offset:6144
    buffer_load_dwordx4 v[140:143], v23, s[8:11], s57 offen offset:512 sc1
    s_waitcnt lgkmcnt(4)
    v_mfma_f32_32x32x16_bf16 v[48:63], v[224:227], v[148:151], v[48:63]
    ds_read_b64_tr_b16 v[240:241], v25 offset:5120
    ds_read_b64_tr_b16 v[242:243], v25 offset:7168
    v_mfma_f32_32x32x16_bf16 v[200:215], v[228:231], v[148:151], v[200:215]
    ds_read_b64_tr_b16 v[244:245], v28 offset:5120
    ds_read_b64_tr_b16 v[246:247], v28 offset:7168
    s_waitcnt vmcnt(7)
    s_waitcnt lgkmcnt(4)
    v_mfma_f32_32x32x16_bf16 v[48:63], v[232:235], v[152:155], v[48:63]
    s_add_u32 s57, s47, 0x40000
    buffer_load_dwordx4 v[144:147], v23, s[8:11], s57 offen offset:0 sc1
    buffer_load_dwordx4 v[148:151], v23, s[8:11], s57 offen offset:512 sc1
    v_mfma_f32_32x32x16_bf16 v[200:215], v[236:239], v[152:155], v[200:215]
    s_waitcnt lgkmcnt(0)
    s_barrier
    ds_read_b64_tr_b16 v[216:217], v25 offset:12288
    ds_read_b64_tr_b16 v[218:219], v25 offset:14336
    v_mfma_f32_32x32x16_bf16 v[48:63], v[240:243], v[156:159], v[48:63]
    ds_read_b64_tr_b16 v[220:221], v28 offset:12288
    ds_read_b64_tr_b16 v[222:223], v28 offset:14336
    ds_read_b64_tr_b16 v[224:225], v25 offset:13312
    v_mfma_f32_32x32x16_bf16 v[200:215], v[244:247], v[156:159], v[200:215]
    ds_read_b64_tr_b16 v[226:227], v25 offset:15360
    ds_read_b64_tr_b16 v[228:229], v28 offset:13312
    ds_read_b64_tr_b16 v[230:231], v28 offset:15360
    s_waitcnt vmcnt(6)
    s_waitcnt lgkmcnt(4)
    v_mfma_f32_32x32x16_bf16 v[48:63], v[216:219], v[120:123], v[48:63]
    s_add_u32 s57, s47, 0x46000
    buffer_load_dwordx4 v[152:155], v23, s[8:11], s57 offen offset:0 sc1
    ds_read_b64_tr_b16 v[232:233], v25 offset:20480
    ds_read_b64_tr_b16 v[234:235], v25 offset:22528
    v_mfma_f32_32x32x16_bf16 v[200:215], v[220:223], v[120:123], v[200:215]
    ds_read_b64_tr_b16 v[236:237], v28 offset:20480
    ds_read_b64_tr_b16 v[238:239], v28 offset:22528
    buffer_load_dwordx4 v[156:159], v23, s[8:11], s57 offen offset:512 sc1
    s_waitcnt lgkmcnt(4)
    v_mfma_f32_32x32x16_bf16 v[48:63], v[224:227], v[124:127], v[48:63]
    ds_read_b64_tr_b16 v[240:241], v25 offset:21504
    ds_read_b64_tr_b16 v[242:243], v25 offset:23552
    ds_read_b64_tr_b16 v[244:245], v28 offset:21504
    v_mfma_f32_32x32x16_bf16 v[200:215], v[228:231], v[124:127], v[200:215]
    ds_read_b64_tr_b16 v[246:247], v28 offset:23552
    v_cmp_gt_u32 vcc, 6, v10
    s_cbranch_vccnz L_pl_33
L_pb_34:
    s_waitcnt vmcnt(6)
    s_waitcnt lgkmcnt(4)
    v_mfma_f32_32x32x16_bf16 v[48:63], v[232:235], v[128:131], v[48:63]
    s_add_u32 s57, s47, 0x24000
    buffer_load_dwordx4 v[120:123], v23, s[8:11], s57 offen offset:0 sc1
    buffer_load_dwordx4 v[124:127], v23, s[8:11], s57 offen offset:512 sc1
    v_mfma_f32_32x32x16_bf16 v[200:215], v[236:239], v[128:131], v[200:215]
    s_waitcnt lgkmcnt(0)
    s_barrier
    ds_read_b64_tr_b16 v[216:217], v25 offset:28672
    ds_read_b64_tr_b16 v[218:219], v25 offset:30720
    v_mfma_f32_32x32x16_bf16 v[48:63], v[240:243], v[132:135], v[48:63]
    ds_read_b64_tr_b16 v[220:221], v28 offset:28672
    ds_read_b64_tr_b16 v[222:223], v28 offset:30720
    ds_read_b64_tr_b16 v[224:225], v25 offset:29696
    v_mfma_f32_32x32x16_bf16 v[200:215], v[244:247], v[132:135], v[200:215]
    ds_read_b64_tr_b16 v[226:227], v25 offset:31744
    ds_read_b64_tr_b16 v[228:229], v28 offset:29696
    ds_read_b64_tr_b16 v[230:231], v28 offset:31744
    s_waitcnt vmcnt(6)
    s_waitcnt lgkmcnt(4)
    v_mfma_f32_32x32x16_bf16 v[48:63], v[216:219], v[136:139], v[48:63]
    s_add_u32 s57, s47, 0x2a000
    buffer_load_dwordx4 v[128:131], v23, s[8:11], s57 offen offset:0 sc1
    ds_read_b64_tr_b16 v[232:233], v25 offset:36864
    ds_read_b64_tr_b16 v[234:235], v25 offset:38912
    v_mfma_f32_32x32x16_bf16 v[200:215], v[220:223], v[136:139], v[200:215]
    ds_read_b64_tr_b16 v[236:237], v28 offset:36864
    ds_read_b64_tr_b16 v[238:239], v28 offset:38912
    buffer_load_dwordx4 v[132:135], v23, s[8:11], s57 offen offset:512 sc1
    s_waitcnt lgkmcnt(4)
    v_mfma_f32_32x32x16_bf16 v[48:63], v[224:227], v[140:143], v[48:63]
    ds_read_b64_tr_b16 v[240:241], v25 offset:37888
    ds_read_b64_tr_b16 v[242:243], v25 offset:39936
    v_mfma_f32_32x32x16_bf16 v[200:215], v[228:231], v[140:143], v[200:215]
    ds_read_b64_tr_b16 v[244:245], v28 offset:37888
    ds_read_b64_tr_b16 v[246:247], v28 offset:39936
    s_waitcnt vmcnt(6)
    s_waitcnt lgkmcnt(4)
    v_mfma_f32_32x32x16_bf16 v[48:63], v[232:235], v[144:147], v[48:63]
    s_add_u32 s57, s47, 0x30000
    buffer_load_dwordx4 v[136:139], v23, s[8:11], s57 offen offset:0 sc1
    buffer_load_dwordx4 v[140:143], v23, s[8:11], s57 offen offset:512 sc1
    v_mfma_f32_32x32x16_bf16 v[200:215], v[236:239], v[144:147], v[200:215]
    s_waitcnt lgkmcnt(0)
    s_barrier
    ds_read_b64_tr_b16 v[216:217], v25 offset:45056
    ds_read_b64_tr_b16 v[218:219], v25 offset:47104
    v_mfma_f32_32x32x16_bf16 v[48:63], v[240:243], v[148:151], v[48:63]
    ds_read_b64_tr_b16 v[220:221], v28 offset:45056
    ds_read_b64_tr_b16 v[222:223], v28 offset:47104
    ds_read_b64_tr_b16 v[224:225], v25 offset:46080
    v_mfma_f32_32x32x16_bf16 v[200:215], v[244:247], v[148:151], v[200:215]
    ds_read_b64_tr_b16 v[226:227], v25 offset:48128
    ds_read_b64_tr_b16 v[228:229], v28 offset:46080
    ds_read_b64_tr_b16 v[230:231], v28 offset:48128
    s_waitcnt vmcnt(6)
    s_waitcnt lgkmcnt(4)
    v_mfma_f32_32x32x16_bf16 v[48:63], v[216:219], v[152:155], v[48:63]
    s_add_u32 s57, s47, 0x36000
    buffer_load_dwordx4 v[144:147], v23, s[8:11], s57 offen offset:0 sc1
    ds_read_b64_tr_b16 v[232:233], v26 offset:0
    ds_read_b64_tr_b16 v[234:235], v26 offset:2048
    v_mfma_f32_32x32x16_bf16 v[200:215], v[220:223], v[152:155], v[200:215]
    ds_read_b64_tr_b16 v[236:237], v29 offset:0
    ds_read_b64_tr_b16 v[238:239], v29 offset:2048
    buffer_load_dwordx4 v[148:151], v23, s[8:11], s57 offen offset:512 sc1
    s_waitcnt lgkmcnt(4)
    v_mfma_f32_32x32x16_bf16 v[48:63], v[224:227], v[156:159], v[48:63]
    ds_read_b64_tr_b16 v[240:241], v26 offset:1024
    ds_read_b64_tr_b16 v[242:243], v26 offset:3072
    v_mfma_f32_32x32x16_bf16 v[200:215], v[228:231], v[156:159], v[200:215]
    ds_read_b64_tr_b16 v[244:245], v29 offset:1024
    ds_read_b64_tr_b16 v[246:247], v29 offset:3072
    s_waitcnt vmcnt(6)
    s_waitcnt lgkmcnt(4)
    v_mfma_f32_32x32x16_bf16 v[48:63], v[232:235], v[120:123], v[48:63]
    s_add_u32 s57, s47, 0x3c000
    buffer_load_dwordx4 v[152:155], v23, s[8:11], s57 offen offset:0 sc1
    buffer_load_dwordx4 v[156:159], v23, s[8:11], s57 offen offset:512 sc1
    v_mfma_f32_32x32x16_bf16 v[200:215], v[236:239], v[120:123], v[200:215]
    s_waitcnt lgkmcnt(0)
    s_barrier
    ds_read_b64_tr_b16 v[216:217], v26 offset:8192
    ds_read_b64_tr_b16 v[218:219], v26 offset:10240
    v_mfma_f32_32x32x16_bf16 v[48:63], v[240:243], v[124:127], v[48:63]
    ds_read_b64_tr_b16 v[220:221], v29 offset:8192
    ds_read_b64_tr_b16 v[222:223], v29 offset:10240
    ds_read_b64_tr_b16 v[224:225], v26 offset:9216
    v_mfma_f32_32x32x16_bf16 v[200:215], v[244:247], v[124:127], v[200:215]
    ds_read_b64_tr_b16 v[226:227], v26 offset:11264
    ds_read_b64_tr_b16 v[228:229], v29 offset:9216
    ds_read_b64_tr_b16 v[230:231], v29 offset:11264
    s_waitcnt vmcnt(6)
    s_waitcnt lgkmcnt(4)
    v_mfma_f32_32x32x16_bf16 v[48:63], v[216:219], v[128:131], v[48:63]
    s_add_u32 s57, s47, 0x42000
    buffer_load_dwordx4 v[120:123], v23, s[8:11], s57 offen offset:0 sc1
    ds_read_b64_tr_b16 v[232:233], v26 offset:16384
    ds_read_b64_tr_b16 v[234:235], v26 offset:18432
    v_mfma_f32_32x32x16_bf16 v[200:215], v[220:223], v[128:131], v[200:215]
    ds_read_b64_tr_b16 v[236:237], v29 offset:16384
    ds_read_b64_tr_b16 v[238:239], v29 offset:18432
    buffer_load_dwordx4 v[124:127], v23, s[8:11], s57 offen offset:512 sc1
    s_waitcnt lgkmcnt(4)
    v_mfma_f32_32x32x16_bf16 v[48:63], v[224:227], v[132:135], v[48:63]
    ds_read_b64_tr_b16 v[240:241], v26 offset:17408
    ds_read_b64_tr_b16 v[242:243], v26 offset:19456
    v_mfma_f32_32x32x16_bf16 v[200:215], v[228:231], v[132:135], v[200:215]
    ds_read_b64_tr_b16 v[244:245], v29 offset:17408
    ds_read_b64_tr_b16 v[246:247], v29 offset:19456
    s_waitcnt vmcnt(6)
    s_waitcnt lgkmcnt(4)
    v_mfma_f32_32x32x16_bf16 v[48:63], v[232:235], v[136:139], v[48:63]
    s_add_u32 s57, s47, 0x48000
    buffer_load_dwordx4 v[128:131], v23, s[8:11], s57 offen offset:0 sc1
    buffer_load_dwordx4 v[132:135], v23, s[8:11], s57 offen offset:512 sc1
    v_mfma_f32_32x32x16_bf16 v[200:215], v[236:239], v[136:139], v[200:215]
    s_waitcnt lgkmcnt(0)
    s_barrier
    ds_read_b64_tr_b16 v[216:217], v26 offset:24576
    ds_read_b64_tr_b16 v[218:219], v26 offset:26624
    v_mfma_f32_32x32x16_bf16 v[48:63], v[240:243], v[140:143], v[48:63]
    ds_read_b64_tr_b16 v[220:221], v29 offset:24576
    ds_read_b64_tr_b16 v[222:223], v29 offset:26624
    ds_read_b64_tr_b16 v[224:225], v26 offset:25600
    v_mfma_f32_32x32x16_bf16 v[200:215], v[244:247], v[140:143], v[200:215]
    ds_read_b64_tr_b16 v[226:227], v26 offset:27648
    ds_read_b64_tr_b16 v[228:229], v29 offset:25600
    ds_read_b64_tr_b16 v[230:231], v29 offset:27648
    s_waitcnt vmcnt(6)
    s_waitcnt lgkmcnt(4)
    v_mfma_f32_32x32x16_bf16 v[48:63], v[216:219], v[144:147], v[48:63]
    ds_read_b64_tr_b16 v[232:233], v26 offset:32768
    ds_read_b64_tr_b16 v[234:235], v26 offset:34816
    v_mfma_f32_32x32x16_bf16 v[200:215], v[220:223], v[144:147], v[200:215]
    ds_read_b64_tr_b16 v[236:237], v29 offset:32768
    ds_read_b64_tr_b16 v[238:239], v29 offset:34816
    s_waitcnt lgkmcnt(4)
    v_mfma_f32_32x32x16_bf16 v[48:63], v[224:227], v[148:151], v[48:63]
    ds_read_b64_tr_b16 v[240:241], v26 offset:33792
    ds_read_b64_tr_b16 v[242:243], v26 offset:35840
    v_mfma_f32_32x32x16_bf16 v[200:215], v[228:231], v[148:151], v[200:215]
    ds_read_b64_tr_b16 v[244:245], v29 offset:33792
    ds_read_b64_tr_b16 v[246:247], v29 offset:35840
    s_waitcnt vmcnt(4)
    s_waitcnt lgkmcnt(4)
    v_mfma_f32_32x32x16_bf16 v[48:63], v[232:235], v[152:155], v[48:63]
    v_mfma_f32_32x32x16_bf16 v[200:215], v[236:239], v[152:155], v[200:215]
    s_waitcnt lgkmcnt(0)
    s_barrier
    ds_read_b64_tr_b16 v[216:217], v26 offset:40960
    ds_read_b64_tr_b16 v[218:219], v26 offset:43008
    v_mfma_f32_32x32x16_bf16 v[48:63], v[240:243], v[156:159], v[48:63]
    ds_read_b64_tr_b16 v[220:221], v29 offset:40960
    ds_read_b64_tr_b16 v[222:223], v29 offset:43008
    ds_read_b64_tr_b16 v[224:225], v26 offset:41984
    v_mfma_f32_32x32x16_bf16 v[200:215], v[244:247], v[156:159], v[200:215]
    ds_read_b64_tr_b16 v[226:227], v26 offset:44032
    ds_read_b64_tr_b16 v[228:229], v29 offset:41984
    ds_read_b64_tr_b16 v[230:231], v29 offset:44032
    s_waitcnt vmcnt(2)
    s_waitcnt lgkmcnt(4)
    v_mfma_f32_32x32x16_bf16 v[48:63], v[216:219], v[120:123], v[48:63]
    ds_read_b64_tr_b16 v[236:237], v27 offset:0
    ds_read_b64_tr_b16 v[238:239], v27 offset:2048
    v_mfma_f32_32x32x16_bf16 v[200:215], v[220:223], v[120:123], v[200:215]
    ds_read_b64_tr_b16 v[244:245], v27 offset:1024
    ds_read_b64_tr_b16 v[246:247], v27 offset:3072
    s_waitcnt lgkmcnt(4)
    v_mfma_f32_32x32x16_bf16 v[48:63], v[224:227], v[124:127], v[48:63]
    ds_read_b64_tr_b16 v[232:233], v24 offset:0
    ds_read_b64_tr_b16 v[234:235], v24 offset:2048
    v_mfma_f32_32x32x16_bf16 v[200:215], v[228:231], v[124:127], v[200:215]
    ds_read_b64_tr_b16 v[240:241], v24 offset:1024
    ds_read_b64_tr_b16 v[242:243], v24 offset:3072
    s_waitcnt vmcnt(0)
    s_waitcnt lgkmcnt(4)
    v_mfma_f32_32x32x16_bf16 v[200:215], v[236:239], v[128:131], v[200:215]
    v_mfma_f32_32x32x16_bf16 v[200:215], v[244:247], v[132:135], v[200:215]
    s_cmp_lt_u32 s46, 2
    s_mov_b32 s53, 0x11000
    s_cselect_b32 s53, 0x8000, s53
    s_lshl_b32 s52, s51, 12
    v_lshlrev_b32 v9, 4, v0
    v_add_u32 v9, s53, v9
    s_waitcnt lgkmcnt(0)
    v_mfma_f32_32x32x16_bf16 v[48:63], v[232:235], v[128:131], v[48:63]
    v_add_u32 v8, s52, v9
    s_xor_b32 s52, s52, 0x1000
    v_add_u32 v9, s52, v9
    v_mfma_f32_32x32x16_bf16 v[48:63], v[240:243], v[132:135], v[48:63]
    s_nop 0
    ds_write_b128 v8, v[200:203] offset:0
    ds_write_b128 v8, v[204:207] offset:1024
    ds_write_b128 v8, v[208:211] offset:2048
    ds_write_b128 v8, v[212:215] offset:3072
    s_waitcnt lgkmcnt(0)
    s_barrier
    ds_read_b128 v[200:203], v9 offset:0
    ds_read_b128 v[204:207], v9 offset:1024
    ds_read_b128 v[208:211], v9 offset:2048
    ds_read_b128 v[212:215], v9 offset:3072
    s_lshl_b32 s56, s45, 13
    s_add_u32 s56, s56, s47
    s_add_u32 s56, s56, 0x10000
    s_add_u32 s53, s47, 0x1000
    s_waitcnt lgkmcnt(3)
    v_pk_add_f32 v[48:49], v[48:49], v[200:201]
    v_pk_add_f32 v[50:51], v[50:51], v[202:203]
    s_waitcnt lgkmcnt(2)
    v_pk_add_f32 v[52:53], v[52:53], v[204:205]
    v_pk_add_f32 v[54:55], v[54:55], v[206:207]
    s_waitcnt lgkmcnt(1)
    v_pk_add_f32 v[56:57], v[56:57], v[208:209]
    v_pk_add_f32 v[58:59], v[58:59], v[210:211]
    s_waitcnt lgkmcnt(0)
    .p2align 3
    v_pk_add_f32 v[60:61], v[60:61], v[212:213]
    v_pk_add_f32 v[62:63], v[62:63], v[214:215]
    v_cvt_pk_bf16_f32 v184, v48, v49
    v_cvt_pk_bf16_f32 v185, v50, v51
    v_cvt_pk_bf16_f32 v186, v52, v53
    v_cvt_pk_bf16_f32 v187, v54, v55
    v_cvt_pk_bf16_f32 v188, v56, v57
    v_cvt_pk_bf16_f32 v189, v58, v59
    v_cvt_pk_bf16_f32 v190, v60, v61
    v_cvt_pk_bf16_f32 v191, v62, v63
    v_permlane32_swap_b32 v184, v186
    v_permlane32_swap_b32 v185, v187
    v_permlane32_swap_b32 v188, v190
    v_permlane32_swap_b32 v189, v191
    s_cmp_eq_u32 s48, 1
    s_cbranch_scc1 L_sl_37
    buffer_store_dwordx4 v[184:187], v23, s[8:11], s56 offen offset:0
    buffer_store_dwordx4 v[188:191], v23, s[8:11], s56 offen offset:512
L_sb_38:
    .p2align 3
    v_pk_add_f32 v[192:193], v[48:49], v[50:51]
    v_pk_mul_f32 v[194:195], v[48:49], v[48:49]
    v_pk_add_f32 v[196:197], v[56:57], v[58:59]
    v_pk_mul_f32 v[198:199], v[56:57], v[56:57]
    v_pk_fma_f32 v[194:195], v[50:51], v[50:51], v[194:195]
    v_pk_fma_f32 v[198:199], v[58:59], v[58:59], v[198:199]
    v_pk_add_f32 v[192:193], v[192:193], v[52:53]
    v_pk_fma_f32 v[194:195], v[52:53], v[52:53], v[194:195]
    v_pk_add_f32 v[196:197], v[196:197], v[60:61]
    v_pk_fma_f32 v[198:199], v[60:61], v[60:61], v[198:199]
    v_pk_add_f32 v[192:193], v[192:193], v[54:55]
    v_pk_fma_f32 v[194:195], v[54:55], v[54:55], v[194:195]
    v_pk_add_f32 v[196:197], v[196:197], v[62:63]
    v_pk_fma_f32 v[198:199], v[62:63], v[62:63], v[198:199]
    v_pk_add_f32 v[192:193], v[192:193], v[196:197]
    v_pk_add_f32 v[194:195], v[194:195], v[198:199]
    v_add_f32 v192, v192, v193
    v_add_f32 v194, v194, v195
    s_nop 1
    v_permlane32_swap_b32 v192, v194
    v_add_f32 v192, v192, v194
    s_cmp_eq_u32 s48, 1
    s_cbranch_scc1 L_sl_39
    buffer_store_dword v192, v19, s[8:11], s53 offen
L_sb_40:
    s_cmp_lt_u32 s46, 2
    s_cbranch_scc1 L_nohalo_41
    v_and_b32 v5, 2047, v23
    v_and_b32 v6, 2047, v19
    s_lshl_b32 s52, s45, 11
    s_add_u32 s52, s52, s47
    s_add_u32 s52, s52, 0x4000
    s_add_u32 s53, s47, 0x3000
    s_mov_b32 exec_lo, 0xffff0000
    s_mov_b32 exec_hi, 0xffff0000
    buffer_store_dwordx4 v[184:187], v5, s[8:11], s52 offen offset:0 sc1
    buffer_store_dwordx4 v[188:191], v5, s[8:11], s52 offen offset:512 sc1
    buffer_store_dword v192, v6, s[8:11], s53 offen sc1
    s_mov_b64 exec, -1
L_nohalo_41:
    s_barrier
    v_mov_b32 v24, v12
    v_add_u32 v25, 0xd000, v24
    v_add_u32 v26, 0x1a000, v24
    v_lshlrev_b32 v27, 4, v0
    v_add_u32 v28, 0xd000, v27
    v_add_u32 v29, 0x1a000, v27
    s_cmp_lt_u32 s46, 2
    s_cbranch_scc1 L_nohalo_43
    v_mov_b32 v4, 8
    s_waitcnt vmcnt(3)
    s_cmp_eq_u32 s48, 1
    s_cbranch_scc1 L_sl_44
    s_mov_b64 exec, 1
    buffer_store_dword v4, v16, s[8:11], s47 offen
    s_mov_b64 exec, -1
L_sb_45:
    s_branch L_nohalo_42
L_nohalo_43:
    v_mov_b32 v4, 8
    s_waitcnt vmcnt(0)
    s_cmp_eq_u32 s48, 1
    s_cbranch_scc1 L_sl_46
    s_mov_b64 exec, 1
    buffer_store_dword v4, v16, s[8:11], s47 offen
    s_mov_b64 exec, -1
L_sb_47:
L_nohalo_42:
    s_barrier
    ds_read_b128 v[188:191], v27 offset:32768
    ds_read_b64_tr_b16 v[180:181], v24 offset:12288
    ds_read_b64_tr_b16 v[182:183], v24 offset:14336
    ds_read_b64_tr_b16 v[184:185], v24 offset:16384
    ds_read_b64_tr_b16 v[186:187], v24 offset:18432
    ds_read_b64_tr_b16 v[176:177], v24 offset:8192
    ds_read_b64_tr_b16 v[178:179], v24 offset:10240
    ds_read_b128 v[192:195], v27 offset:34816
    ds_read_b128 v[196:199], v27 offset:36864
    ds_read_b128 v[200:203], v27 offset:38912
    ds_read_b128 v[204:207], v27 offset:40960
    s_waitcnt lgkmcnt(4)
    v_mfma_f32_16x16x32_bf16 v[136:139], v[180:183], v[188:191], 0
    ds_read_b128 v[224:227], v27 offset:33792
    v_mfma_f32_16x16x32_bf16 v[156:159], v[188:191], v[184:187], 0
    ds_read_b64_tr_b16 v[216:217], v24 offset:24576
    s_waitcnt lgkmcnt(4)
    v_mfma_f32_16x16x32_bf16 v[140:143], v[180:183], v[192:195], 0
    ds_read_b64_tr_b16 v[218:219], v24 offset:26624
    v_mfma_f32_16x16x32_bf16 v[160:163], v[192:195], v[184:187], 0
    ds_read_b64_tr_b16 v[220:221], v24 offset:28672
    v_mfma_f32_16x16x32_bf16 v[120:123], v[176:179], v[192:195], 0
    ds_read_b64_tr_b16 v[222:223], v24 offset:30720
    v_mfma_f32_16x16x32_bf16 v[144:147], v[180:183], v[196:199], 0
    ds_read_b64_tr_b16 v[212:213], v24 offset:20480
    v_mfma_f32_16x16x32_bf16 v[164:167], v[196:199], v[184:187], 0
    ds_read_b64_tr_b16 v[214:215], v24 offset:22528
    v_mfma_f32_16x16x32_bf16 v[124:127], v[176:179], v[196:199], 0
    ds_read_b128 v[228:231], v27 offset:35840
    s_waitcnt lgkmcnt(8)
    v_mfma_f32_16x16x32_bf16 v[148:151], v[180:183], v[200:203], 0
    ds_read_b128 v[232:235], v27 offset:37888
    v_mfma_f32_16x16x32_bf16 v[168:171], v[200:203], v[184:187], 0
    ds_read_b128 v[236:239], v27 offset:39936
    v_mfma_f32_16x16x32_bf16 v[128:131], v[176:179], v[200:203], 0
    ds_read_b128 v[240:243], v27 offset:41984
    v_mfma_f32_16x16x32_bf16 v[152:155], v[180:183], v[204:207], 0
    v_mfma_f32_16x16x32_bf16 v[172:175], v[204:207], v[184:187], 0
    v_mfma_f32_16x16x32_bf16 v[132:135], v[176:179], v[204:207], 0
    s_waitcnt lgkmcnt(4)
    v_mfma_f32_16x16x32_bf16 v[136:139], v[216:219], v[224:227], v[136:139]
    v_mfma_f32_16x16x32_bf16 v[156:159], v[224:227], v[220:223], v[156:159]
    s_waitcnt lgkmcnt(2)
    v_mfma_f32_16x16x32_bf16 v[140:143], v[216:219], v[228:231], v[140:143]
    s_waitcnt lgkmcnt(0)
    s_barrier
    v_mfma_f32_16x16x32_bf16 v[160:163], v[228:231], v[220:223], v[160:163]
    ds_read_b128 v[188:191], v28 offset:16384
    v_mfma_f32_16x16x32_bf16 v[120:123], v[212:215], v[228:231], v[120:123]
    ds_read_b64_tr_b16 v[180:181], v24 offset:49152
    v_mfma_f32_16x16x32_bf16 v[144:147], v[216:219], v[232:235], v[144:147]
    ds_read_b64_tr_b16 v[182:183], v24 offset:51200
    v_mfma_f32_16x16x32_bf16 v[164:167], v[232:235], v[220:223], v[164:167]
    ds_read_b64_tr_b16 v[184:185], v25 offset:0
    v_mfma_f32_16x16x32_bf16 v[124:127], v[212:215], v[232:235], v[124:127]
    ds_read_b64_tr_b16 v[186:187], v25 offset:2048
    v_mfma_f32_16x16x32_bf16 v[148:151], v[216:219], v[236:239], v[148:151]
    ds_read_b64_tr_b16 v[176:177], v24 offset:45056
    v_mfma_f32_16x16x32_bf16 v[168:171], v[236:239], v[220:223], v[168:171]
    ds_read_b64_tr_b16 v[178:179], v24 offset:47104
    v_mfma_f32_16x16x32_bf16 v[128:131], v[212:215], v[236:239], v[128:131]
    ds_read_b128 v[192:195], v28 offset:18432
    v_mfma_f32_16x16x32_bf16 v[152:155], v[216:219], v[240:243], v[152:155]
    ds_read_b128 v[196:199], v28 offset:20480
    v_mfma_f32_16x16x32_bf16 v[172:175], v[240:243], v[220:223], v[172:175]
    ds_read_b128 v[200:203], v28 offset:22528
    v_mfma_f32_16x16x32_bf16 v[132:135], v[212:215], v[240:243], v[132:135]
    ds_read_b128 v[204:207], v28 offset:24576
    s_waitcnt lgkmcnt(4)
    v_mfma_f32_16x16x32_bf16 v[136:139], v[180:183], v[188:191], v[136:139]
    ds_read_b128 v[224:227], v28 offset:17408
    v_mfma_f32_16x16x32_bf16 v[156:159], v[188:191], v[184:187], v[156:159]
    ds_read_b64_tr_b16 v[216:217], v25 offset:8192
    s_waitcnt lgkmcnt(4)
    v_mfma_f32_16x16x32_bf16 v[140:143], v[180:183], v[192:195], v[140:143]
    ds_read_b64_tr_b16 v[218:219], v25 offset:10240
    v_mfma_f32_16x16x32_bf16 v[160:163], v[192:195], v[184:187], v[160:163]
    ds_read_b64_tr_b16 v[220:221], v25 offset:12288
    v_mfma_f32_16x16x32_bf16 v[120:123], v[176:179], v[192:195], v[120:123]
    ds_read_b64_tr_b16 v[222:223], v25 offset:14336
    v_mfma_f32_16x16x32_bf16 v[144:147], v[180:183], v[196:199], v[144:147]
    ds_read_b64_tr_b16 v[212:213], v25 offset:4096
    v_mfma_f32_16x16x32_bf16 v[164:167], v[196:199], v[184:187], v[164:167]
    ds_read_b64_tr_b16 v[214:215], v25 offset:6144
    v_mfma_f32_16x16x32_bf16 v[124:127], v[176:179], v[196:199], v[124:127]
    ds_read_b128 v[228:231], v28 offset:19456
    s_waitcnt lgkmcnt(8)
    v_mfma_f32_16x16x32_bf16 v[148:151], v[180:183], v[200:203], v[148:151]
    ds_read_b128 v[232:235], v28 offset:21504
    v_mfma_f32_16x16x32_bf16 v[168:171], v[200:203], v[184:187], v[168:171]
    ds_read_b128 v[236:239], v28 offset:23552
    v_mfma_f32_16x16x32_bf16 v[128:131], v[176:179], v[200:203], v[128:131]
    ds_read_b128 v[240:243], v28 offset:25600
    v_mfma_f32_16x16x32_bf16 v[152:155], v[180:183], v[204:207], v[152:155]
    v_mfma_f32_16x16x32_bf16 v[172:175], v[204:207], v[184:187], v[172:175]
    v_mfma_f32_16x16x32_bf16 v[132:135], v[176:179], v[204:207], v[132:135]
    s_waitcnt lgkmcnt(4)
    v_mfma_f32_16x16x32_bf16 v[136:139], v[216:219], v[224:227], v[136:139]
    v_mfma_f32_16x16x32_bf16 v[156:159], v[224:227], v[220:223], v[156:159]
    s_waitcnt lgkmcnt(2)
    v_mfma_f32_16x16x32_bf16 v[140:143], v[216:219], v[228:231], v[140:143]
    s_waitcnt lgkmcnt(0)
    s_barrier
    v_mfma_f32_16x16x32_bf16 v[160:163], v[228:231], v[220:223], v[160:163]
    ds_read_b128 v[188:191], v29 offset:0
    v_mfma_f32_16x16x32_bf16 v[120:123], v[212:215], v[228:231], v[120:123]
    ds_read_b64_tr_b16 v[180:181], v25 offset:32768
    v_mfma_f32_16x16x32_bf16 v[144:147], v[216:219], v[232:235], v[144:147]
    ds_read_b64_tr_b16 v[182:183], v25 offset:34816
    v_mfma_f32_16x16x32_bf16 v[164:167], v[232:235], v[220:223], v[164:167]
    ds_read_b64_tr_b16 v[184:185], v25 offset:36864
    v_mfma_f32_16x16x32_bf16 v[124:127], v[212:215], v[232:235], v[124:127]
    ds_read_b64_tr_b16 v[186:187], v25 offset:38912
    v_mfma_f32_16x16x32_bf16 v[148:151], v[216:219], v[236:239], v[148:151]
    ds_read_b64_tr_b16 v[176:177], v25 offset:28672
    v_mfma_f32_16x16x32_bf16 v[168:171], v[236:239], v[220:223], v[168:171]
    ds_read_b64_tr_b16 v[178:179], v25 offset:30720
    v_mfma_f32_16x16x32_bf16 v[128:131], v[212:215], v[236:239], v[128:131]
    ds_read_b128 v[192:195], v29 offset:2048
    v_mfma_f32_16x16x32_bf16 v[152:155], v[216:219], v[240:243], v[152:155]
    ds_read_b128 v[196:199], v29 offset:4096
    v_mfma_f32_16x16x32_bf16 v[172:175], v[240:243], v[220:223], v[172:175]
    ds_read_b128 v[200:203], v29 offset:6144
    v_mfma_f32_16x16x32_bf16 v[132:135], v[212:215], v[240:243], v[132:135]
    ds_read_b128 v[204:207], v29 offset:8192
    s_waitcnt lgkmcnt(4)
    v_mfma_f32_16x16x32_bf16 v[136:139], v[180:183], v[188:191], v[136:139]
    ds_read_b128 v[224:227], v29 offset:1024
    v_mfma_f32_16x16x32_bf16 v[156:159], v[188:191], v[184:187], v[156:159]
    ds_read_b64_tr_b16 v[216:217], v25 offset:45056
    s_waitcnt lgkmcnt(4)
    v_mfma_f32_16x16x32_bf16 v[140:143], v[180:183], v[192:195], v[140:143]
    ds_read_b64_tr_b16 v[218:219], v25 offset:47104
    v_mfma_f32_16x16x32_bf16 v[160:163], v[192:195], v[184:187], v[160:163]
    ds_read_b64_tr_b16 v[220:221], v25 offset:49152
    v_mfma_f32_16x16x32_bf16 v[120:123], v[176:179], v[192:195], v[120:123]
    ds_read_b64_tr_b16 v[222:223], v25 offset:51200
    v_mfma_f32_16x16x32_bf16 v[144:147], v[180:183], v[196:199], v[144:147]
    ds_read_b64_tr_b16 v[212:213], v25 offset:40960
    v_mfma_f32_16x16x32_bf16 v[164:167], v[196:199], v[184:187], v[164:167]
    ds_read_b64_tr_b16 v[214:215], v25 offset:43008
    v_mfma_f32_16x16x32_bf16 v[124:127], v[176:179], v[196:199], v[124:127]
    ds_read_b128 v[228:231], v29 offset:3072
    s_waitcnt lgkmcnt(8)
    v_mfma_f32_16x16x32_bf16 v[148:151], v[180:183], v[200:203], v[148:151]
    ds_read_b128 v[232:235], v29 offset:5120
    v_mfma_f32_16x16x32_bf16 v[168:171], v[200:203], v[184:187], v[168:171]
    ds_read_b128 v[236:239], v29 offset:7168
    v_mfma_f32_16x16x32_bf16 v[128:131], v[176:179], v[200:203], v[128:131]
    ds_read_b128 v[240:243], v29 offset:9216
    v_mfma_f32_16x16x32_bf16 v[152:155], v[180:183], v[204:207], v[152:155]
    v_mfma_f32_16x16x32_bf16 v[172:175], v[204:207], v[184:187], v[172:175]
    v_mfma_f32_16x16x32_bf16 v[132:135], v[176:179], v[204:207], v[132:135]
    s_waitcnt lgkmcnt(4)
    v_mfma_f32_16x16x32_bf16 v[136:139], v[216:219], v[224:227], v[136:139]
    v_mfma_f32_16x16x32_bf16 v[156:159], v[224:227], v[220:223], v[156:159]
    s_waitcnt lgkmcnt(2)
    v_mfma_f32_16x16x32_bf16 v[140:143], v[216:219], v[228:231], v[140:143]
    s_waitcnt lgkmcnt(0)
    s_barrier
    v_mfma_f32_16x16x32_bf16 v[160:163], v[228:231], v[220:223], v[160:163]
    ds_read_b128 v[188:191], v29 offset:36864
    v_mfma_f32_16x16x32_bf16 v[120:123], v[212:215], v[228:231], v[120:123]
    ds_read_b64_tr_b16 v[180:181], v26 offset:16384
    v_mfma_f32_16x16x32_bf16 v[144:147], v[216:219], v[232:235], v[144:147]
    ds_read_b64_tr_b16 v[182:183], v26 offset:18432
    v_mfma_f32_16x16x32_bf16 v[164:167], v[232:235], v[220:223], v[164:167]
    ds_read_b64_tr_b16 v[184:185], v26 offset:20480
    v_mfma_f32_16x16x32_bf16 v[124:127], v[212:215], v[232:235], v[124:127]
    ds_read_b64_tr_b16 v[186:187], v26 offset:22528
    v_mfma_f32_16x16x32_bf16 v[148:151], v[216:219], v[236:239], v[148:151]
    ds_read_b64_tr_b16 v[176:177], v26 offset:12288
    v_mfma_f32_16x16x32_bf16 v[168:171], v[236:239], v[220:223], v[168:171]
    ds_read_b64_tr_b16 v[178:179], v26 offset:14336
    v_mfma_f32_16x16x32_bf16 v[128:131], v[212:215], v[236:239], v[128:131]
    ds_read_b128 v[192:195], v29 offset:38912
    v_mfma_f32_16x16x32_bf16 v[152:155], v[216:219], v[240:243], v[152:155]
    ds_read_b128 v[196:199], v29 offset:40960
    v_mfma_f32_16x16x32_bf16 v[172:175], v[240:243], v[220:223], v[172:175]
    ds_read_b128 v[200:203], v29 offset:43008
    v_mfma_f32_16x16x32_bf16 v[132:135], v[212:215], v[240:243], v[132:135]
    ds_read_b128 v[204:207], v29 offset:45056
    s_waitcnt lgkmcnt(4)
    v_mfma_f32_16x16x32_bf16 v[136:139], v[180:183], v[188:191], v[136:139]
    ds_read_b128 v[224:227], v29 offset:37888
    v_mfma_f32_16x16x32_bf16 v[156:159], v[188:191], v[184:187], v[156:159]
    ds_read_b64_tr_b16 v[216:217], v26 offset:28672
    s_waitcnt lgkmcnt(4)
    v_mfma_f32_16x16x32_bf16 v[140:143], v[180:183], v[192:195], v[140:143]
    ds_read_b64_tr_b16 v[218:219], v26 offset:30720
    v_mfma_f32_16x16x32_bf16 v[160:163], v[192:195], v[184:187], v[160:163]
    ds_read_b64_tr_b16 v[220:221], v26 offset:32768
    v_mfma_f32_16x16x32_bf16 v[120:123], v[176:179], v[192:195], v[120:123]
    ds_read_b64_tr_b16 v[222:223], v26 offset:34816
    v_mfma_f32_16x16x32_bf16 v[144:147], v[180:183], v[196:199], v[144:147]
    ds_read_b64_tr_b16 v[212:213], v26 offset:24576
    v_mfma_f32_16x16x32_bf16 v[164:167], v[196:199], v[184:187], v[164:167]
    ds_read_b64_tr_b16 v[214:215], v26 offset:26624
    v_mfma_f32_16x16x32_bf16 v[124:127], v[176:179], v[196:199], v[124:127]
    ds_read_b128 v[228:231], v29 offset:39936
    s_waitcnt lgkmcnt(8)
    v_mfma_f32_16x16x32_bf16 v[148:151], v[180:183], v[200:203], v[148:151]
    ds_read_b128 v[232:235], v29 offset:41984
    v_mfma_f32_16x16x32_bf16 v[168:171], v[200:203], v[184:187], v[168:171]
    ds_read_b128 v[236:239], v29 offset:44032
    v_mfma_f32_16x16x32_bf16 v[128:131], v[176:179], v[200:203], v[128:131]
    ds_read_b128 v[240:243], v29 offset:46080
    v_mfma_f32_16x16x32_bf16 v[152:155], v[180:183], v[204:207], v[152:155]
    v_mfma_f32_16x16x32_bf16 v[172:175], v[204:207], v[184:187], v[172:175]
    v_mfma_f32_16x16x32_bf16 v[132:135], v[176:179], v[204:207], v[132:135]
    s_waitcnt lgkmcnt(4)
    v_mfma_f32_16x16x32_bf16 v[136:139], v[216:219], v[224:227], v[136:139]
    v_mfma_f32_16x16x32_bf16 v[156:159], v[224:227], v[220:223], v[156:159]
    s_waitcnt lgkmcnt(2)
    v_mfma_f32_16x16x32_bf16 v[140:143], v[216:219], v[228:231], v[140:143]
    s_waitcnt lgkmcnt(0)
    s_barrier
    v_mfma_f32_16x16x32_bf16 v[160:163], v[228:231], v[220:223], v[160:163]
    ds_read_b128 v[188:191], v27 offset:20480
    v_mfma_f32_16x16x32_bf16 v[120:123], v[212:215], v[228:231], v[120:123]
    ds_read_b64_tr_b16 v[180:181], v24 offset:0
    v_mfma_f32_16x16x32_bf16 v[144:147], v[216:219], v[232:235], v[144:147]
    ds_read_b64_tr_b16 v[182:183], v24 offset:2048
    v_mfma_f32_16x16x32_bf16 v[164:167], v[232:235], v[220:223], v[164:167]
    ds_read_b64_tr_b16 v[184:185], v24 offset:4096
    v_mfma_f32_16x16x32_bf16 v[124:127], v[212:215], v[232:235], v[124:127]
    ds_read_b64_tr_b16 v[186:187], v24 offset:6144
    v_mfma_f32_16x16x32_bf16 v[148:151], v[216:219], v[236:239], v[148:151]
    ds_read_b64_tr_b16 v[176:177], v26 offset:49152
    v_mfma_f32_16x16x32_bf16 v[168:171], v[236:239], v[220:223], v[168:171]
    ds_read_b64_tr_b16 v[178:179], v26 offset:51200
    v_mfma_f32_16x16x32_bf16 v[128:131], v[212:215], v[236:239], v[128:131]
    ds_read_b128 v[192:195], v27 offset:22528
    v_mfma_f32_16x16x32_bf16 v[152:155], v[216:219], v[240:243], v[152:155]
    ds_read_b128 v[196:199], v27 offset:24576
    v_mfma_f32_16x16x32_bf16 v[172:175], v[240:243], v[220:223], v[172:175]
    ds_read_b128 v[200:203], v27 offset:26624
    v_mfma_f32_16x16x32_bf16 v[132:135], v[212:215], v[240:243], v[132:135]
    ds_read_b128 v[204:207], v27 offset:28672
    s_waitcnt lgkmcnt(4)
    v_mfma_f32_16x16x32_bf16 v[136:139], v[180:183], v[188:191], v[136:139]
    ds_read_b128 v[224:227], v27 offset:21504
    v_mfma_f32_16x16x32_bf16 v[156:159], v[188:191], v[184:187], v[156:159]
    ds_read_b64_tr_b16 v[216:217], v24 offset:12288
    s_waitcnt lgkmcnt(4)
    v_mfma_f32_16x16x32_bf16 v[140:143], v[180:183], v[192:195], v[140:143]
    ds_read_b64_tr_b16 v[218:219], v24 offset:14336
    v_mfma_f32_16x16x32_bf16 v[160:163], v[192:195], v[184:187], v[160:163]
    ds_read_b64_tr_b16 v[220:221], v24 offset:16384
    v_mfma_f32_16x16x32_bf16 v[120:123], v[176:179], v[192:195], v[120:123]
    ds_read_b64_tr_b16 v[222:223], v24 offset:18432
    v_mfma_f32_16x16x32_bf16 v[144:147], v[180:183], v[196:199], v[144:147]
    ds_read_b64_tr_b16 v[212:213], v24 offset:8192
    v_mfma_f32_16x16x32_bf16 v[164:167], v[196:199], v[184:187], v[164:167]
    ds_read_b64_tr_b16 v[214:215], v24 offset:10240
    v_mfma_f32_16x16x32_bf16 v[124:127], v[176:179], v[196:199], v[124:127]
    ds_read_b128 v[228:231], v27 offset:23552
    s_waitcnt lgkmcnt(8)
    v_mfma_f32_16x16x32_bf16 v[148:151], v[180:183], v[200:203], v[148:151]
    ds_read_b128 v[232:235], v27 offset:25600
    v_mfma_f32_16x16x32_bf16 v[168:171], v[200:203], v[184:187], v[168:171]
    ds_read_b128 v[236:239], v27 offset:27648
    v_mfma_f32_16x16x32_bf16 v[128:131], v[176:179], v[200:203], v[128:131]
    ds_read_b128 v[240:243], v27 offset:29696
    v_mfma_f32_16x16x32_bf16 v[152:155], v[180:183], v[204:207], v[152:155]
    v_mfma_f32_16x16x32_bf16 v[172:175], v[204:207], v[184:187], v[172:175]
    v_mfma_f32_16x16x32_bf16 v[132:135], v[176:179], v[204:207], v[132:135]
    s_waitcnt lgkmcnt(4)
    v_mfma_f32_16x16x32_bf16 v[136:139], v[216:219], v[224:227], v[136:139]
    v_mfma_f32_16x16x32_bf16 v[156:159], v[224:227], v[220:223], v[156:159]
    s_waitcnt lgkmcnt(2)
    v_mfma_f32_16x16x32_bf16 v[140:143], v[216:219], v[228:231], v[140:143]
    s_waitcnt lgkmcnt(0)
    s_barrier
    v_mfma_f32_16x16x32_bf16 v[160:163], v[228:231], v[220:223], v[160:163]
    ds_read_b128 v[188:191], v28 offset:4096
    v_mfma_f32_16x16x32_bf16 v[120:123], v[212:215], v[228:231], v[120:123]
    ds_read_b64_tr_b16 v[180:181], v24 offset:36864
    v_mfma_f32_16x16x32_bf16 v[144:147], v[216:219], v[232:235], v[144:147]
    ds_read_b64_tr_b16 v[182:183], v24 offset:38912
    v_mfma_f32_16x16x32_bf16 v[164:167], v[232:235], v[220:223], v[164:167]
    ds_read_b64_tr_b16 v[184:185], v24 offset:40960
    v_mfma_f32_16x16x32_bf16 v[124:127], v[212:215], v[232:235], v[124:127]
    ds_read_b64_tr_b16 v[186:187], v24 offset:43008
    v_mfma_f32_16x16x32_bf16 v[148:151], v[216:219], v[236:239], v[148:151]
    ds_read_b64_tr_b16 v[176:177], v24 offset:32768
    v_mfma_f32_16x16x32_bf16 v[168:171], v[236:239], v[220:223], v[168:171]
    ds_read_b64_tr_b16 v[178:179], v24 offset:34816
    v_mfma_f32_16x16x32_bf16 v[128:131], v[212:215], v[236:239], v[128:131]
    ds_read_b128 v[192:195], v28 offset:6144
    v_mfma_f32_16x16x32_bf16 v[152:155], v[216:219], v[240:243], v[152:155]
    ds_read_b128 v[196:199], v28 offset:8192
    v_mfma_f32_16x16x32_bf16 v[172:175], v[240:243], v[220:223], v[172:175]
    ds_read_b128 v[200:203], v28 offset:10240
    v_mfma_f32_16x16x32_bf16 v[132:135], v[212:215], v[240:243], v[132:135]
    ds_read_b128 v[204:207], v28 offset:12288
    s_waitcnt lgkmcnt(4)
    v_mfma_f32_16x16x32_bf16 v[136:139], v[180:183], v[188:191], v[136:139]
    ds_read_b128 v[224:227], v28 offset:5120
    v_mfma_f32_16x16x32_bf16 v[156:159], v[188:191], v[184:187], v[156:159]
    ds_read_b64_tr_b16 v[216:217], v24 offset:49152
    s_waitcnt lgkmcnt(4)
    v_mfma_f32_16x16x32_bf16 v[140:143], v[180:183], v[192:195], v[140:143]
    ds_read_b64_tr_b16 v[218:219], v24 offset:51200
    v_mfma_f32_16x16x32_bf16 v[160:163], v[192:195], v[184:187], v[160:163]
    ds_read_b64_tr_b16 v[220:221], v25 offset:0
    v_mfma_f32_16x16x32_bf16 v[120:123], v[176:179], v[192:195], v[120:123]
    ds_read_b64_tr_b16 v[222:223], v25 offset:2048
    v_mfma_f32_16x16x32_bf16 v[144:147], v[180:183], v[196:199], v[144:147]
    ds_read_b64_tr_b16 v[212:213], v24 offset:45056
    v_mfma_f32_16x16x32_bf16 v[164:167], v[196:199], v[184:187], v[164:167]
    ds_read_b64_tr_b16 v[214:215], v24 offset:47104
    v_mfma_f32_16x16x32_bf16 v[124:127], v[176:179], v[196:199], v[124:127]
    ds_read_b128 v[228:231], v28 offset:7168
    s_waitcnt lgkmcnt(8)
    v_mfma_f32_16x16x32_bf16 v[148:151], v[180:183], v[200:203], v[148:151]
    ds_read_b128 v[232:235], v28 offset:9216
    v_mfma_f32_16x16x32_bf16 v[168:171], v[200:203], v[184:187], v[168:171]
    ds_read_b128 v[236:239], v28 offset:11264
    v_mfma_f32_16x16x32_bf16 v[128:131], v[176:179], v[200:203], v[128:131]
    ds_read_b128 v[240:243], v28 offset:13312
    v_mfma_f32_16x16x32_bf16 v[152:155], v[180:183], v[204:207], v[152:155]
    v_mfma_f32_16x16x32_bf16 v[172:175], v[204:207], v[184:187], v[172:175]
    v_mfma_f32_16x16x32_bf16 v[132:135], v[176:179], v[204:207], v[132:135]
    s_waitcnt lgkmcnt(4)
    v_mfma_f32_16x16x32_bf16 v[136:139], v[216:219], v[224:227], v[136:139]
    v_mfma_f32_16x16x32_bf16 v[156:159], v[224:227], v[220:223], v[156:159]
    s_waitcnt lgkmcnt(2)
    v_mfma_f32_16x16x32_bf16 v[140:143], v[216:219], v[228:231], v[140:143]
    s_waitcnt lgkmcnt(0)
    s_barrier
    v_mfma_f32_16x16x32_bf16 v[160:163], v[228:231], v[220:223], v[160:163]
    ds_read_b128 v[188:191], v28 offset:40960
    v_mfma_f32_16x16x32_bf16 v[120:123], v[212:215], v[228:231], v[120:123]
    ds_read_b64_tr_b16 v[180:181], v25 offset:20480
    v_mfma_f32_16x16x32_bf16 v[144:147], v[216:219], v[232:235], v[144:147]
    ds_read_b64_tr_b16 v[182:183], v25 offset:22528
    v_mfma_f32_16x16x32_bf16 v[164:167], v[232:235], v[220:223], v[164:167]
    ds_read_b64_tr_b16 v[184:185], v25 offset:24576
    v_mfma_f32_16x16x32_bf16 v[124:127], v[212:215], v[232:235], v[124:127]
    ds_read_b64_tr_b16 v[186:187], v25 offset:26624
    v_mfma_f32_16x16x32_bf16 v[148:151], v[216:219], v[236:239], v[148:151]
    ds_read_b64_tr_b16 v[176:177], v25 offset:16384
    v_mfma_f32_16x16x32_bf16 v[168:171], v[236:239], v[220:223], v[168:171]
    ds_read_b64_tr_b16 v[178:179], v25 offset:18432
    v_mfma_f32_16x16x32_bf16 v[128:131], v[212:215], v[236:239], v[128:131]
    ds_read_b128 v[192:195], v28 offset:43008
    v_mfma_f32_16x16x32_bf16 v[152:155], v[216:219], v[240:243], v[152:155]
    ds_read_b128 v[196:199], v28 offset:45056
    v_mfma_f32_16x16x32_bf16 v[172:175], v[240:243], v[220:223], v[172:175]
    ds_read_b128 v[200:203], v28 offset:47104
    v_mfma_f32_16x16x32_bf16 v[132:135], v[212:215], v[240:243], v[132:135]
    ds_read_b128 v[204:207], v28 offset:49152
    s_waitcnt lgkmcnt(4)
    v_mfma_f32_16x16x32_bf16 v[136:139], v[180:183], v[188:191], v[136:139]
    ds_read_b128 v[224:227], v28 offset:41984
    v_mfma_f32_16x16x32_bf16 v[156:159], v[188:191], v[184:187], v[156:159]
    ds_read_b64_tr_b16 v[216:217], v25 offset:32768
    s_waitcnt lgkmcnt(4)
    v_mfma_f32_16x16x32_bf16 v[140:143], v[180:183], v[192:195], v[140:143]
    ds_read_b64_tr_b16 v[218:219], v25 offset:34816
    v_mfma_f32_16x16x32_bf16 v[160:163], v[192:195], v[184:187], v[160:163]
    ds_read_b64_tr_b16 v[220:221], v25 offset:36864
    v_mfma_f32_16x16x32_bf16 v[120:123], v[176:179], v[192:195], v[120:123]
    ds_read_b64_tr_b16 v[222:223], v25 offset:38912
    v_mfma_f32_16x16x32_bf16 v[144:147], v[180:183], v[196:199], v[144:147]
    ds_read_b64_tr_b16 v[212:213], v25 offset:28672
    v_mfma_f32_16x16x32_bf16 v[164:167], v[196:199], v[184:187], v[164:167]
    ds_read_b64_tr_b16 v[214:215], v25 offset:30720
    v_mfma_f32_16x16x32_bf16 v[124:127], v[176:179], v[196:199], v[124:127]
    ds_read_b128 v[228:231], v28 offset:44032
    s_waitcnt lgkmcnt(8)
    v_mfma_f32_16x16x32_bf16 v[148:151], v[180:183], v[200:203], v[148:151]
    ds_read_b128 v[232:235], v28 offset:46080
    v_mfma_f32_16x16x32_bf16 v[168:171], v[200:203], v[184:187], v[168:171]
    ds_read_b128 v[236:239], v28 offset:48128
    v_mfma_f32_16x16x32_bf16 v[128:131], v[176:179], v[200:203], v[128:131]
    ds_read_b128 v[240:243], v28 offset:50176
    v_mfma_f32_16x16x32_bf16 v[152:155], v[180:183], v[204:207], v[152:155]
    v_mfma_f32_16x16x32_bf16 v[172:175], v[204:207], v[184:187], v[172:175]
    v_mfma_f32_16x16x32_bf16 v[132:135], v[176:179], v[204:207], v[132:135]
    s_waitcnt lgkmcnt(4)
    v_mfma_f32_16x16x32_bf16 v[136:139], v[216:219], v[224:227], v[136:139]
    v_mfma_f32_16x16x32_bf16 v[156:159], v[224:227], v[220:223], v[156:159]
    s_waitcnt lgkmcnt(2)
    v_mfma_f32_16x16x32_bf16 v[140:143], v[216:219], v[228:231], v[140:143]
    s_waitcnt lgkmcnt(0)
    s_barrier
    v_mfma_f32_16x16x32_bf16 v[160:163], v[228:231], v[220:223], v[160:163]
    ds_read_b128 v[188:191], v29 offset:24576
    v_mfma_f32_16x16x32_bf16 v[120:123], v[212:215], v[228:231], v[120:123]
    ds_read_b64_tr_b16 v[180:181], v26 offset:4096
    v_mfma_f32_16x16x32_bf16 v[144:147], v[216:219], v[232:235], v[144:147]
    ds_read_b64_tr_b16 v[182:183], v26 offset:6144
    v_mfma_f32_16x16x32_bf16 v[164:167], v[232:235], v[220:223], v[164:167]
    ds_read_b64_tr_b16 v[184:185], v26 offset:8192
    v_mfma_f32_16x16x32_bf16 v[124:127], v[212:215], v[232:235], v[124:127]
    ds_read_b64_tr_b16 v[186:187], v26 offset:10240
    v_mfma_f32_16x16x32_bf16 v[148:151], v[216:219], v[236:239], v[148:151]
    ds_read_b64_tr_b16 v[176:177], v26 offset:0
    v_mfma_f32_16x16x32_bf16 v[168:171], v[236:239], v[220:223], v[168:171]
    ds_read_b64_tr_b16 v[178:179], v26 offset:2048
    v_mfma_f32_16x16x32_bf16 v[128:131], v[212:215], v[236:239], v[128:131]
    ds_read_b128 v[192:195], v29 offset:26624
    v_mfma_f32_16x16x32_bf16 v[152:155], v[216:219], v[240:243], v[152:155]
    ds_read_b128 v[196:199], v29 offset:28672
    v_mfma_f32_16x16x32_bf16 v[172:175], v[240:243], v[220:223], v[172:175]
    ds_read_b128 v[200:203], v29 offset:30720
    v_mfma_f32_16x16x32_bf16 v[132:135], v[212:215], v[240:243], v[132:135]
    ds_read_b128 v[204:207], v29 offset:32768
    s_waitcnt lgkmcnt(4)
    v_mfma_f32_16x16x32_bf16 v[136:139], v[180:183], v[188:191], v[136:139]
    ds_read_b128 v[224:227], v29 offset:25600
    v_mfma_f32_16x16x32_bf16 v[156:159], v[188:191], v[184:187], v[156:159]
    ds_read_b64_tr_b16 v[216:217], v26 offset:16384
    s_waitcnt lgkmcnt(4)
    v_mfma_f32_16x16x32_bf16 v[140:143], v[180:183], v[192:195], v[140:143]
    ds_read_b64_tr_b16 v[218:219], v26 offset:18432
    v_mfma_f32_16x16x32_bf16 v[160:163], v[192:195], v[184:187], v[160:163]
    ds_read_b64_tr_b16 v[220:221], v26 offset:20480
    v_mfma_f32_16x16x32_bf16 v[120:123], v[176:179], v[192:195], v[120:123]
    ds_read_b64_tr_b16 v[222:223], v26 offset:22528
    v_mfma_f32_16x16x32_bf16 v[144:147], v[180:183], v[196:199], v[144:147]
    ds_read_b64_tr_b16 v[212:213], v26 offset:12288
    v_mfma_f32_16x16x32_bf16 v[164:167], v[196:199], v[184:187], v[164:167]
    ds_read_b64_tr_b16 v[214:215], v26 offset:14336
    v_mfma_f32_16x16x32_bf16 v[124:127], v[176:179], v[196:199], v[124:127]
    ds_read_b128 v[228:231], v29 offset:27648
    s_waitcnt lgkmcnt(8)
    v_mfma_f32_16x16x32_bf16 v[148:151], v[180:183], v[200:203], v[148:151]
    ds_read_b128 v[232:235], v29 offset:29696
    v_mfma_f32_16x16x32_bf16 v[168:171], v[200:203], v[184:187], v[168:171]
    ds_read_b128 v[236:239], v29 offset:31744
    v_mfma_f32_16x16x32_bf16 v[128:131], v[176:179], v[200:203], v[128:131]
    ds_read_b128 v[240:243], v29 offset:33792
    v_mfma_f32_16x16x32_bf16 v[152:155], v[180:183], v[204:207], v[152:155]
    v_mfma_f32_16x16x32_bf16 v[172:175], v[204:207], v[184:187], v[172:175]
    v_mfma_f32_16x16x32_bf16 v[132:135], v[176:179], v[204:207], v[132:135]
    s_waitcnt lgkmcnt(4)
    v_mfma_f32_16x16x32_bf16 v[136:139], v[216:219], v[224:227], v[136:139]
    v_mfma_f32_16x16x32_bf16 v[156:159], v[224:227], v[220:223], v[156:159]
    s_waitcnt lgkmcnt(2)
    v_mfma_f32_16x16x32_bf16 v[140:143], v[216:219], v[228:231], v[140:143]
    s_waitcnt lgkmcnt(0)
    s_barrier
    v_mfma_f32_16x16x32_bf16 v[160:163], v[228:231], v[220:223], v[160:163]
    ds_read2_b32 v[176:177], v17 offset0:0 offset1:16
    v_mfma_f32_16x16x32_bf16 v[120:123], v[212:215], v[228:231], v[120:123]
    ds_read2_b32 v[178:179], v17 offset0:32 offset1:48
    v_mfma_f32_16x16x32_bf16 v[144:147], v[216:219], v[232:235], v[144:147]
    ds_read2_b32 v[180:181], v17 offset0:64 offset1:80
    v_mfma_f32_16x16x32_bf16 v[164:167], v[232:235], v[220:223], v[164:167]
    ds_read2_b32 v[182:183], v17 offset0:96 offset1:112
    v_mfma_f32_16x16x32_bf16 v[124:127], v[212:215], v[232:235], v[124:127]
    ds_read2_b32 v[184:185], v17 offset0:128 offset1:144
    v_mfma_f32_16x16x32_bf16 v[148:151], v[216:219], v[236:239], v[148:151]
    v_mfma_f32_16x16x32_bf16 v[168:171], v[236:239], v[220:223], v[168:171]
    v_mfma_f32_16x16x32_bf16 v[128:131], v[212:215], v[236:239], v[128:131]
    v_mfma_f32_16x16x32_bf16 v[152:155], v[216:219], v[240:243], v[152:155]
    v_mfma_f32_16x16x32_bf16 v[172:175], v[240:243], v[220:223], v[172:175]
    v_mfma_f32_16x16x32_bf16 v[132:135], v[212:215], v[240:243], v[132:135]
    ds_read_b128 v[208:211], v18 offset:0
    ds_read_b128 v[228:231], v18 offset:64
    ds_read_b128 v[212:215], v18 offset:128
    ds_read_b128 v[232:235], v18 offset:192
    ds_read_b128 v[216:219], v18 offset:256
    ds_read_b128 v[236:239], v18 offset:320
    ds_read_b128 v[220:223], v18 offset:384
    ds_read_b128 v[240:243], v18 offset:448
    ds_read_b128 v[224:227], v18 offset:512
    ds_read_b128 v[244:247], v18 offset:576
    s_waitcnt lgkmcnt(10)
    .p2align 3
    v_pk_mul_f32 v[186:187], v[178:179], s[88:89]
    v_pk_mul_f32 v[188:189], v[180:181], s[88:89]
    v_pk_mul_f32 v[190:191], v[182:183], s[88:89]
    v_pk_mul_f32 v[192:193], v[184:185], s[88:89]
    v_pk_mul_f32 v[194:195], v[68:69], v[176:177] op_sel:[0,1] op_sel_hi:[1,1]
    v_pk_mul_f32 v[196:197], v[70:71], v[176:177] op_sel:[0,1] op_sel_hi:[1,1]
    v_pk_mul_f32 v[198:199], v[68:69], v[178:179] op_sel:[0,1] op_sel_hi:[1,1]
    v_pk_mul_f32 v[200:201], v[70:71], v[178:179] op_sel:[0,1] op_sel_hi:[1,1]
    v_pk_fma_f32 v[136:137], v[136:137], v[176:177], v[194:195] op_sel_hi:[1,0,1] neg_lo:[0,0,1] neg_hi:[0,0,1]
    v_pk_fma_f32 v[138:139], v[138:139], v[176:177], v[196:197] op_sel_hi:[1,0,1] neg_lo:[0,0,1] neg_hi:[0,0,1]
    v_pk_fma_f32 v[140:141], v[140:141], v[178:179], v[198:199] op_sel_hi:[1,0,1] neg_lo:[0,0,1] neg_hi:[0,0,1]
    v_pk_fma_f32 v[142:143], v[142:143], v[178:179], v[200:201] op_sel_hi:[1,0,1] neg_lo:[0,0,1] neg_hi:[0,0,1]
    v_cvt_pk_bf16_f32 v136, v136, v137
    v_cvt_pk_bf16_f32 v137, v138, v139
    v_cvt_pk_bf16_f32 v140, v140, v141
    v_cvt_pk_bf16_f32 v141, v142, v143
    v_pk_mul_f32 v[194:195], v[68:69], v[180:181] op_sel:[0,1] op_sel_hi:[1,1]
    v_pk_mul_f32 v[196:197], v[70:71], v[180:181] op_sel:[0,1] op_sel_hi:[1,1]
    v_pk_mul_f32 v[198:199], v[68:69], v[182:183] op_sel:[0,1] op_sel_hi:[1,1]
    v_pk_mul_f32 v[200:201], v[70:71], v[182:183] op_sel:[0,1] op_sel_hi:[1,1]
    v_pk_fma_f32 v[144:145], v[144:145], v[180:181], v[194:195] op_sel_hi:[1,0,1] neg_lo:[0,0,1] neg_hi:[0,0,1]
    v_pk_fma_f32 v[146:147], v[146:147], v[180:181], v[196:197] op_sel_hi:[1,0,1] neg_lo:[0,0,1] neg_hi:[0,0,1]
    v_pk_fma_f32 v[148:149], v[148:149], v[182:183], v[198:199] op_sel_hi:[1,0,1] neg_lo:[0,0,1] neg_hi:[0,0,1]
    v_pk_fma_f32 v[150:151], v[150:151], v[182:183], v[200:201] op_sel_hi:[1,0,1] neg_lo:[0,0,1] neg_hi:[0,0,1]
    v_cvt_pk_bf16_f32 v144, v144, v145
    v_cvt_pk_bf16_f32 v145, v146, v147
    v_cvt_pk_bf16_f32 v148, v148, v149
    v_cvt_pk_bf16_f32 v149, v150, v151
    v_pk_mul_f32 v[194:195], v[68:69], v[184:185] op_sel:[0,1] op_sel_hi:[1,1]
    v_pk_mul_f32 v[196:197], v[70:71], v[184:185] op_sel:[0,1] op_sel_hi:[1,1]
    v_pk_mul_f32 v[198:199], v[64:65], v[186:187] op_sel:[0,1] op_sel_hi:[1,1]
    v_pk_mul_f32 v[200:201], v[66:67], v[186:187] op_sel:[0,1] op_sel_hi:[1,1]
    v_pk_fma_f32 v[152:153], v[152:153], v[184:185], v[194:195] op_sel_hi:[1,0,1] neg_lo:[0,0,1] neg_hi:[0,0,1]
    v_pk_fma_f32 v[154:155], v[154:155], v[184:185], v[196:197] op_sel_hi:[1,0,1] neg_lo:[0,0,1] neg_hi:[0,0,1]
    v_pk_fma_f32 v[120:121], v[120:121], v[186:187], v[198:199] op_sel_hi:[1,0,1] neg_lo:[0,0,1] neg_hi:[0,0,1]
    v_pk_fma_f32 v[122:123], v[122:123], v[186:187], v[200:201] op_sel_hi:[1,0,1] neg_lo:[0,0,1] neg_hi:[0,0,1]
    v_cvt_pk_bf16_f32 v152, v152, v153
    v_cvt_pk_bf16_f32 v153, v154, v155
    v_cvt_pk_bf16_f32 v120, v120, v121
    v_cvt_pk_bf16_f32 v121, v122, v123
    v_pk_mul_f32 v[194:195], v[64:65], v[188:189] op_sel:[0,1] op_sel_hi:[1,1]
    v_pk_mul_f32 v[196:197], v[66:67], v[188:189] op_sel:[0,1] op_sel_hi:[1,1]
    v_pk_mul_f32 v[198:199], v[64:65], v[190:191] op_sel:[0,1] op_sel_hi:[1,1]
    v_pk_mul_f32 v[200:201], v[66:67], v[190:191] op_sel:[0,1] op_sel_hi:[1,1]
    v_pk_fma_f32 v[124:125], v[124:125], v[188:189], v[194:195] op_sel_hi:[1,0,1] neg_lo:[0,0,1] neg_hi:[0,0,1]
    v_pk_fma_f32 v[126:127], v[126:127], v[188:189], v[196:197] op_sel_hi:[1,0,1] neg_lo:[0,0,1] neg_hi:[0,0,1]
    v_pk_fma_f32 v[128:129], v[128:129], v[190:191], v[198:199] op_sel_hi:[1,0,1] neg_lo:[0,0,1] neg_hi:[0,0,1]
    v_pk_fma_f32 v[130:131], v[130:131], v[190:191], v[200:201] op_sel_hi:[1,0,1] neg_lo:[0,0,1] neg_hi:[0,0,1]
    v_cvt_pk_bf16_f32 v124, v124, v125
    v_cvt_pk_bf16_f32 v125, v126, v127
    v_cvt_pk_bf16_f32 v128, v128, v129
    v_cvt_pk_bf16_f32 v129, v130, v131
    v_pk_mul_f32 v[194:195], v[64:65], v[192:193] op_sel:[0,1] op_sel_hi:[1,1]
    v_pk_mul_f32 v[196:197], v[66:67], v[192:193] op_sel:[0,1] op_sel_hi:[1,1]
    v_pk_fma_f32 v[132:133], v[132:133], v[192:193], v[194:195] op_sel_hi:[1,0,1] neg_lo:[0,0,1] neg_hi:[0,0,1]
    v_pk_fma_f32 v[134:135], v[134:135], v[192:193], v[196:197] op_sel_hi:[1,0,1] neg_lo:[0,0,1] neg_hi:[0,0,1]
    v_cvt_pk_bf16_f32 v132, v132, v133
    v_cvt_pk_bf16_f32 v133, v134, v135
    v_mfma_f32_16x16x16_bf16 v[176:179], v[136:137], v[120:121], v[108:111]
    v_mfma_f32_16x16x16_bf16 v[180:183], v[140:141], v[120:121], v[112:115]
    v_mfma_f32_16x16x16_bf16 v[184:187], v[140:141], v[124:125], v[104:107]
    v_mfma_f32_16x16x16_bf16 v[188:191], v[144:145], v[124:125], v[112:115]
    v_mfma_f32_16x16x16_bf16 v[192:195], v[144:145], v[128:129], v[104:107]
    v_mfma_f32_16x16x16_bf16 v[196:199], v[148:149], v[128:129], v[112:115]
    v_mfma_f32_16x16x16_bf16 v[200:203], v[148:149], v[132:133], v[104:107]
    v_mfma_f32_16x16x16_bf16 v[204:207], v[152:153], v[132:133], v[112:115]
    s_waitcnt lgkmcnt(0)
    .p2align 3
    v_pk_mul_f32 v[228:229], v[228:229], v[72:73]
    v_pk_mul_f32 v[230:231], v[230:231], v[72:73]
    v_pk_mul_f32 v[232:233], v[232:233], v[72:73]
    v_pk_mul_f32 v[234:235], v[234:235], v[72:73]
    v_pk_mul_f32 v[236:237], v[236:237], v[72:73]
    v_pk_mul_f32 v[238:239], v[238:239], v[72:73]
    v_pk_mul_f32 v[240:241], v[240:241], v[72:73]
    v_pk_mul_f32 v[242:243], v[242:243], v[72:73]
    v_max3_f32 v136, v176, v177, v180
    v_max3_f32 v137, v178, v179, v182
    v_max3_f32 v138, v184, v185, v188
    v_max3_f32 v139, v186, v187, v190
    v_max3_f32 v140, v192, v193, v196
    v_max3_f32 v141, v194, v195, v198
    v_max3_f32 v142, v200, v201, v204
    v_max3_f32 v143, v202, v203, v206
    v_max_f32 v136, v136, v181
    v_max_f32 v137, v137, v183
    v_max_f32 v138, v138, v189
    v_max_f32 v139, v139, v191
    v_max_f32 v140, v140, v197
    v_max_f32 v141, v141, v199
    v_max_f32 v142, v142, v205
    v_max_f32 v143, v143, v207
    v_max_f32 v144, v136, v137
    v_max_f32 v145, v138, v139
    v_max_f32 v146, v140, v141
    v_max_f32 v147, v142, v143
    v_pk_mul_f32 v[244:245], v[244:245], v[72:73]
    v_pk_mul_f32 v[246:247], v[246:247], v[72:73]
    v_permlane32_swap_b32 v144, v145
    v_permlane32_swap_b32 v146, v147
    v_pk_fma_f32 v[156:157], v[156:157], v[208:209], v[228:229] neg_lo:[0,0,1] neg_hi:[0,0,1]
    v_max_f32 v144, v144, v145
    v_max_f32 v146, v146, v147
    v_pk_fma_f32 v[158:159], v[158:159], v[210:211], v[230:231] neg_lo:[0,0,1] neg_hi:[0,0,1]
    v_pk_fma_f32 v[160:161], v[160:161], v[212:213], v[232:233] neg_lo:[0,0,1] neg_hi:[0,0,1]
    v_permlane16_swap_b32 v144, v146
    v_pk_fma_f32 v[162:163], v[162:163], v[214:215], v[234:235] neg_lo:[0,0,1] neg_hi:[0,0,1]
    v_max_f32 v144, v144, v146
    v_pk_fma_f32 v[164:165], v[164:165], v[216:217], v[236:237] neg_lo:[0,0,1] neg_hi:[0,0,1]
    v_mov_b32 v146, v144
    v_pk_fma_f32 v[166:167], v[166:167], v[218:219], v[238:239] neg_lo:[0,0,1] neg_hi:[0,0,1]
    v_pk_fma_f32 v[168:169], v[168:169], v[220:221], v[240:241] neg_lo:[0,0,1] neg_hi:[0,0,1]
    v_permlane16_swap_b32 v144, v146
    v_pk_fma_f32 v[170:171], v[170:171], v[222:223], v[242:243] neg_lo:[0,0,1] neg_hi:[0,0,1]
    v_mov_b32 v145, v144
    v_mov_b32 v147, v146
    v_pk_fma_f32 v[172:173], v[172:173], v[224:225], v[244:245] neg_lo:[0,0,1] neg_hi:[0,0,1]
    v_pk_fma_f32 v[174:175], v[174:175], v[226:227], v[246:247] neg_lo:[0,0,1] neg_hi:[0,0,1]
    v_permlane32_swap_b32 v144, v145
    v_permlane32_swap_b32 v146, v147
    v_cvt_pk_bf16_f32 v208, v156, v157
    v_sub_f32 v136, v136, v144
    v_sub_f32 v137, v137, v144
    v_sub_f32 v138, v138, v145
    v_sub_f32 v139, v139, v145
    v_sub_f32 v140, v140, v146
    v_sub_f32 v141, v141, v146
    v_sub_f32 v142, v142, v147
    v_sub_f32 v143, v143, v147
    v_exp_f32 v136, v136
    v_exp_f32 v137, v137
    v_exp_f32 v138, v138
    v_exp_f32 v139, v139
    v_exp_f32 v140, v140
    v_exp_f32 v141, v141
    v_exp_f32 v142, v142
    v_exp_f32 v143, v143
    .p2align 3
    v_cvt_pk_bf16_f32 v209, v158, v159
    v_cvt_pk_bf16_f32 v210, v160, v161
    v_cvt_pk_bf16_f32 v211, v162, v163
    v_cvt_pk_bf16_f32 v212, v164, v165
    v_cvt_pk_bf16_f32 v213, v166, v167
    v_cvt_pk_bf16_f32 v214, v168, v169
    v_cvt_pk_bf16_f32 v215, v170, v171
    v_cvt_pk_bf16_f32 v216, v172, v173
    v_cvt_pk_bf16_f32 v217, v174, v175
    v_cvt_pk_bf16_f32 v136, v136, v136
    v_cvt_pk_bf16_f32 v137, v137, v137
    v_cvt_pk_bf16_f32 v138, v138, v138
    v_cvt_pk_bf16_f32 v139, v139, v139
    v_cvt_pk_bf16_f32 v140, v140, v140
    v_cvt_pk_bf16_f32 v141, v141, v141
    v_cvt_pk_bf16_f32 v142, v142, v142
    v_cvt_pk_bf16_f32 v143, v143, v143
    v_and_b32 v176, v116, v136
    v_and_b32 v177, v117, v137
    v_and_b32 v178, v118, v136
    v_and_b32 v179, v119, v137
    v_and_b32 v180, v116, v138
    v_and_b32 v181, v117, v139
    v_and_b32 v182, v118, v138
    v_and_b32 v183, v119, v139
    v_and_b32 v184, v116, v140
    v_and_b32 v185, v117, v141
    v_and_b32 v186, v118, v140
    v_and_b32 v187, v119, v141
    v_and_b32 v188, v116, v142
    v_and_b32 v189, v117, v143
    v_and_b32 v190, v118, v142
    v_and_b32 v191, v119, v143
    s_lshl_b32 s56, s45, 13
    s_add_u32 s56, s56, s47
    v_mfma_f32_16x16x32_bf16 v[156:159], v[100:103], v[176:179], 0
    v_mfma_f32_16x16x32_bf16 v[160:163], v[100:103], v[180:183], 0
    v_mfma_f32_16x16x32_bf16 v[164:167], v[100:103], v[184:187], 0
    v_mfma_f32_16x16x32_bf16 v[168:171], v[100:103], v[188:191], 0
    v_mfma_f32_16x16x32_bf16 v[120:123], v[208:211], v[176:179], 0
    v_mfma_f32_16x16x32_bf16 v[124:127], v[210:213], v[180:183], 0
    v_mfma_f32_16x16x32_bf16 v[128:131], v[212:215], v[184:187], 0
    v_mfma_f32_16x16x32_bf16 v[132:135], v[214:217], v[188:191], 0
    s_add_u32 s56, s56, 0x20000
    s_add_u32 s52, s56, 4096
    s_nop 1
    v_rcp_f32 v156, v156
    v_rcp_f32 v160, v160
    v_rcp_f32 v164, v164
    v_rcp_f32 v168, v168
    s_nop 1
    .p2align 3
    v_pk_mul_f32 v[120:121], v[120:121], v[156:157] op_sel_hi:[1,0]
    v_pk_mul_f32 v[122:123], v[122:123], v[156:157] op_sel_hi:[1,0]
    v_pk_mul_f32 v[124:125], v[124:125], v[160:161] op_sel_hi:[1,0]
    v_pk_mul_f32 v[126:127], v[126:127], v[160:161] op_sel_hi:[1,0]
    v_pk_mul_f32 v[128:129], v[128:129], v[164:165] op_sel_hi:[1,0]
    v_pk_mul_f32 v[130:131], v[130:131], v[164:165] op_sel_hi:[1,0]
    v_pk_mul_f32 v[132:133], v[132:133], v[168:169] op_sel_hi:[1,0]
    v_pk_mul_f32 v[134:135], v[134:135], v[168:169] op_sel_hi:[1,0]
    v_cvt_pk_bf16_f32 v192, v120, v121
    v_cvt_pk_bf16_f32 v193, v122, v123
    v_cvt_pk_bf16_f32 v194, v124, v125
    v_cvt_pk_bf16_f32 v195, v126, v127
    v_cvt_pk_bf16_f32 v196, v128, v129
    v_cvt_pk_bf16_f32 v197, v130, v131
    v_cvt_pk_bf16_f32 v198, v132, v133
    v_cvt_pk_bf16_f32 v199, v134, v135
    v_permlane16_swap_b32 v192, v194
    v_permlane16_swap_b32 v193, v195
    v_permlane16_swap_b32 v196, v198
    v_permlane16_swap_b32 v197, v199
    s_cmp_eq_u32 s48, 1
    s_cbranch_scc1 L_sl_48
    buffer_store_dwordx4 v[192:195], v14, s[8:11], s56 offen
    buffer_store_dwordx4 v[196:199], v14, s[8:11], s52 offen
L_sb_49:
    v_mov_b32 v24, v13
    v_add_u32 v25, 0xd000, v24
    v_add_u32 v26, 0x1a000, v24
    v_xor_b32 v27, 64, v13
    v_add_u32 v28, 0xd000, v27
    v_add_u32 v29, 0x1a000, v27
    s_barrier
    ds_read_b64_tr_b16 v[216:217], v26 offset:36864
    ds_read_b64_tr_b16 v[218:219], v26 offset:38912
    ds_read_b64_tr_b16 v[220:221], v29 offset:36864
    ds_read_b64_tr_b16 v[222:223], v29 offset:38912
    ds_read_b64_tr_b16 v[224:225], v26 offset:37888
    ds_read_b64_tr_b16 v[226:227], v26 offset:39936
    ds_read_b64_tr_b16 v[228:229], v29 offset:37888
    ds_read_b64_tr_b16 v[230:231], v29 offset:39936
    v_mov_b32 v4, 9
    s_waitcnt vmcnt(0)
    s_cmp_eq_u32 s48, 1
    s_cbranch_scc1 L_sl_50
    s_mov_b64 exec, 1
    buffer_store_dword v4, v16, s[8:11], s47 offen
    s_mov_b64 exec, -1
L_sb_51:
    s_mov_b32 exec_hi, 0
    buffer_load_dword v10, v22, s[8:11], 0 offen sc1
L_poll_52:
    buffer_load_dword v11, v22, s[8:11], 0 offen sc1
    s_waitcnt vmcnt(1)
    v_cmp_gt_u32 vcc, 9, v10
    s_cbranch_vccz L_polld_53
    buffer_load_dword v10, v22, s[8:11], 0 offen sc1
    s_waitcnt vmcnt(1)
    v_cmp_gt_u32 vcc, 9, v11
    s_cbranch_vccz L_polld_53
    s_add_u32 s58, s58, 1
    s_cmp_lt_u32 s58, 0x493e0
    s_cbranch_scc1 L_poll_52
L_polld_53:
    s_mov_b32 exec_hi, -1
    s_add_u32 s57, s47, 0x20000
    buffer_load_dwordx4 v[120:123], v23, s[8:11], s57 offen offset:0 sc1
    buffer_load_dwordx4 v[124:127], v23, s[8:11], s57 offen offset:512 sc1
    s_add_u32 s57, s47, 0x22000
    buffer_load_dwordx4 v[128:131], v23, s[8:11], s57 offen offset:0 sc1
    buffer_load_dwordx4 v[132:135], v23, s[8:11], s57 offen offset:512 sc1
    s_add_u32 s57, s47, 0x24000
    buffer_load_dwordx4 v[136:139], v23, s[8:11], s57 offen offset:0 sc1
    buffer_load_dwordx4 v[140:143], v23, s[8:11], s57 offen offset:512 sc1
    s_add_u32 s57, s47, 0x26000
    buffer_load_dwordx4 v[144:147], v23, s[8:11], s57 offen offset:0 sc1
    buffer_load_dwordx4 v[148:151], v23, s[8:11], s57 offen offset:512 sc1
    s_waitcnt vmcnt(6)
    s_waitcnt lgkmcnt(4)
    v_mfma_f32_32x32x16_bf16 v[48:63], v[216:219], v[120:123], v[48:63]
    s_add_u32 s57, s47, 0x28000
    buffer_load_dwordx4 v[152:155], v23, s[8:11], s57 offen offset:0 sc1
    ds_read_b64_tr_b16 v[232:233], v26 offset:45056
    ds_read_b64_tr_b16 v[234:235], v26 offset:47104
    v_mfma_f32_32x32x16_bf16 v[200:215], v[220:223], v[120:123], 0
    ds_read_b64_tr_b16 v[236:237], v29 offset:45056
    ds_read_b64_tr_b16 v[238:239], v29 offset:47104
    buffer_load_dwordx4 v[156:159], v23, s[8:11], s57 offen offset:512 sc1
    s_waitcnt lgkmcnt(4)
    v_mfma_f32_32x32x16_bf16 v[48:63], v[224:227], v[124:127], v[48:63]
    ds_read_b64_tr_b16 v[240:241], v26 offset:46080
    ds_read_b64_tr_b16 v[242:243], v26 offset:48128
    v_mfma_f32_32x32x16_bf16 v[200:215], v[228:231], v[124:127], v[200:215]
    ds_read_b64_tr_b16 v[244:245], v29 offset:46080
    ds_read_b64_tr_b16 v[246:247], v29 offset:48128
    s_waitcnt vmcnt(6)
    s_waitcnt lgkmcnt(4)
    v_mfma_f32_32x32x16_bf16 v[48:63], v[232:235], v[128:131], v[48:63]
    s_add_u32 s57, s47, 0x2a000
    buffer_load_dwordx4 v[120:123], v23, s[8:11], s57 offen offset:0 sc1
    buffer_load_dwordx4 v[124:127], v23, s[8:11], s57 offen offset:512 sc1
    v_mfma_f32_32x32x16_bf16 v[200:215], v[236:239], v[128:131], v[200:215]
    s_waitcnt lgkmcnt(0)
    s_barrier
    ds_read_b64_tr_b16 v[216:217], v24 offset:0
    ds_read_b64_tr_b16 v[218:219], v24 offset:2048
    v_mfma_f32_32x32x16_bf16 v[48:63], v[240:243], v[132:135], v[48:63]
    ds_read_b64_tr_b16 v[220:221], v27 offset:0
    ds_read_b64_tr_b16 v[222:223], v27 offset:2048
    ds_read_b64_tr_b16 v[224:225], v24 offset:1024
    v_mfma_f32_32x32x16_bf16 v[200:215], v[244:247], v[132:135], v[200:215]
    ds_read_b64_tr_b16 v[226:227], v24 offset:3072
    ds_read_b64_tr_b16 v[228:229], v27 offset:1024
    ds_read_b64_tr_b16 v[230:231], v27 offset:3072
    s_waitcnt vmcnt(6)
    s_waitcnt lgkmcnt(4)
    v_mfma_f32_32x32x16_bf16 v[48:63], v[216:219], v[136:139], v[48:63]
    s_add_u32 s57, s47, 0x2c000
    buffer_load_dwordx4 v[128:131], v23, s[8:11], s57 offen offset:0 sc1
    ds_read_b64_tr_b16 v[232:233], v24 offset:8192
    ds_read_b64_tr_b16 v[234:235], v24 offset:10240
    v_mfma_f32_32x32x16_bf16 v[200:215], v[220:223], v[136:139], v[200:215]
    ds_read_b64_tr_b16 v[236:237], v27 offset:8192
    ds_read_b64_tr_b16 v[238:239], v27 offset:10240
    buffer_load_dwordx4 v[132:135], v23, s[8:11], s57 offen offset:512 sc1
    s_waitcnt lgkmcnt(4)
    v_mfma_f32_32x32x16_bf16 v[48:63], v[224:227], v[140:143], v[48:63]
    ds_read_b64_tr_b16 v[240:241], v24 offset:9216
    ds_read_b64_tr_b16 v[242:243], v24 offset:11264
    v_mfma_f32_32x32x16_bf16 v[200:215], v[228:231], v[140:143], v[200:215]
    ds_read_b64_tr_b16 v[244:245], v27 offset:9216
    ds_read_b64_tr_b16 v[246:247], v27 offset:11264
    s_waitcnt vmcnt(6)
    s_waitcnt lgkmcnt(4)
    v_mfma_f32_32x32x16_bf16 v[48:63], v[232:235], v[144:147], v[48:63]
    s_add_u32 s57, s47, 0x2e000
    buffer_load_dwordx4 v[136:139], v23, s[8:11], s57 offen offset:0 sc1
    buffer_load_dwordx4 v[140:143], v23, s[8:11], s57 offen offset:512 sc1
    v_mfma_f32_32x32x16_bf16 v[200:215], v[236:239], v[144:147], v[200:215]
    s_waitcnt lgkmcnt(0)
    s_barrier
    ds_read_b64_tr_b16 v[216:217], v24 offset:16384
    ds_read_b64_tr_b16 v[218:219], v24 offset:18432
    v_mfma_f32_32x32x16_bf16 v[48:63], v[240:243], v[148:151], v[48:63]
    ds_read_b64_tr_b16 v[220:221], v27 offset:16384
    ds_read_b64_tr_b16 v[222:223], v27 offset:18432
    ds_read_b64_tr_b16 v[224:225], v24 offset:17408
    v_mfma_f32_32x32x16_bf16 v[200:215], v[244:247], v[148:151], v[200:215]
    ds_read_b64_tr_b16 v[226:227], v24 offset:19456
    ds_read_b64_tr_b16 v[228:229], v27 offset:17408
    ds_read_b64_tr_b16 v[230:231], v27 offset:19456
    s_waitcnt vmcnt(6)
    s_waitcnt lgkmcnt(4)
    v_mfma_f32_32x32x16_bf16 v[48:63], v[216:219], v[152:155], v[48:63]
    ds_read_b64_tr_b16 v[232:233], v24 offset:24576
    ds_read_b64_tr_b16 v[234:235], v24 offset:26624
    v_mfma_f32_32x32x16_bf16 v[200:215], v[220:223], v[152:155], v[200:215]
    ds_read_b64_tr_b16 v[236:237], v27 offset:24576
    ds_read_b64_tr_b16 v[238:239], v27 offset:26624
    s_waitcnt lgkmcnt(4)
    v_mfma_f32_32x32x16_bf16 v[48:63], v[224:227], v[156:159], v[48:63]
    ds_read_b64_tr_b16 v[240:241], v24 offset:25600
    ds_read_b64_tr_b16 v[242:243], v24 offset:27648
    v_mfma_f32_32x32x16_bf16 v[200:215], v[228:231], v[156:159], v[200:215]
    ds_read_b64_tr_b16 v[244:245], v27 offset:25600
    ds_read_b64_tr_b16 v[246:247], v27 offset:27648
    s_waitcnt vmcnt(4)
    s_waitcnt lgkmcnt(4)
    v_mfma_f32_32x32x16_bf16 v[48:63], v[232:235], v[120:123], v[48:63]
    v_mfma_f32_32x32x16_bf16 v[200:215], v[236:239], v[120:123], v[200:215]
    s_waitcnt lgkmcnt(0)
    s_barrier
    ds_read_b64_tr_b16 v[216:217], v24 offset:32768
    ds_read_b64_tr_b16 v[218:219], v24 offset:34816
    v_mfma_f32_32x32x16_bf16 v[48:63], v[240:243], v[124:127], v[48:63]
    ds_read_b64_tr_b16 v[220:221], v27 offset:32768
    ds_read_b64_tr_b16 v[222:223], v27 offset:34816
    ds_read_b64_tr_b16 v[224:225], v24 offset:33792
    v_mfma_f32_32x32x16_bf16 v[200:215], v[244:247], v[124:127], v[200:215]
    ds_read_b64_tr_b16 v[226:227], v24 offset:35840
    ds_read_b64_tr_b16 v[228:229], v27 offset:33792
    ds_read_b64_tr_b16 v[230:231], v27 offset:35840
    s_waitcnt vmcnt(2)
    s_waitcnt lgkmcnt(4)
    v_mfma_f32_32x32x16_bf16 v[48:63], v[216:219], v[128:131], v[48:63]
    ds_read_b64_tr_b16 v[236:237], v27 offset:40960
    ds_read_b64_tr_b16 v[238:239], v27 offset:43008
    v_mfma_f32_32x32x16_bf16 v[200:215], v[220:223], v[128:131], v[200:215]
    ds_read_b64_tr_b16 v[244:245], v27 offset:41984
    ds_read_b64_tr_b16 v[246:247], v27 offset:44032
    s_waitcnt lgkmcnt(4)
    v_mfma_f32_32x32x16_bf16 v[48:63], v[224:227], v[132:135], v[48:63]
    ds_read_b64_tr_b16 v[232:233], v24 offset:40960
    ds_read_b64_tr_b16 v[234:235], v24 offset:43008
    v_mfma_f32_32x32x16_bf16 v[200:215], v[228:231], v[132:135], v[200:215]
    ds_read_b64_tr_b16 v[240:241], v24 offset:41984
    ds_read_b64_tr_b16 v[242:243], v24 offset:44032
    s_waitcnt vmcnt(0)
    s_waitcnt lgkmcnt(4)
    v_mfma_f32_32x32x16_bf16 v[200:215], v[236:239], v[136:139], v[200:215]
    v_mfma_f32_32x32x16_bf16 v[200:215], v[244:247], v[140:143], v[200:215]
    s_cmp_lt_u32 s46, 2
    s_mov_b32 s53, 0x1a000
    s_cselect_b32 s53, 0x12000, s53
    s_lshl_b32 s52, s51, 12
    v_lshlrev_b32 v9, 4, v0
    v_add_u32 v9, s53, v9
    s_waitcnt lgkmcnt(0)
    v_mfma_f32_32x32x16_bf16 v[48:63], v[232:235], v[136:139], v[48:63]
    v_add_u32 v8, s52, v9
    s_xor_b32 s52, s52, 0x1000
    v_add_u32 v9, s52, v9
    v_mfma_f32_32x32x16_bf16 v[48:63], v[240:243], v[140:143], v[48:63]
    s_nop 0
    ds_write_b128 v8, v[200:203] offset:0
    ds_write_b128 v8, v[204:207] offset:1024
    ds_write_b128 v8, v[208:211] offset:2048
    ds_write_b128 v8, v[212:215] offset:3072
    s_waitcnt lgkmcnt(0)
    s_barrier
    ds_read_b128 v[200:203], v9 offset:0
    ds_read_b128 v[204:207], v9 offset:1024
    ds_read_b128 v[208:211], v9 offset:2048
    ds_read_b128 v[212:215], v9 offset:3072
    s_lshl_b32 s56, s45, 13
    s_add_u32 s56, s56, s47
    s_add_u32 s56, s56, 0x10000
    s_add_u32 s53, s47, 0x1000
    s_waitcnt lgkmcnt(3)
    v_pk_add_f32 v[48:49], v[48:49], v[200:201]
    v_pk_add_f32 v[50:51], v[50:51], v[202:203]
    s_waitcnt lgkmcnt(2)
    v_pk_add_f32 v[52:53], v[52:53], v[204:205]
    v_pk_add_f32 v[54:55], v[54:55], v[206:207]
    s_waitcnt lgkmcnt(1)
    v_pk_add_f32 v[56:57], v[56:57], v[208:209]
    v_pk_add_f32 v[58:59], v[58:59], v[210:211]
    s_waitcnt lgkmcnt(0)
    .p2align 3
    v_pk_add_f32 v[60:61], v[60:61], v[212:213]
    v_pk_add_f32 v[62:63], v[62:63], v[214:215]
    v_cvt_pk_bf16_f32 v184, v48, v49
    v_cvt_pk_bf16_f32 v185, v50, v51
    v_cvt_pk_bf16_f32 v186, v52, v53
    v_cvt_pk_bf16_f32 v187, v54, v55
    v_cvt_pk_bf16_f32 v188, v56, v57
    v_cvt_pk_bf16_f32 v189, v58, v59
    v_cvt_pk_bf16_f32 v190, v60, v61
    v_cvt_pk_bf16_f32 v191, v62, v63
    v_permlane32_swap_b32 v184, v186
    v_permlane32_swap_b32 v185, v187
    v_permlane32_swap_b32 v188, v190
    v_permlane32_swap_b32 v189, v191
    s_cmp_eq_u32 s48, 1
    s_cbranch_scc1 L_sl_54
    buffer_store_dwordx4 v[184:187], v23, s[8:11], s56 offen offset:0
    buffer_store_dwordx4 v[188:191], v23, s[8:11], s56 offen offset:512
L_sb_55:
    .p2align 3
    v_pk_add_f32 v[192:193], v[48:49], v[50:51]
    v_pk_mul_f32 v[194:195], v[48:49], v[48:49]
    v_pk_add_f32 v[196:197], v[56:57], v[58:59]
    v_pk_mul_f32 v[198:199], v[56:57], v[56:57]
    v_pk_fma_f32 v[194:195], v[50:51], v[50:51], v[194:195]
    v_pk_fma_f32 v[198:199], v[58:59], v[58:59], v[198:199]
    v_pk_add_f32 v[192:193], v[192:193], v[52:53]
    v_pk_fma_f32 v[194:195], v[52:53], v[52:53], v[194:195]
    v_pk_add_f32 v[196:197], v[196:197], v[60:61]
    v_pk_fma_f32 v[198:199], v[60:61], v[60:61], v[198:199]
    v_pk_add_f32 v[192:193], v[192:193], v[54:55]
    v_pk_fma_f32 v[194:195], v[54:55], v[54:55], v[194:195]
    v_pk_add_f32 v[196:197], v[196:197], v[62:63]
    v_pk_fma_f32 v[198:199], v[62:63], v[62:63], v[198:199]
    v_pk_add_f32 v[192:193], v[192:193], v[196:197]
    v_pk_add_f32 v[194:195], v[194:195], v[198:199]
    v_add_f32 v192, v192, v193
    v_add_f32 v194, v194, v195
    s_nop 1
    v_permlane32_swap_b32 v192, v194
    v_add_f32 v192, v192, v194
    s_cmp_eq_u32 s48, 1
    s_cbranch_scc1 L_sl_56
    buffer_store_dword v192, v19, s[8:11], s53 offen
L_sb_57:
    s_barrier
    v_mov_b32 v24, v12
    v_add_u32 v25, 0xd000, v24
    v_add_u32 v26, 0x1a000, v24
    v_lshlrev_b32 v27, 4, v0
    v_add_u32 v28, 0xd000, v27
    v_add_u32 v29, 0x1a000, v27
    v_mov_b32 v4, 11
    s_waitcnt vmcnt(0)
    s_cmp_eq_u32 s48, 1
    s_cbranch_scc1 L_sl_58
    s_mov_b64 exec, 1
    buffer_store_dword v4, v16, s[8:11], s47 offen
    s_mov_b64 exec, -1
L_sb_59:
    s_barrier
    s_barrier
    ds_read_b128 v[188:191], v28 offset:20480
    ds_read_b64_tr_b16 v[176:177], v24 offset:49152
    ds_read_b64_tr_b16 v[178:179], v24 offset:51200
    ds_read_b64_tr_b16 v[180:181], v25 offset:0
    ds_read_b64_tr_b16 v[182:183], v25 offset:2048
    ds_read_b64_tr_b16 v[184:185], v25 offset:4096
    ds_read_b64_tr_b16 v[186:187], v25 offset:6144
    ds_read_b128 v[192:195], v28 offset:22528
    ds_read_b128 v[196:199], v28 offset:24576
    ds_read_b128 v[200:203], v28 offset:26624
    s_waitcnt lgkmcnt(3)
    v_mfma_f32_16x16x32_bf16 v[120:123], v[176:179], v[188:191], 0
    ds_read_b128 v[224:227], v28 offset:21504
    v_mfma_f32_16x16x32_bf16 v[136:139], v[180:183], v[188:191], 0
    ds_read_b64_tr_b16 v[212:213], v25 offset:8192
    v_mfma_f32_16x16x32_bf16 v[152:155], v[184:187], v[188:191], 0
    ds_read_b64_tr_b16 v[214:215], v25 offset:10240
    s_waitcnt lgkmcnt(4)
    v_mfma_f32_16x16x32_bf16 v[124:127], v[176:179], v[192:195], 0
    ds_read_b64_tr_b16 v[216:217], v25 offset:12288
    v_mfma_f32_16x16x32_bf16 v[140:143], v[180:183], v[192:195], 0
    ds_read_b64_tr_b16 v[218:219], v25 offset:14336
    v_mfma_f32_16x16x32_bf16 v[156:159], v[184:187], v[192:195], 0
    ds_read_b64_tr_b16 v[220:221], v25 offset:16384
    v_mfma_f32_16x16x32_bf16 v[128:131], v[176:179], v[196:199], 0
    ds_read_b64_tr_b16 v[222:223], v25 offset:18432
    v_mfma_f32_16x16x32_bf16 v[144:147], v[180:183], v[196:199], 0
    ds_read_b128 v[228:231], v28 offset:23552
    v_mfma_f32_16x16x32_bf16 v[160:163], v[184:187], v[196:199], 0
    ds_read_b128 v[232:235], v28 offset:25600
    s_waitcnt lgkmcnt(9)
    v_mfma_f32_16x16x32_bf16 v[132:135], v[176:179], v[200:203], 0
    ds_read_b128 v[236:239], v28 offset:27648
    v_mfma_f32_16x16x32_bf16 v[148:151], v[180:183], v[200:203], 0
    v_mfma_f32_16x16x32_bf16 v[164:167], v[184:187], v[200:203], 0
    s_waitcnt lgkmcnt(3)
    v_mfma_f32_16x16x32_bf16 v[120:123], v[212:215], v[224:227], v[120:123]
    v_mfma_f32_16x16x32_bf16 v[136:139], v[216:219], v[224:227], v[136:139]
    v_mfma_f32_16x16x32_bf16 v[152:155], v[220:223], v[224:227], v[152:155]
    s_waitcnt lgkmcnt(0)
    s_barrier
    ds_read_b128 v[188:191], v29 offset:0
    v_mfma_f32_16x16x32_bf16 v[124:127], v[212:215], v[228:231], v[124:127]
    ds_read_b64_tr_b16 v[176:177], v25 offset:28672
    v_mfma_f32_16x16x32_bf16 v[140:143], v[216:219], v[228:231], v[140:143]
    ds_read_b64_tr_b16 v[178:179], v25 offset:30720
    v_mfma_f32_16x16x32_bf16 v[156:159], v[220:223], v[228:231], v[156:159]
    ds_read_b64_tr_b16 v[180:181], v25 offset:32768
    v_mfma_f32_16x16x32_bf16 v[128:131], v[212:215], v[232:235], v[128:131]
    ds_read_b64_tr_b16 v[182:183], v25 offset:34816
    v_mfma_f32_16x16x32_bf16 v[144:147], v[216:219], v[232:235], v[144:147]
    ds_read_b64_tr_b16 v[184:185], v25 offset:36864
    v_mfma_f32_16x16x32_bf16 v[160:163], v[220:223], v[232:235], v[160:163]
    ds_read_b64_tr_b16 v[186:187], v25 offset:38912
    v_mfma_f32_16x16x32_bf16 v[132:135], v[212:215], v[236:239], v[132:135]
    ds_read_b128 v[192:195], v29 offset:2048
    v_mfma_f32_16x16x32_bf16 v[148:151], v[216:219], v[236:239], v[148:151]
    ds_read_b128 v[196:199], v29 offset:4096
    v_mfma_f32_16x16x32_bf16 v[164:167], v[220:223], v[236:239], v[164:167]
    ds_read_b128 v[200:203], v29 offset:6144
    s_waitcnt lgkmcnt(3)
    v_mfma_f32_16x16x32_bf16 v[120:123], v[176:179], v[188:191], v[120:123]
    ds_read_b128 v[224:227], v29 offset:1024
    v_mfma_f32_16x16x32_bf16 v[136:139], v[180:183], v[188:191], v[136:139]
    ds_read_b64_tr_b16 v[212:213], v25 offset:40960
    v_mfma_f32_16x16x32_bf16 v[152:155], v[184:187], v[188:191], v[152:155]
    ds_read_b64_tr_b16 v[214:215], v25 offset:43008
    s_waitcnt lgkmcnt(4)
    v_mfma_f32_16x16x32_bf16 v[124:127], v[176:179], v[192:195], v[124:127]
    ds_read_b64_tr_b16 v[216:217], v25 offset:45056
    v_mfma_f32_16x16x32_bf16 v[140:143], v[180:183], v[192:195], v[140:143]
    ds_read_b64_tr_b16 v[218:219], v25 offset:47104
    v_mfma_f32_16x16x32_bf16 v[156:159], v[184:187], v[192:195], v[156:159]
    ds_read_b64_tr_b16 v[220:221], v25 offset:49152
    v_mfma_f32_16x16x32_bf16 v[128:131], v[176:179], v[196:199], v[128:131]
    ds_read_b64_tr_b16 v[222:223], v25 offset:51200
    v_mfma_f32_16x16x32_bf16 v[144:147], v[180:183], v[196:199], v[144:147]
    ds_read_b128 v[228:231], v29 offset:3072
    v_mfma_f32_16x16x32_bf16 v[160:163], v[184:187], v[196:199], v[160:163]
    ds_read_b128 v[232:235], v29 offset:5120
    s_waitcnt lgkmcnt(9)
    v_mfma_f32_16x16x32_bf16 v[132:135], v[176:179], v[200:203], v[132:135]
    ds_read_b128 v[236:239], v29 offset:7168
    v_mfma_f32_16x16x32_bf16 v[148:151], v[180:183], v[200:203], v[148:151]
    v_mfma_f32_16x16x32_bf16 v[164:167], v[184:187], v[200:203], v[164:167]
    s_waitcnt lgkmcnt(3)
    v_mfma_f32_16x16x32_bf16 v[120:123], v[212:215], v[224:227], v[120:123]
    v_mfma_f32_16x16x32_bf16 v[136:139], v[216:219], v[224:227], v[136:139]
    v_mfma_f32_16x16x32_bf16 v[152:155], v[220:223], v[224:227], v[152:155]
    s_waitcnt lgkmcnt(0)
    s_barrier
    ds_read_b128 v[188:191], v29 offset:32768
    v_mfma_f32_16x16x32_bf16 v[124:127], v[212:215], v[228:231], v[124:127]
    ds_read_b64_tr_b16 v[176:177], v26 offset:8192
    v_mfma_f32_16x16x32_bf16 v[140:143], v[216:219], v[228:231], v[140:143]
    ds_read_b64_tr_b16 v[178:179], v26 offset:10240
    v_mfma_f32_16x16x32_bf16 v[156:159], v[220:223], v[228:231], v[156:159]
    ds_read_b64_tr_b16 v[180:181], v26 offset:12288
    v_mfma_f32_16x16x32_bf16 v[128:131], v[212:215], v[232:235], v[128:131]
    ds_read_b64_tr_b16 v[182:183], v26 offset:14336
    v_mfma_f32_16x16x32_bf16 v[144:147], v[216:219], v[232:235], v[144:147]
    ds_read_b64_tr_b16 v[184:185], v26 offset:16384
    v_mfma_f32_16x16x32_bf16 v[160:163], v[220:223], v[232:235], v[160:163]
    ds_read_b64_tr_b16 v[186:187], v26 offset:18432
    v_mfma_f32_16x16x32_bf16 v[132:135], v[212:215], v[236:239], v[132:135]
    ds_read_b128 v[192:195], v29 offset:34816
    v_mfma_f32_16x16x32_bf16 v[148:151], v[216:219], v[236:239], v[148:151]
    ds_read_b128 v[196:199], v29 offset:36864
    v_mfma_f32_16x16x32_bf16 v[164:167], v[220:223], v[236:239], v[164:167]
    ds_read_b128 v[200:203], v29 offset:38912
    s_waitcnt lgkmcnt(3)
    v_mfma_f32_16x16x32_bf16 v[120:123], v[176:179], v[188:191], v[120:123]
    ds_read_b128 v[224:227], v29 offset:33792
    v_mfma_f32_16x16x32_bf16 v[136:139], v[180:183], v[188:191], v[136:139]
    ds_read_b64_tr_b16 v[212:213], v26 offset:20480
    v_mfma_f32_16x16x32_bf16 v[152:155], v[184:187], v[188:191], v[152:155]
    ds_read_b64_tr_b16 v[214:215], v26 offset:22528
    s_waitcnt lgkmcnt(4)
    v_mfma_f32_16x16x32_bf16 v[124:127], v[176:179], v[192:195], v[124:127]
    ds_read_b64_tr_b16 v[216:217], v26 offset:24576
    v_mfma_f32_16x16x32_bf16 v[140:143], v[180:183], v[192:195], v[140:143]
    ds_read_b64_tr_b16 v[218:219], v26 offset:26624
    v_mfma_f32_16x16x32_bf16 v[156:159], v[184:187], v[192:195], v[156:159]
    ds_read_b64_tr_b16 v[220:221], v26 offset:28672
    v_mfma_f32_16x16x32_bf16 v[128:131], v[176:179], v[196:199], v[128:131]
    ds_read_b64_tr_b16 v[222:223], v26 offset:30720
    v_mfma_f32_16x16x32_bf16 v[144:147], v[180:183], v[196:199], v[144:147]
    ds_read_b128 v[228:231], v29 offset:35840
    v_mfma_f32_16x16x32_bf16 v[160:163], v[184:187], v[196:199], v[160:163]
    ds_read_b128 v[232:235], v29 offset:37888
    s_waitcnt lgkmcnt(9)
    v_mfma_f32_16x16x32_bf16 v[132:135], v[176:179], v[200:203], v[132:135]
    ds_read_b128 v[236:239], v29 offset:39936
    v_mfma_f32_16x16x32_bf16 v[148:151], v[180:183], v[200:203], v[148:151]
    v_mfma_f32_16x16x32_bf16 v[164:167], v[184:187], v[200:203], v[164:167]
    s_waitcnt lgkmcnt(3)
    v_mfma_f32_16x16x32_bf16 v[120:123], v[212:215], v[224:227], v[120:123]
    v_mfma_f32_16x16x32_bf16 v[136:139], v[216:219], v[224:227], v[136:139]
    v_mfma_f32_16x16x32_bf16 v[152:155], v[220:223], v[224:227], v[152:155]
    s_waitcnt lgkmcnt(0)
    s_barrier
    ds_read_b128 v[188:191], v27 offset:12288
    v_mfma_f32_16x16x32_bf16 v[124:127], v[212:215], v[228:231], v[124:127]
    ds_read_b64_tr_b16 v[176:177], v26 offset:40960
    v_mfma_f32_16x16x32_bf16 v[140:143], v[216:219], v[228:231], v[140:143]
    ds_read_b64_tr_b16 v[178:179], v26 offset:43008
    v_mfma_f32_16x16x32_bf16 v[156:159], v[220:223], v[228:231], v[156:159]
    ds_read_b64_tr_b16 v[180:181], v26 offset:45056
    v_mfma_f32_16x16x32_bf16 v[128:131], v[212:215], v[232:235], v[128:131]
    ds_read_b64_tr_b16 v[182:183], v26 offset:47104
    v_mfma_f32_16x16x32_bf16 v[144:147], v[216:219], v[232:235], v[144:147]
    ds_read_b64_tr_b16 v[184:185], v26 offset:49152
    v_mfma_f32_16x16x32_bf16 v[160:163], v[220:223], v[232:235], v[160:163]
    ds_read_b64_tr_b16 v[186:187], v26 offset:51200
    v_mfma_f32_16x16x32_bf16 v[132:135], v[212:215], v[236:239], v[132:135]
    ds_read_b128 v[192:195], v27 offset:14336
    v_mfma_f32_16x16x32_bf16 v[148:151], v[216:219], v[236:239], v[148:151]
    ds_read_b128 v[196:199], v27 offset:16384
    v_mfma_f32_16x16x32_bf16 v[164:167], v[220:223], v[236:239], v[164:167]
    ds_read_b128 v[200:203], v27 offset:18432
    s_waitcnt lgkmcnt(3)
    v_mfma_f32_16x16x32_bf16 v[120:123], v[176:179], v[188:191], v[120:123]
    ds_read_b128 v[224:227], v27 offset:13312
    v_mfma_f32_16x16x32_bf16 v[136:139], v[180:183], v[188:191], v[136:139]
    ds_read_b64_tr_b16 v[212:213], v24 offset:0
    v_mfma_f32_16x16x32_bf16 v[152:155], v[184:187], v[188:191], v[152:155]
    ds_read_b64_tr_b16 v[214:215], v24 offset:2048
    s_waitcnt lgkmcnt(4)
    v_mfma_f32_16x16x32_bf16 v[124:127], v[176:179], v[192:195], v[124:127]
    ds_read_b64_tr_b16 v[216:217], v24 offset:4096
    v_mfma_f32_16x16x32_bf16 v[140:143], v[180:183], v[192:195], v[140:143]
    ds_read_b64_tr_b16 v[218:219], v24 offset:6144
    v_mfma_f32_16x16x32_bf16 v[156:159], v[184:187], v[192:195], v[156:159]
    ds_read_b64_tr_b16 v[220:221], v24 offset:8192
    v_mfma_f32_16x16x32_bf16 v[128:131], v[176:179], v[196:199], v[128:131]
    ds_read_b64_tr_b16 v[222:223], v24 offset:10240
    v_mfma_f32_16x16x32_bf16 v[144:147], v[180:183], v[196:199], v[144:147]
    ds_read_b128 v[228:231], v27 offset:15360
    v_mfma_f32_16x16x32_bf16 v[160:163], v[184:187], v[196:199], v[160:163]
    ds_read_b128 v[232:235], v27 offset:17408
    s_waitcnt lgkmcnt(9)
    v_mfma_f32_16x16x32_bf16 v[132:135], v[176:179], v[200:203], v[132:135]
    ds_read_b128 v[236:239], v27 offset:19456
    v_mfma_f32_16x16x32_bf16 v[148:151], v[180:183], v[200:203], v[148:151]
    v_mfma_f32_16x16x32_bf16 v[164:167], v[184:187], v[200:203], v[164:167]
    s_waitcnt lgkmcnt(3)
    v_mfma_f32_16x16x32_bf16 v[120:123], v[212:215], v[224:227], v[120:123]
    v_mfma_f32_16x16x32_bf16 v[136:139], v[216:219], v[224:227], v[136:139]
    v_mfma_f32_16x16x32_bf16 v[152:155], v[220:223], v[224:227], v[152:155]
    s_waitcnt lgkmcnt(0)
    s_barrier
    ds_read_b128 v[188:191], v27 offset:45056
    v_mfma_f32_16x16x32_bf16 v[124:127], v[212:215], v[228:231], v[124:127]
    ds_read_b64_tr_b16 v[176:177], v24 offset:20480
    v_mfma_f32_16x16x32_bf16 v[140:143], v[216:219], v[228:231], v[140:143]
    ds_read_b64_tr_b16 v[178:179], v24 offset:22528
    v_mfma_f32_16x16x32_bf16 v[156:159], v[220:223], v[228:231], v[156:159]
    ds_read_b64_tr_b16 v[180:181], v24 offset:24576
    v_mfma_f32_16x16x32_bf16 v[128:131], v[212:215], v[232:235], v[128:131]
    ds_read_b64_tr_b16 v[182:183], v24 offset:26624
    v_mfma_f32_16x16x32_bf16 v[144:147], v[216:219], v[232:235], v[144:147]
    ds_read_b64_tr_b16 v[184:185], v24 offset:28672
    v_mfma_f32_16x16x32_bf16 v[160:163], v[220:223], v[232:235], v[160:163]
    ds_read_b64_tr_b16 v[186:187], v24 offset:30720
    v_mfma_f32_16x16x32_bf16 v[132:135], v[212:215], v[236:239], v[132:135]
    ds_read_b128 v[192:195], v27 offset:47104
    v_mfma_f32_16x16x32_bf16 v[148:151], v[216:219], v[236:239], v[148:151]
    ds_read_b128 v[196:199], v27 offset:49152
    v_mfma_f32_16x16x32_bf16 v[164:167], v[220:223], v[236:239], v[164:167]
    ds_read_b128 v[200:203], v27 offset:51200
    s_waitcnt lgkmcnt(3)
    v_mfma_f32_16x16x32_bf16 v[120:123], v[176:179], v[188:191], v[120:123]
    ds_read_b128 v[224:227], v27 offset:46080
    v_mfma_f32_16x16x32_bf16 v[136:139], v[180:183], v[188:191], v[136:139]
    ds_read_b64_tr_b16 v[212:213], v24 offset:32768
    v_mfma_f32_16x16x32_bf16 v[152:155], v[184:187], v[188:191], v[152:155]
    ds_read_b64_tr_b16 v[214:215], v24 offset:34816
    s_waitcnt lgkmcnt(4)
    v_mfma_f32_16x16x32_bf16 v[124:127], v[176:179], v[192:195], v[124:127]
    ds_read_b64_tr_b16 v[216:217], v24 offset:36864
    v_mfma_f32_16x16x32_bf16 v[140:143], v[180:183], v[192:195], v[140:143]
    ds_read_b64_tr_b16 v[218:219], v24 offset:38912
    v_mfma_f32_16x16x32_bf16 v[156:159], v[184:187], v[192:195], v[156:159]
    ds_read_b64_tr_b16 v[220:221], v24 offset:40960
    v_mfma_f32_16x16x32_bf16 v[128:131], v[176:179], v[196:199], v[128:131]
    ds_read_b64_tr_b16 v[222:223], v24 offset:43008
    v_mfma_f32_16x16x32_bf16 v[144:147], v[180:183], v[196:199], v[144:147]
    ds_read_b128 v[228:231], v27 offset:48128
    v_mfma_f32_16x16x32_bf16 v[160:163], v[184:187], v[196:199], v[160:163]
    ds_read_b128 v[232:235], v27 offset:50176
    s_waitcnt lgkmcnt(9)
    v_mfma_f32_16x16x32_bf16 v[132:135], v[176:179], v[200:203], v[132:135]
    ds_read_b128 v[236:239], v27 offset:52224
    v_mfma_f32_16x16x32_bf16 v[148:151], v[180:183], v[200:203], v[148:151]
    v_mfma_f32_16x16x32_bf16 v[164:167], v[184:187], v[200:203], v[164:167]
    s_waitcnt lgkmcnt(3)
    v_mfma_f32_16x16x32_bf16 v[120:123], v[212:215], v[224:227], v[120:123]
    v_mfma_f32_16x16x32_bf16 v[136:139], v[216:219], v[224:227], v[136:139]
    v_mfma_f32_16x16x32_bf16 v[152:155], v[220:223], v[224:227], v[152:155]
    s_waitcnt lgkmcnt(0)
    s_barrier
    ds_read_b128 v[188:191], v28 offset:24576
    v_mfma_f32_16x16x32_bf16 v[124:127], v[212:215], v[228:231], v[124:127]
    ds_read_b64_tr_b16 v[176:177], v25 offset:0
    v_mfma_f32_16x16x32_bf16 v[140:143], v[216:219], v[228:231], v[140:143]
    ds_read_b64_tr_b16 v[178:179], v25 offset:2048
    v_mfma_f32_16x16x32_bf16 v[156:159], v[220:223], v[228:231], v[156:159]
    ds_read_b64_tr_b16 v[180:181], v25 offset:4096
    v_mfma_f32_16x16x32_bf16 v[128:131], v[212:215], v[232:235], v[128:131]
    ds_read_b64_tr_b16 v[182:183], v25 offset:6144
    v_mfma_f32_16x16x32_bf16 v[144:147], v[216:219], v[232:235], v[144:147]
    ds_read_b64_tr_b16 v[184:185], v25 offset:8192
    v_mfma_f32_16x16x32_bf16 v[160:163], v[220:223], v[232:235], v[160:163]
    ds_read_b64_tr_b16 v[186:187], v25 offset:10240
    v_mfma_f32_16x16x32_bf16 v[132:135], v[212:215], v[236:239], v[132:135]
    ds_read_b128 v[192:195], v28 offset:26624
    v_mfma_f32_16x16x32_bf16 v[148:151], v[216:219], v[236:239], v[148:151]
    ds_read_b128 v[196:199], v28 offset:28672
    v_mfma_f32_16x16x32_bf16 v[164:167], v[220:223], v[236:239], v[164:167]
    ds_read_b128 v[200:203], v28 offset:30720
    s_waitcnt lgkmcnt(3)
    v_mfma_f32_16x16x32_bf16 v[120:123], v[176:179], v[188:191], v[120:123]
    ds_read_b128 v[224:227], v28 offset:25600
    v_mfma_f32_16x16x32_bf16 v[136:139], v[180:183], v[188:191], v[136:139]
    ds_read_b64_tr_b16 v[212:213], v25 offset:12288
    v_mfma_f32_16x16x32_bf16 v[152:155], v[184:187], v[188:191], v[152:155]
    ds_read_b64_tr_b16 v[214:215], v25 offset:14336
    s_waitcnt lgkmcnt(4)
    v_mfma_f32_16x16x32_bf16 v[124:127], v[176:179], v[192:195], v[124:127]
    ds_read_b64_tr_b16 v[216:217], v25 offset:16384
    v_mfma_f32_16x16x32_bf16 v[140:143], v[180:183], v[192:195], v[140:143]
    ds_read_b64_tr_b16 v[218:219], v25 offset:18432
    v_mfma_f32_16x16x32_bf16 v[156:159], v[184:187], v[192:195], v[156:159]
    ds_read_b64_tr_b16 v[220:221], v25 offset:20480
    v_mfma_f32_16x16x32_bf16 v[128:131], v[176:179], v[196:199], v[128:131]
    ds_read_b64_tr_b16 v[222:223], v25 offset:22528
    v_mfma_f32_16x16x32_bf16 v[144:147], v[180:183], v[196:199], v[144:147]
    ds_read_b128 v[228:231], v28 offset:27648
    v_mfma_f32_16x16x32_bf16 v[160:163], v[184:187], v[196:199], v[160:163]
    ds_read_b128 v[232:235], v28 offset:29696
    s_waitcnt lgkmcnt(9)
    v_mfma_f32_16x16x32_bf16 v[132:135], v[176:179], v[200:203], v[132:135]
    ds_read_b128 v[236:239], v28 offset:31744
    v_mfma_f32_16x16x32_bf16 v[148:151], v[180:183], v[200:203], v[148:151]
    v_mfma_f32_16x16x32_bf16 v[164:167], v[184:187], v[200:203], v[164:167]
    s_waitcnt lgkmcnt(3)
    v_mfma_f32_16x16x32_bf16 v[120:123], v[212:215], v[224:227], v[120:123]
    v_mfma_f32_16x16x32_bf16 v[136:139], v[216:219], v[224:227], v[136:139]
    v_mfma_f32_16x16x32_bf16 v[152:155], v[220:223], v[224:227], v[152:155]
    s_waitcnt lgkmcnt(0)
    s_barrier
    ds_read_b128 v[188:191], v29 offset:4096
    v_mfma_f32_16x16x32_bf16 v[124:127], v[212:215], v[228:231], v[124:127]
    ds_read_b64_tr_b16 v[176:177], v25 offset:32768
    v_mfma_f32_16x16x32_bf16 v[140:143], v[216:219], v[228:231], v[140:143]
    ds_read_b64_tr_b16 v[178:179], v25 offset:34816
    v_mfma_f32_16x16x32_bf16 v[156:159], v[220:223], v[228:231], v[156:159]
    ds_read_b64_tr_b16 v[180:181], v25 offset:36864
    v_mfma_f32_16x16x32_bf16 v[128:131], v[212:215], v[232:235], v[128:131]
    ds_read_b64_tr_b16 v[182:183], v25 offset:38912
    v_mfma_f32_16x16x32_bf16 v[144:147], v[216:219], v[232:235], v[144:147]
    ds_read_b64_tr_b16 v[184:185], v25 offset:40960
    v_mfma_f32_16x16x32_bf16 v[160:163], v[220:223], v[232:235], v[160:163]
    ds_read_b64_tr_b16 v[186:187], v25 offset:43008
    v_mfma_f32_16x16x32_bf16 v[132:135], v[212:215], v[236:239], v[132:135]
    ds_read_b128 v[192:195], v29 offset:6144
    v_mfma_f32_16x16x32_bf16 v[148:151], v[216:219], v[236:239], v[148:151]
    ds_read_b128 v[196:199], v29 offset:8192
    v_mfma_f32_16x16x32_bf16 v[164:167], v[220:223], v[236:239], v[164:167]
    ds_read_b128 v[200:203], v29 offset:10240
    s_waitcnt lgkmcnt(3)
    v_mfma_f32_16x16x32_bf16 v[120:123], v[176:179], v[188:191], v[120:123]
    ds_read_b128 v[224:227], v29 offset:5120
    v_mfma_f32_16x16x32_bf16 v[136:139], v[180:183], v[188:191], v[136:139]
    ds_read_b64_tr_b16 v[212:213], v25 offset:45056
    v_mfma_f32_16x16x32_bf16 v[152:155], v[184:187], v[188:191], v[152:155]
    ds_read_b64_tr_b16 v[214:215], v25 offset:47104
    s_waitcnt lgkmcnt(4)
    v_mfma_f32_16x16x32_bf16 v[124:127], v[176:179], v[192:195], v[124:127]
    ds_read_b64_tr_b16 v[216:217], v25 offset:49152
    v_mfma_f32_16x16x32_bf16 v[140:143], v[180:183], v[192:195], v[140:143]
    ds_read_b64_tr_b16 v[218:219], v25 offset:51200
    v_mfma_f32_16x16x32_bf16 v[156:159], v[184:187], v[192:195], v[156:159]
    ds_read_b64_tr_b16 v[220:221], v26 offset:0
    v_mfma_f32_16x16x32_bf16 v[128:131], v[176:179], v[196:199], v[128:131]
    ds_read_b64_tr_b16 v[222:223], v26 offset:2048
    v_mfma_f32_16x16x32_bf16 v[144:147], v[180:183], v[196:199], v[144:147]
    ds_read_b128 v[228:231], v29 offset:7168
    v_mfma_f32_16x16x32_bf16 v[160:163], v[184:187], v[196:199], v[160:163]
    ds_read_b128 v[232:235], v29 offset:9216
    s_waitcnt lgkmcnt(9)
    v_mfma_f32_16x16x32_bf16 v[132:135], v[176:179], v[200:203], v[132:135]
    ds_read_b128 v[236:239], v29 offset:11264
    v_mfma_f32_16x16x32_bf16 v[148:151], v[180:183], v[200:203], v[148:151]
    v_mfma_f32_16x16x32_bf16 v[164:167], v[184:187], v[200:203], v[164:167]
    s_waitcnt lgkmcnt(3)
    v_mfma_f32_16x16x32_bf16 v[120:123], v[212:215], v[224:227], v[120:123]
    v_mfma_f32_16x16x32_bf16 v[136:139], v[216:219], v[224:227], v[136:139]
    v_mfma_f32_16x16x32_bf16 v[152:155], v[220:223], v[224:227], v[152:155]
    s_waitcnt lgkmcnt(0)
    s_barrier
    ds_read_b128 v[188:191], v29 offset:36864
    v_mfma_f32_16x16x32_bf16 v[124:127], v[212:215], v[228:231], v[124:127]
    ds_read_b64_tr_b16 v[176:177], v26 offset:12288
    v_mfma_f32_16x16x32_bf16 v[140:143], v[216:219], v[228:231], v[140:143]
    ds_read_b64_tr_b16 v[178:179], v26 offset:14336
    v_mfma_f32_16x16x32_bf16 v[156:159], v[220:223], v[228:231], v[156:159]
    ds_read_b64_tr_b16 v[180:181], v26 offset:16384
    v_mfma_f32_16x16x32_bf16 v[128:131], v[212:215], v[232:235], v[128:131]
    ds_read_b64_tr_b16 v[182:183], v26 offset:18432
    v_mfma_f32_16x16x32_bf16 v[144:147], v[216:219], v[232:235], v[144:147]
    ds_read_b64_tr_b16 v[184:185], v26 offset:20480
    v_mfma_f32_16x16x32_bf16 v[160:163], v[220:223], v[232:235], v[160:163]
    ds_read_b64_tr_b16 v[186:187], v26 offset:22528
    v_mfma_f32_16x16x32_bf16 v[132:135], v[212:215], v[236:239], v[132:135]
    ds_read_b128 v[192:195], v29 offset:38912
    v_mfma_f32_16x16x32_bf16 v[148:151], v[216:219], v[236:239], v[148:151]
    ds_read_b128 v[196:199], v29 offset:40960
    v_mfma_f32_16x16x32_bf16 v[164:167], v[220:223], v[236:239], v[164:167]
    ds_read_b128 v[200:203], v29 offset:43008
    s_waitcnt lgkmcnt(3)
    v_mfma_f32_16x16x32_bf16 v[120:123], v[176:179], v[188:191], v[120:123]
    ds_read_b128 v[224:227], v29 offset:37888
    v_mfma_f32_16x16x32_bf16 v[136:139], v[180:183], v[188:191], v[136:139]
    ds_read_b64_tr_b16 v[212:213], v26 offset:24576
    v_mfma_f32_16x16x32_bf16 v[152:155], v[184:187], v[188:191], v[152:155]
    ds_read_b64_tr_b16 v[214:215], v26 offset:26624
    s_waitcnt lgkmcnt(4)
    v_mfma_f32_16x16x32_bf16 v[124:127], v[176:179], v[192:195], v[124:127]
    ds_read_b64_tr_b16 v[216:217], v26 offset:28672
    v_mfma_f32_16x16x32_bf16 v[140:143], v[180:183], v[192:195], v[140:143]
    ds_read_b64_tr_b16 v[218:219], v26 offset:30720
    v_mfma_f32_16x16x32_bf16 v[156:159], v[184:187], v[192:195], v[156:159]
    ds_read_b64_tr_b16 v[220:221], v26 offset:32768
    v_mfma_f32_16x16x32_bf16 v[128:131], v[176:179], v[196:199], v[128:131]
    ds_read_b64_tr_b16 v[222:223], v26 offset:34816
    v_mfma_f32_16x16x32_bf16 v[144:147], v[180:183], v[196:199], v[144:147]
    ds_read_b128 v[228:231], v29 offset:39936
    v_mfma_f32_16x16x32_bf16 v[160:163], v[184:187], v[196:199], v[160:163]
    ds_read_b128 v[232:235], v29 offset:41984
    s_waitcnt lgkmcnt(9)
    v_mfma_f32_16x16x32_bf16 v[132:135], v[176:179], v[200:203], v[132:135]
    ds_read_b128 v[236:239], v29 offset:44032
    v_mfma_f32_16x16x32_bf16 v[148:151], v[180:183], v[200:203], v[148:151]
    v_mfma_f32_16x16x32_bf16 v[164:167], v[184:187], v[200:203], v[164:167]
    s_waitcnt lgkmcnt(3)
    v_mfma_f32_16x16x32_bf16 v[120:123], v[212:215], v[224:227], v[120:123]
    v_mfma_f32_16x16x32_bf16 v[136:139], v[216:219], v[224:227], v[136:139]
    v_mfma_f32_16x16x32_bf16 v[152:155], v[220:223], v[224:227], v[152:155]
    s_waitcnt lgkmcnt(0)
    s_barrier
    v_mfma_f32_16x16x32_bf16 v[124:127], v[212:215], v[228:231], v[124:127]
    ds_read2_b32 v[176:177], v17 offset0:0 offset1:16
    v_mfma_f32_16x16x32_bf16 v[140:143], v[216:219], v[228:231], v[140:143]
    ds_read2_b32 v[178:179], v17 offset0:32 offset1:48
    v_mfma_f32_16x16x32_bf16 v[156:159], v[220:223], v[228:231], v[156:159]
    ds_read2_b32 v[180:181], v17 offset0:64 offset1:80
    v_mfma_f32_16x16x32_bf16 v[128:131], v[212:215], v[232:235], v[128:131]
    ds_read2_b32 v[182:183], v17 offset0:96 offset1:112
    v_mfma_f32_16x16x32_bf16 v[144:147], v[216:219], v[232:235], v[144:147]
    v_mov_b32 v184, 0x3f317218
    v_mfma_f32_16x16x32_bf16 v[160:163], v[220:223], v[232:235], v[160:163]
    v_mov_b32 v185, 0x3f317218
    v_mfma_f32_16x16x32_bf16 v[132:135], v[212:215], v[236:239], v[132:135]
    s_mul_i32 s56, s45, 0x6000
    v_mfma_f32_16x16x32_bf16 v[148:151], v[216:219], v[236:239], v[148:151]
    s_add_u32 s56, s56, s47
    s_add_u32 s56, s56, 0x20000
    v_mfma_f32_16x16x32_bf16 v[164:167], v[220:223], v[236:239], v[164:167]
    s_waitcnt lgkmcnt(0)
    .p2align 3
    v_pk_fma_f32 v[232:233], v[88:89], v[176:177], v[76:77] op_sel:[0,1,0] op_sel_hi:[1,1,1] neg_lo:[1,0,0] neg_hi:[1,0,0]
    v_pk_fma_f32 v[234:235], v[90:91], v[176:177], v[78:79] op_sel:[0,1,0] op_sel_hi:[1,1,1] neg_lo:[1,0,0] neg_hi:[1,0,0]
    v_pk_fma_f32 v[236:237], v[88:89], v[178:179], v[76:77] op_sel:[0,1,0] op_sel_hi:[1,1,1] neg_lo:[1,0,0] neg_hi:[1,0,0]
    v_pk_fma_f32 v[238:239], v[90:91], v[178:179], v[78:79] op_sel:[0,1,0] op_sel_hi:[1,1,1] neg_lo:[1,0,0] neg_hi:[1,0,0]
    v_pk_fma_f32 v[240:241], v[88:89], v[180:181], v[76:77] op_sel:[0,1,0] op_sel_hi:[1,1,1] neg_lo:[1,0,0] neg_hi:[1,0,0]
    v_pk_fma_f32 v[242:243], v[90:91], v[180:181], v[78:79] op_sel:[0,1,0] op_sel_hi:[1,1,1] neg_lo:[1,0,0] neg_hi:[1,0,0]
    v_pk_fma_f32 v[244:245], v[88:89], v[182:183], v[76:77] op_sel:[0,1,0] op_sel_hi:[1,1,1] neg_lo:[1,0,0] neg_hi:[1,0,0]
    v_pk_fma_f32 v[246:247], v[90:91], v[182:183], v[78:79] op_sel:[0,1,0] op_sel_hi:[1,1,1] neg_lo:[1,0,0] neg_hi:[1,0,0]
    v_pk_fma_f32 v[120:121], v[120:121], v[176:177], v[232:233] op_sel_hi:[1,0,1]
    v_pk_fma_f32 v[122:123], v[122:123], v[176:177], v[234:235] op_sel_hi:[1,0,1]
    v_pk_fma_f32 v[124:125], v[124:125], v[178:179], v[236:237] op_sel_hi:[1,0,1]
    v_pk_fma_f32 v[126:127], v[126:127], v[178:179], v[238:239] op_sel_hi:[1,0,1]
    v_pk_fma_f32 v[128:129], v[128:129], v[180:181], v[240:241] op_sel_hi:[1,0,1]
    v_pk_fma_f32 v[130:131], v[130:131], v[180:181], v[242:243] op_sel_hi:[1,0,1]
    v_pk_fma_f32 v[132:133], v[132:133], v[182:183], v[244:245] op_sel_hi:[1,0,1]
    v_pk_fma_f32 v[134:135], v[134:135], v[182:183], v[246:247] op_sel_hi:[1,0,1]
    v_exp_f32 v232, v120
    v_exp_f32 v233, v121
    v_exp_f32 v234, v122
    v_exp_f32 v235, v123
    v_exp_f32 v236, v124
    v_exp_f32 v237, v125
    v_exp_f32 v238, v126
    v_exp_f32 v239, v127
    v_exp_f32 v240, v128
    v_exp_f32 v241, v129
    v_exp_f32 v242, v130
    v_exp_f32 v243, v131
    v_exp_f32 v244, v132
    v_exp_f32 v245, v133
    v_exp_f32 v246, v134
    v_exp_f32 v247, v135
    .p2align 3
    v_pk_add_f32 v[232:233], v[232:233], 1.0 op_sel_hi:[1,0]
    v_pk_add_f32 v[234:235], v[234:235], 1.0 op_sel_hi:[1,0]
    v_pk_add_f32 v[236:237], v[236:237], 1.0 op_sel_hi:[1,0]
    v_pk_add_f32 v[238:239], v[238:239], 1.0 op_sel_hi:[1,0]
    v_pk_add_f32 v[240:241], v[240:241], 1.0 op_sel_hi:[1,0]
    v_pk_add_f32 v[242:243], v[242:243], 1.0 op_sel_hi:[1,0]
    v_pk_add_f32 v[244:245], v[244:245], 1.0 op_sel_hi:[1,0]
    v_pk_add_f32 v[246:247], v[246:247], 1.0 op_sel_hi:[1,0]
    v_pk_fma_f32 v[232:233], v[232:233], v[232:233], 1.0 op_sel_hi:[1,1,0]
    v_pk_fma_f32 v[234:235], v[234:235], v[234:235], 1.0 op_sel_hi:[1,1,0]
    v_pk_fma_f32 v[236:237], v[236:237], v[236:237], 1.0 op_sel_hi:[1,1,0]
    v_pk_fma_f32 v[238:239], v[238:239], v[238:239], 1.0 op_sel_hi:[1,1,0]
    v_pk_fma_f32 v[240:241], v[240:241], v[240:241], 1.0 op_sel_hi:[1,1,0]
    v_pk_fma_f32 v[242:243], v[242:243], v[242:243], 1.0 op_sel_hi:[1,1,0]
    v_pk_fma_f32 v[244:245], v[244:245], v[244:245], 1.0 op_sel_hi:[1,1,0]
    v_pk_fma_f32 v[246:247], v[246:247], v[246:247], 1.0 op_sel_hi:[1,1,0]
    v_rcp_f32 v232, v232
    v_rcp_f32 v233, v233
    v_rcp_f32 v234, v234
    v_rcp_f32 v235, v235
    v_rcp_f32 v236, v236
    v_rcp_f32 v237, v237
    v_rcp_f32 v238, v238
    v_rcp_f32 v239, v239
    v_rcp_f32 v240, v240
    v_rcp_f32 v241, v241
    v_rcp_f32 v242, v242
    v_rcp_f32 v243, v243
    v_rcp_f32 v244, v244
    v_rcp_f32 v245, v245
    v_rcp_f32 v246, v246
    v_rcp_f32 v247, v247
    .p2align 3
    v_pk_fma_f32 v[232:233], v[232:233], s[86:87], v[184:185]
    v_pk_fma_f32 v[234:235], v[234:235], s[86:87], v[184:185]
    v_pk_fma_f32 v[236:237], v[236:237], s[86:87], v[184:185]
    v_pk_fma_f32 v[238:239], v[238:239], s[86:87], v[184:185]
    v_pk_fma_f32 v[240:241], v[240:241], s[86:87], v[184:185]
    v_pk_fma_f32 v[242:243], v[242:243], s[86:87], v[184:185]
    v_pk_fma_f32 v[244:245], v[244:245], s[86:87], v[184:185]
    v_pk_fma_f32 v[246:247], v[246:247], s[86:87], v[184:185]
    v_pk_mul_f32 v[120:121], v[120:121], v[232:233]
    v_pk_mul_f32 v[122:123], v[122:123], v[234:235]
    v_pk_mul_f32 v[124:125], v[124:125], v[236:237]
    v_pk_mul_f32 v[126:127], v[126:127], v[238:239]
    v_pk_mul_f32 v[128:129], v[128:129], v[240:241]
    v_pk_mul_f32 v[130:131], v[130:131], v[242:243]
    v_pk_mul_f32 v[132:133], v[132:133], v[244:245]
    v_pk_mul_f32 v[134:135], v[134:135], v[246:247]
    v_cvt_pk_bf16_f32 v188, v120, v121
    v_cvt_pk_bf16_f32 v189, v122, v123
    v_cvt_pk_bf16_f32 v190, v124, v125
    v_cvt_pk_bf16_f32 v191, v126, v127
    v_cvt_pk_bf16_f32 v192, v128, v129
    v_cvt_pk_bf16_f32 v193, v130, v131
    v_cvt_pk_bf16_f32 v194, v132, v133
    v_cvt_pk_bf16_f32 v195, v134, v135
    s_add_u32 s52, s56, 0
    s_add_u32 s53, s56, 4096
    v_permlane16_swap_b32 v188, v190
    v_permlane16_swap_b32 v189, v191
    v_permlane16_swap_b32 v192, v194
    v_permlane16_swap_b32 v193, v195
    s_cmp_eq_u32 s48, 1
    s_cbranch_scc1 L_sl_60
    buffer_store_dwordx4 v[188:191], v14, s[8:11], s52 offen
    buffer_store_dwordx4 v[192:195], v14, s[8:11], s53 offen
L_sb_61:
    .p2align 3
    v_pk_fma_f32 v[232:233], v[92:93], v[176:177], v[80:81] op_sel:[0,1,0] op_sel_hi:[1,1,1] neg_lo:[1,0,0] neg_hi:[1,0,0]
    v_pk_fma_f32 v[234:235], v[94:95], v[176:177], v[82:83] op_sel:[0,1,0] op_sel_hi:[1,1,1] neg_lo:[1,0,0] neg_hi:[1,0,0]
    v_pk_fma_f32 v[236:237], v[92:93], v[178:179], v[80:81] op_sel:[0,1,0] op_sel_hi:[1,1,1] neg_lo:[1,0,0] neg_hi:[1,0,0]
    v_pk_fma_f32 v[238:239], v[94:95], v[178:179], v[82:83] op_sel:[0,1,0] op_sel_hi:[1,1,1] neg_lo:[1,0,0] neg_hi:[1,0,0]
    v_pk_fma_f32 v[240:241], v[92:93], v[180:181], v[80:81] op_sel:[0,1,0] op_sel_hi:[1,1,1] neg_lo:[1,0,0] neg_hi:[1,0,0]
    v_pk_fma_f32 v[242:243], v[94:95], v[180:181], v[82:83] op_sel:[0,1,0] op_sel_hi:[1,1,1] neg_lo:[1,0,0] neg_hi:[1,0,0]
    v_pk_fma_f32 v[244:245], v[92:93], v[182:183], v[80:81] op_sel:[0,1,0] op_sel_hi:[1,1,1] neg_lo:[1,0,0] neg_hi:[1,0,0]
    v_pk_fma_f32 v[246:247], v[94:95], v[182:183], v[82:83] op_sel:[0,1,0] op_sel_hi:[1,1,1] neg_lo:[1,0,0] neg_hi:[1,0,0]
    v_pk_fma_f32 v[136:137], v[136:137], v[176:177], v[232:233] op_sel_hi:[1,0,1]
    v_pk_fma_f32 v[138:139], v[138:139], v[176:177], v[234:235] op_sel_hi:[1,0,1]
    v_pk_fma_f32 v[140:141], v[140:141], v[178:179], v[236:237] op_sel_hi:[1,0,1]
    v_pk_fma_f32 v[142:143], v[142:143], v[178:179], v[238:239] op_sel_hi:[1,0,1]
    v_pk_fma_f32 v[144:145], v[144:145], v[180:181], v[240:241] op_sel_hi:[1,0,1]
    v_pk_fma_f32 v[146:147], v[146:147], v[180:181], v[242:243] op_sel_hi:[1,0,1]
    v_pk_fma_f32 v[148:149], v[148:149], v[182:183], v[244:245] op_sel_hi:[1,0,1]
    v_pk_fma_f32 v[150:151], v[150:151], v[182:183], v[246:247] op_sel_hi:[1,0,1]
    v_exp_f32 v232, v136
    v_exp_f32 v233, v137
    v_exp_f32 v234, v138
    v_exp_f32 v235, v139
    v_exp_f32 v236, v140
    v_exp_f32 v237, v141
    v_exp_f32 v238, v142
    v_exp_f32 v239, v143
    v_exp_f32 v240, v144
    v_exp_f32 v241, v145
    v_exp_f32 v242, v146
    v_exp_f32 v243, v147
    v_exp_f32 v244, v148
    v_exp_f32 v245, v149
    v_exp_f32 v246, v150
    v_exp_f32 v247, v151
    .p2align 3
    v_pk_add_f32 v[232:233], v[232:233], 1.0 op_sel_hi:[1,0]
    v_pk_add_f32 v[234:235], v[234:235], 1.0 op_sel_hi:[1,0]
    v_pk_add_f32 v[236:237], v[236:237], 1.0 op_sel_hi:[1,0]
    v_pk_add_f32 v[238:239], v[238:239], 1.0 op_sel_hi:[1,0]
    v_pk_add_f32 v[240:241], v[240:241], 1.0 op_sel_hi:[1,0]
    v_pk_add_f32 v[242:243], v[242:243], 1.0 op_sel_hi:[1,0]
    v_pk_add_f32 v[244:245], v[244:245], 1.0 op_sel_hi:[1,0]
    v_pk_add_f32 v[246:247], v[246:247], 1.0 op_sel_hi:[1,0]
    v_pk_fma_f32 v[232:233], v[232:233], v[232:233], 1.0 op_sel_hi:[1,1,0]
    v_pk_fma_f32 v[234:235], v[234:235], v[234:235], 1.0 op_sel_hi:[1,1,0]
    v_pk_fma_f32 v[236:237], v[236:237], v[236:237], 1.0 op_sel_hi:[1,1,0]
    v_pk_fma_f32 v[238:239], v[238:239], v[238:239], 1.0 op_sel_hi:[1,1,0]
    v_pk_fma_f32 v[240:241], v[240:241], v[240:241], 1.0 op_sel_hi:[1,1,0]
    v_pk_fma_f32 v[242:243], v[242:243], v[242:243], 1.0 op_sel_hi:[1,1,0]
    v_pk_fma_f32 v[244:245], v[244:245], v[244:245], 1.0 op_sel_hi:[1,1,0]
    v_pk_fma_f32 v[246:247], v[246:247], v[246:247], 1.0 op_sel_hi:[1,1,0]
    v_rcp_f32 v232, v232
    v_rcp_f32 v233, v233
    v_rcp_f32 v234, v234
    v_rcp_f32 v235, v235
    v_rcp_f32 v236, v236
    v_rcp_f32 v237, v237
    v_rcp_f32 v238, v238
    v_rcp_f32 v239, v239
    v_rcp_f32 v240, v240
    v_rcp_f32 v241, v241
    v_rcp_f32 v242, v242
    v_rcp_f32 v243, v243
    v_rcp_f32 v244, v244
    v_rcp_f32 v245, v245
    v_rcp_f32 v246, v246
    v_rcp_f32 v247, v247
    .p2align 3
    v_pk_fma_f32 v[232:233], v[232:233], s[86:87], v[184:185]
    v_pk_fma_f32 v[234:235], v[234:235], s[86:87], v[184:185]
    v_pk_fma_f32 v[236:237], v[236:237], s[86:87], v[184:185]
    v_pk_fma_f32 v[238:239], v[238:239], s[86:87], v[184:185]
    v_pk_fma_f32 v[240:241], v[240:241], s[86:87], v[184:185]
    v_pk_fma_f32 v[242:243], v[242:243], s[86:87], v[184:185]
    v_pk_fma_f32 v[244:245], v[244:245], s[86:87], v[184:185]
    v_pk_fma_f32 v[246:247], v[246:247], s[86:87], v[184:185]
    v_mov_b32 v4, 12
    s_waitcnt vmcnt(0)
    s_cmp_eq_u32 s48, 1
    s_cbranch_scc1 L_sl_62
    s_mov_b64 exec, 1
    buffer_store_dword v4, v16, s[8:11], s47 offen
    s_mov_b64 exec, -1
L_sb_63:
    .p2align 3
    v_pk_mul_f32 v[136:137], v[136:137], v[232:233]
    v_pk_mul_f32 v[138:139], v[138:139], v[234:235]
    v_pk_mul_f32 v[140:141], v[140:141], v[236:237]
    v_pk_mul_f32 v[142:143], v[142:143], v[238:239]
    v_pk_mul_f32 v[144:145], v[144:145], v[240:241]
    v_pk_mul_f32 v[146:147], v[146:147], v[242:243]
    v_pk_mul_f32 v[148:149], v[148:149], v[244:245]
    v_pk_mul_f32 v[150:151], v[150:151], v[246:247]
    v_cvt_pk_bf16_f32 v196, v136, v137
    v_cvt_pk_bf16_f32 v197, v138, v139
    v_cvt_pk_bf16_f32 v198, v140, v141
    v_cvt_pk_bf16_f32 v199, v142, v143
    v_cvt_pk_bf16_f32 v200, v144, v145
    v_cvt_pk_bf16_f32 v201, v146, v147
    v_cvt_pk_bf16_f32 v202, v148, v149
    v_cvt_pk_bf16_f32 v203, v150, v151
    s_add_u32 s52, s56, 8192
    s_add_u32 s53, s56, 12288
    v_permlane16_swap_b32 v196, v198
    v_permlane16_swap_b32 v197, v199
    v_permlane16_swap_b32 v200, v202
    v_permlane16_swap_b32 v201, v203
    s_cmp_eq_u32 s48, 1
    s_cbranch_scc1 L_sl_64
    buffer_store_dwordx4 v[196:199], v14, s[8:11], s52 offen
    buffer_store_dwordx4 v[200:203], v14, s[8:11], s53 offen
L_sb_65:
    .p2align 3
    v_pk_fma_f32 v[232:233], v[96:97], v[176:177], v[84:85] op_sel:[0,1,0] op_sel_hi:[1,1,1] neg_lo:[1,0,0] neg_hi:[1,0,0]
    v_pk_fma_f32 v[234:235], v[98:99], v[176:177], v[86:87] op_sel:[0,1,0] op_sel_hi:[1,1,1] neg_lo:[1,0,0] neg_hi:[1,0,0]
    v_pk_fma_f32 v[236:237], v[96:97], v[178:179], v[84:85] op_sel:[0,1,0] op_sel_hi:[1,1,1] neg_lo:[1,0,0] neg_hi:[1,0,0]
    v_pk_fma_f32 v[238:239], v[98:99], v[178:179], v[86:87] op_sel:[0,1,0] op_sel_hi:[1,1,1] neg_lo:[1,0,0] neg_hi:[1,0,0]
    v_pk_fma_f32 v[240:241], v[96:97], v[180:181], v[84:85] op_sel:[0,1,0] op_sel_hi:[1,1,1] neg_lo:[1,0,0] neg_hi:[1,0,0]
    v_pk_fma_f32 v[242:243], v[98:99], v[180:181], v[86:87] op_sel:[0,1,0] op_sel_hi:[1,1,1] neg_lo:[1,0,0] neg_hi:[1,0,0]
    v_pk_fma_f32 v[244:245], v[96:97], v[182:183], v[84:85] op_sel:[0,1,0] op_sel_hi:[1,1,1] neg_lo:[1,0,0] neg_hi:[1,0,0]
    v_pk_fma_f32 v[246:247], v[98:99], v[182:183], v[86:87] op_sel:[0,1,0] op_sel_hi:[1,1,1] neg_lo:[1,0,0] neg_hi:[1,0,0]
    v_pk_fma_f32 v[152:153], v[152:153], v[176:177], v[232:233] op_sel_hi:[1,0,1]
    v_pk_fma_f32 v[154:155], v[154:155], v[176:177], v[234:235] op_sel_hi:[1,0,1]
    v_pk_fma_f32 v[156:157], v[156:157], v[178:179], v[236:237] op_sel_hi:[1,0,1]
    v_pk_fma_f32 v[158:159], v[158:159], v[178:179], v[238:239] op_sel_hi:[1,0,1]
    v_pk_fma_f32 v[160:161], v[160:161], v[180:181], v[240:241] op_sel_hi:[1,0,1]
    v_pk_fma_f32 v[162:163], v[162:163], v[180:181], v[242:243] op_sel_hi:[1,0,1]
    v_pk_fma_f32 v[164:165], v[164:165], v[182:183], v[244:245] op_sel_hi:[1,0,1]
    v_pk_fma_f32 v[166:167], v[166:167], v[182:183], v[246:247] op_sel_hi:[1,0,1]
    buffer_load_dword v10, v22, s[8:11], 0 offen sc1
    v_mov_b32 v24, v13
    v_add_u32 v25, 0xd000, v24
    v_add_u32 v26, 0x1a000, v24
    v_xor_b32 v27, 64, v13
    v_add_u32 v28, 0xd000, v27
    v_add_u32 v29, 0x1a000, v27
    v_exp_f32 v232, v152
    v_exp_f32 v233, v153
    v_exp_f32 v234, v154
    v_exp_f32 v235, v155
    v_exp_f32 v236, v156
    v_exp_f32 v237, v157
    v_exp_f32 v238, v158
    v_exp_f32 v239, v159
    v_exp_f32 v240, v160
    v_exp_f32 v241, v161
    v_exp_f32 v242, v162
    v_exp_f32 v243, v163
    v_exp_f32 v244, v164
    v_exp_f32 v245, v165
    v_exp_f32 v246, v166
    v_exp_f32 v247, v167
    .p2align 3
    v_pk_add_f32 v[232:233], v[232:233], 1.0 op_sel_hi:[1,0]
    v_pk_add_f32 v[234:235], v[234:235], 1.0 op_sel_hi:[1,0]
    v_pk_add_f32 v[236:237], v[236:237], 1.0 op_sel_hi:[1,0]
    v_pk_add_f32 v[238:239], v[238:239], 1.0 op_sel_hi:[1,0]
    v_pk_add_f32 v[240:241], v[240:241], 1.0 op_sel_hi:[1,0]
    v_pk_add_f32 v[242:243], v[242:243], 1.0 op_sel_hi:[1,0]
    v_pk_add_f32 v[244:245], v[244:245], 1.0 op_sel_hi:[1,0]
    v_pk_add_f32 v[246:247], v[246:247], 1.0 op_sel_hi:[1,0]
    v_pk_fma_f32 v[232:233], v[232:233], v[232:233], 1.0 op_sel_hi:[1,1,0]
    v_pk_fma_f32 v[234:235], v[234:235], v[234:235], 1.0 op_sel_hi:[1,1,0]
    v_pk_fma_f32 v[236:237], v[236:237], v[236:237], 1.0 op_sel_hi:[1,1,0]
    v_pk_fma_f32 v[238:239], v[238:239], v[238:239], 1.0 op_sel_hi:[1,1,0]
    v_pk_fma_f32 v[240:241], v[240:241], v[240:241], 1.0 op_sel_hi:[1,1,0]
    v_pk_fma_f32 v[242:243], v[242:243], v[242:243], 1.0 op_sel_hi:[1,1,0]
    v_pk_fma_f32 v[244:245], v[244:245], v[244:245], 1.0 op_sel_hi:[1,1,0]
    v_pk_fma_f32 v[246:247], v[246:247], v[246:247], 1.0 op_sel_hi:[1,1,0]
    v_rcp_f32 v232, v232
    v_rcp_f32 v233, v233
    v_rcp_f32 v234, v234
    v_rcp_f32 v235, v235
    v_rcp_f32 v236, v236
    v_rcp_f32 v237, v237
    v_rcp_f32 v238, v238
    v_rcp_f32 v239, v239
    v_rcp_f32 v240, v240
    v_rcp_f32 v241, v241
    v_rcp_f32 v242, v242
    v_rcp_f32 v243, v243
    v_rcp_f32 v244, v244
    v_rcp_f32 v245, v245
    v_rcp_f32 v246, v246
    v_rcp_f32 v247, v247
    s_waitcnt vmcnt(0)
    v_cmp_gt_u32 vcc, 12, v10
    s_nop 1
    s_cbranch_vccnz L_pl_66
L_pb_67:
    s_add_u32 s57, s47, 0x20000
    buffer_load_dwordx4 v[120:123], v23, s[8:11], s57 offen offset:0 sc1
    .p2align 3
    v_pk_fma_f32 v[232:233], v[232:233], s[86:87], v[184:185]
    v_pk_fma_f32 v[234:235], v[234:235], s[86:87], v[184:185]
    v_pk_fma_f32 v[236:237], v[236:237], s[86:87], v[184:185]
    v_pk_fma_f32 v[238:239], v[238:239], s[86:87], v[184:185]
    v_pk_fma_f32 v[240:241], v[240:241], s[86:87], v[184:185]
    v_pk_fma_f32 v[242:243], v[242:243], s[86:87], v[184:185]
    v_pk_fma_f32 v[244:245], v[244:245], s[86:87], v[184:185]
    v_pk_fma_f32 v[246:247], v[246:247], s[86:87], v[184:185]
    buffer_load_dwordx4 v[124:127], v23, s[8:11], s57 offen offset:512 sc1
    .p2align 3
    v_pk_mul_f32 v[152:153], v[152:153], v[232:233]
    v_pk_mul_f32 v[154:155], v[154:155], v[234:235]
    v_pk_mul_f32 v[156:157], v[156:157], v[236:237]
    v_pk_mul_f32 v[158:159], v[158:159], v[238:239]
    v_pk_mul_f32 v[160:161], v[160:161], v[240:241]
    v_pk_mul_f32 v[162:163], v[162:163], v[242:243]
    v_pk_mul_f32 v[164:165], v[164:165], v[244:245]
    v_pk_mul_f32 v[166:167], v[166:167], v[246:247]
    v_mov_b32 v4, 13
    s_cmp_eq_u32 s48, 1
    s_cbranch_scc1 L_sl_70
    s_mov_b64 exec, 1
    buffer_store_dword v4, v16, s[8:11], s47 offen
    s_mov_b64 exec, -1
L_sb_71:
    s_add_u32 s57, s47, 0x26000
    buffer_load_dwordx4 v[128:131], v23, s[8:11], s57 offen offset:0 sc1
    .p2align 3
    v_cvt_pk_bf16_f32 v204, v152, v153
    v_cvt_pk_bf16_f32 v205, v154, v155
    v_cvt_pk_bf16_f32 v206, v156, v157
    v_cvt_pk_bf16_f32 v207, v158, v159
    v_cvt_pk_bf16_f32 v208, v160, v161
    v_cvt_pk_bf16_f32 v209, v162, v163
    v_cvt_pk_bf16_f32 v210, v164, v165
    v_cvt_pk_bf16_f32 v211, v166, v167
    buffer_load_dwordx4 v[132:135], v23, s[8:11], s57 offen offset:512 sc1
    s_add_u32 s52, s56, 16384
    s_add_u32 s53, s56, 20480
    v_permlane16_swap_b32 v204, v206
    v_permlane16_swap_b32 v205, v207
    v_permlane16_swap_b32 v208, v210
    v_permlane16_swap_b32 v209, v211
    s_cmp_eq_u32 s48, 1
    s_cbranch_scc1 L_sl_72
    buffer_store_dwordx4 v[204:207], v14, s[8:11], s52 offen
    buffer_store_dwordx4 v[208:211], v14, s[8:11], s53 offen
L_sb_73:
    s_add_u32 s57, s47, 0x2c000
    buffer_load_dwordx4 v[136:139], v23, s[8:11], s57 offen offset:0 sc1
    buffer_load_dwordx4 v[140:143], v23, s[8:11], s57 offen offset:512 sc1
    s_add_u32 s57, s47, 0x32000
    buffer_load_dwordx4 v[144:147], v23, s[8:11], s57 offen offset:0 sc1
    buffer_load_dwordx4 v[148:151], v23, s[8:11], s57 offen offset:512 sc1
    s_barrier
    ds_read_b64_tr_b16 v[216:217], v26 offset:45056
    ds_read_b64_tr_b16 v[218:219], v26 offset:47104
    ds_read_b64_tr_b16 v[220:221], v29 offset:45056
    ds_read_b64_tr_b16 v[222:223], v29 offset:47104
    ds_read_b64_tr_b16 v[224:225], v26 offset:46080
    ds_read_b64_tr_b16 v[226:227], v26 offset:48128
    ds_read_b64_tr_b16 v[228:229], v29 offset:46080
    ds_read_b64_tr_b16 v[230:231], v29 offset:48128
    s_waitcnt vmcnt(9)
    s_waitcnt lgkmcnt(4)
    v_mfma_f32_32x32x16_bf16 v[48:63], v[216:219], v[120:123], v[48:63]
    s_add_u32 s57, s47, 0x38000
    buffer_load_dwordx4 v[152:155], v23, s[8:11], s57 offen offset:0 sc1
    ds_read_b64_tr_b16 v[232:233], v24 offset:0
    ds_read_b64_tr_b16 v[234:235], v24 offset:2048
    v_mfma_f32_32x32x16_bf16 v[200:215], v[220:223], v[120:123], 0
    ds_read_b64_tr_b16 v[236:237], v27 offset:0
    ds_read_b64_tr_b16 v[238:239], v27 offset:2048
    buffer_load_dwordx4 v[156:159], v23, s[8:11], s57 offen offset:512 sc1
    s_waitcnt lgkmcnt(4)
    v_mfma_f32_32x32x16_bf16 v[48:63], v[224:227], v[124:127], v[48:63]
    ds_read_b64_tr_b16 v[240:241], v24 offset:1024
    ds_read_b64_tr_b16 v[242:243], v24 offset:3072
    ds_read_b64_tr_b16 v[244:245], v27 offset:1024
    v_mfma_f32_32x32x16_bf16 v[200:215], v[228:231], v[124:127], v[200:215]
    ds_read_b64_tr_b16 v[246:247], v27 offset:3072
    buffer_load_dword v10, v22, s[8:11], 0 offen sc1
    s_waitcnt vmcnt(9)
    s_waitcnt lgkmcnt(4)
    v_mfma_f32_32x32x16_bf16 v[48:63], v[232:235], v[128:131], v[48:63]
    s_add_u32 s57, s47, 0x3e000
    buffer_load_dwordx4 v[120:123], v23, s[8:11], s57 offen offset:0 sc1
    buffer_load_dwordx4 v[124:127], v23, s[8:11], s57 offen offset:512 sc1
    v_mfma_f32_32x32x16_bf16 v[200:215], v[236:239], v[128:131], v[200:215]
    s_waitcnt lgkmcnt(0)
    s_barrier
    ds_read_b64_tr_b16 v[216:217], v24 offset:8192
    ds_read_b64_tr_b16 v[218:219], v24 offset:10240
    ds_read_b64_tr_b16 v[220:221], v27 offset:8192
    v_mfma_f32_32x32x16_bf16 v[48:63], v[240:243], v[132:135], v[48:63]
    ds_read_b64_tr_b16 v[222:223], v27 offset:10240
    ds_read_b64_tr_b16 v[224:225], v24 offset:9216
    ds_read_b64_tr_b16 v[226:227], v24 offset:11264
    v_mfma_f32_32x32x16_bf16 v[200:215], v[244:247], v[132:135], v[200:215]
    ds_read_b64_tr_b16 v[228:229], v27 offset:9216
    ds_read_b64_tr_b16 v[230:231], v27 offset:11264
    v_mov_b32 v4, 14
    s_waitcnt vmcnt(9)
    s_cmp_eq_u32 s48, 1
    s_cbranch_scc1 L_sl_74
    s_mov_b64 exec, 1
    buffer_store_dword v4, v16, s[8:11], s47 offen
    s_mov_b64 exec, -1
L_sb_75:
    s_waitcnt vmcnt(8)
    s_waitcnt lgkmcnt(4)
    v_mfma_f32_32x32x16_bf16 v[48:63], v[216:219], v[136:139], v[48:63]
    s_add_u32 s57, s47, 0x44000
    buffer_load_dwordx4 v[128:131], v23, s[8:11], s57 offen offset:0 sc1
    ds_read_b64_tr_b16 v[232:233], v24 offset:16384
    ds_read_b64_tr_b16 v[234:235], v24 offset:18432
    v_mfma_f32_32x32x16_bf16 v[200:215], v[220:223], v[136:139], v[200:215]
    ds_read_b64_tr_b16 v[236:237], v27 offset:16384
    ds_read_b64_tr_b16 v[238:239], v27 offset:18432
    buffer_load_dwordx4 v[132:135], v23, s[8:11], s57 offen offset:512 sc1
    s_waitcnt lgkmcnt(4)
    v_mfma_f32_32x32x16_bf16 v[48:63], v[224:227], v[140:143], v[48:63]
    ds_read_b64_tr_b16 v[240:241], v24 offset:17408
    ds_read_b64_tr_b16 v[242:243], v24 offset:19456
    v_mfma_f32_32x32x16_bf16 v[200:215], v[228:231], v[140:143], v[200:215]
    ds_read_b64_tr_b16 v[244:245], v27 offset:17408
    ds_read_b64_tr_b16 v[246:247], v27 offset:19456
    s_waitcnt vmcnt(8)
    s_waitcnt lgkmcnt(4)
    v_mfma_f32_32x32x16_bf16 v[48:63], v[232:235], v[144:147], v[48:63]
    s_add_u32 s57, s47, 0x4a000
    buffer_load_dwordx4 v[136:139], v23, s[8:11], s57 offen offset:0 sc1
    buffer_load_dwordx4 v[140:143], v23, s[8:11], s57 offen offset:512 sc1
    v_mfma_f32_32x32x16_bf16 v[200:215], v[236:239], v[144:147], v[200:215]
    s_waitcnt lgkmcnt(0)
    s_barrier
    ds_read_b64_tr_b16 v[216:217], v24 offset:24576
    ds_read_b64_tr_b16 v[218:219], v24 offset:26624
    ds_read_b64_tr_b16 v[220:221], v27 offset:24576
    v_mfma_f32_32x32x16_bf16 v[48:63], v[240:243], v[148:151], v[48:63]
    ds_read_b64_tr_b16 v[222:223], v27 offset:26624
    ds_read_b64_tr_b16 v[224:225], v24 offset:25600
    ds_read_b64_tr_b16 v[226:227], v24 offset:27648
    v_mfma_f32_32x32x16_bf16 v[200:215], v[244:247], v[148:151], v[200:215]
    ds_read_b64_tr_b16 v[228:229], v27 offset:25600
    ds_read_b64_tr_b16 v[230:231], v27 offset:27648
    s_waitcnt vmcnt(7)
    v_cmp_gt_u32 vcc, 13, v10
    s_cbranch_vccnz L_pl_76
L_pb_77:
    s_waitcnt lgkmcnt(4)
    v_mfma_f32_32x32x16_bf16 v[48:63], v[216:219], v[152:155], v[48:63]
    s_add_u32 s57, s47, 0x22000
    buffer_load_dwordx4 v[144:147], v23, s[8:11], s57 offen offset:0 sc1
    ds_read_b64_tr_b16 v[232:233], v24 offset:32768
    ds_read_b64_tr_b16 v[234:235], v24 offset:34816
    v_mfma_f32_32x32x16_bf16 v[200:215], v[220:223], v[152:155], v[200:215]
    ds_read_b64_tr_b16 v[236:237], v27 offset:32768
    ds_read_b64_tr_b16 v[238:239], v27 offset:34816
    buffer_load_dwordx4 v[148:151], v23, s[8:11], s57 offen offset:512 sc1
    s_waitcnt lgkmcnt(4)
    v_mfma_f32_32x32x16_bf16 v[48:63], v[224:227], v[156:159], v[48:63]
    ds_read_b64_tr_b16 v[240:241], v24 offset:33792
    ds_read_b64_tr_b16 v[242:243], v24 offset:35840
    v_mfma_f32_32x32x16_bf16 v[200:215], v[228:231], v[156:159], v[200:215]
    ds_read_b64_tr_b16 v[244:245], v27 offset:33792
    ds_read_b64_tr_b16 v[246:247], v27 offset:35840
    s_waitcnt vmcnt(7)
    s_waitcnt lgkmcnt(4)
    v_mfma_f32_32x32x16_bf16 v[48:63], v[232:235], v[120:123], v[48:63]
    s_add_u32 s57, s47, 0x28000
    buffer_load_dwordx4 v[152:155], v23, s[8:11], s57 offen offset:0 sc1
    buffer_load_dwordx4 v[156:159], v23, s[8:11], s57 offen offset:512 sc1
    v_mfma_f32_32x32x16_bf16 v[200:215], v[236:239], v[120:123], v[200:215]
    s_waitcnt lgkmcnt(0)
    s_barrier
    ds_read_b64_tr_b16 v[216:217], v24 offset:40960
    ds_read_b64_tr_b16 v[218:219], v24 offset:43008
    ds_read_b64_tr_b16 v[220:221], v27 offset:40960
    v_mfma_f32_32x32x16_bf16 v[48:63], v[240:243], v[124:127], v[48:63]
    ds_read_b64_tr_b16 v[222:223], v27 offset:43008
    ds_read_b64_tr_b16 v[224:225], v24 offset:41984
    ds_read_b64_tr_b16 v[226:227], v24 offset:44032
    v_mfma_f32_32x32x16_bf16 v[200:215], v[244:247], v[124:127], v[200:215]
    ds_read_b64_tr_b16 v[228:229], v27 offset:41984
    ds_read_b64_tr_b16 v[230:231], v27 offset:44032
    buffer_load_dword v10, v22, s[8:11], 0 offen sc1
    s_waitcnt vmcnt(7)
    s_waitcnt lgkmcnt(4)
    v_mfma_f32_32x32x16_bf16 v[48:63], v[216:219], v[128:131], v[48:63]
    s_add_u32 s57, s47, 0x2e000
    buffer_load_dwordx4 v[120:123], v23, s[8:11], s57 offen offset:0 sc1
    ds_read_b64_tr_b16 v[232:233], v24 offset:49152
    ds_read_b64_tr_b16 v[234:235], v24 offset:51200
    v_mfma_f32_32x32x16_bf16 v[200:215], v[220:223], v[128:131], v[200:215]
    ds_read_b64_tr_b16 v[236:237], v27 offset:49152
    ds_read_b64_tr_b16 v[238:239], v27 offset:51200
    buffer_load_dwordx4 v[124:127], v23, s[8:11], s57 offen offset:512 sc1
    s_waitcnt lgkmcnt(4)
    v_mfma_f32_32x32x16_bf16 v[48:63], v[224:227], v[132:135], v[48:63]
    ds_read_b64_tr_b16 v[240:241], v24 offset:50176
    ds_read_b64_tr_b16 v[242:243], v24 offset:52224
    v_mfma_f32_32x32x16_bf16 v[200:215], v[228:231], v[132:135], v[200:215]
    ds_read_b64_tr_b16 v[244:245], v27 offset:50176
    ds_read_b64_tr_b16 v[246:247], v27 offset:52224
    s_waitcnt vmcnt(7)
    s_waitcnt lgkmcnt(4)
    v_mfma_f32_32x32x16_bf16 v[48:63], v[232:235], v[136:139], v[48:63]
    s_add_u32 s57, s47, 0x34000
    buffer_load_dwordx4 v[128:131], v23, s[8:11], s57 offen offset:0 sc1
    buffer_load_dwordx4 v[132:135], v23, s[8:11], s57 offen offset:512 sc1
    v_mfma_f32_32x32x16_bf16 v[200:215], v[236:239], v[136:139], v[200:215]
    s_waitcnt lgkmcnt(0)
    s_barrier
    ds_read_b64_tr_b16 v[216:217], v25 offset:4096
    ds_read_b64_tr_b16 v[218:219], v25 offset:6144
    v_mfma_f32_32x32x16_bf16 v[48:63], v[240:243], v[140:143], v[48:63]
    ds_read_b64_tr_b16 v[220:221], v28 offset:4096
    ds_read_b64_tr_b16 v[222:223], v28 offset:6144
    ds_read_b64_tr_b16 v[224:225], v25 offset:5120
    v_mfma_f32_32x32x16_bf16 v[200:215], v[244:247], v[140:143], v[200:215]
    ds_read_b64_tr_b16 v[226:227], v25 offset:7168
    ds_read_b64_tr_b16 v[228:229], v28 offset:5120
    ds_read_b64_tr_b16 v[230:231], v28 offset:7168
    s_waitcnt vmcnt(7)
    s_waitcnt lgkmcnt(4)
    v_mfma_f32_32x32x16_bf16 v[48:63], v[216:219], v[144:147], v[48:63]
    s_add_u32 s57, s47, 0x3a000
    buffer_load_dwordx4 v[136:139], v23, s[8:11], s57 offen offset:0 sc1
    ds_read_b64_tr_b16 v[232:233], v25 offset:12288
    ds_read_b64_tr_b16 v[234:235], v25 offset:14336
    v_mfma_f32_32x32x16_bf16 v[200:215], v[220:223], v[144:147], v[200:215]
    ds_read_b64_tr_b16 v[236:237], v28 offset:12288
    ds_read_b64_tr_b16 v[238:239], v28 offset:14336
    buffer_load_dwordx4 v[140:143], v23, s[8:11], s57 offen offset:512 sc1
    s_waitcnt lgkmcnt(4)
    v_mfma_f32_32x32x16_bf16 v[48:63], v[224:227], v[148:151], v[48:63]
    ds_read_b64_tr_b16 v[240:241], v25 offset:13312
    ds_read_b64_tr_b16 v[242:243], v25 offset:15360
    v_mfma_f32_32x32x16_bf16 v[200:215], v[228:231], v[148:151], v[200:215]
    ds_read_b64_tr_b16 v[244:245], v28 offset:13312
    ds_read_b64_tr_b16 v[246:247], v28 offset:15360
    s_waitcnt vmcnt(7)
    s_waitcnt lgkmcnt(4)
    v_mfma_f32_32x32x16_bf16 v[48:63], v[232:235], v[152:155], v[48:63]
    s_add_u32 s57, s47, 0x40000
    buffer_load_dwordx4 v[144:147], v23, s[8:11], s57 offen offset:0 sc1
    buffer_load_dwordx4 v[148:151], v23, s[8:11], s57 offen offset:512 sc1
    v_mfma_f32_32x32x16_bf16 v[200:215], v[236:239], v[152:155], v[200:215]
    s_waitcnt lgkmcnt(0)
    s_barrier
    ds_read_b64_tr_b16 v[216:217], v25 offset:20480
    ds_read_b64_tr_b16 v[218:219], v25 offset:22528
    v_mfma_f32_32x32x16_bf16 v[48:63], v[240:243], v[156:159], v[48:63]
    ds_read_b64_tr_b16 v[220:221], v28 offset:20480
    ds_read_b64_tr_b16 v[222:223], v28 offset:22528
    ds_read_b64_tr_b16 v[224:225], v25 offset:21504
    v_mfma_f32_32x32x16_bf16 v[200:215], v[244:247], v[156:159], v[200:215]
    ds_read_b64_tr_b16 v[226:227], v25 offset:23552
    ds_read_b64_tr_b16 v[228:229], v28 offset:21504
    ds_read_b64_tr_b16 v[230:231], v28 offset:23552
    s_waitcnt vmcnt(6)
    s_waitcnt lgkmcnt(4)
    v_mfma_f32_32x32x16_bf16 v[48:63], v[216:219], v[120:123], v[48:63]
    s_add_u32 s57, s47, 0x46000
    buffer_load_dwordx4 v[152:155], v23, s[8:11], s57 offen offset:0 sc1
    ds_read_b64_tr_b16 v[232:233], v25 offset:28672
    ds_read_b64_tr_b16 v[234:235], v25 offset:30720
    v_mfma_f32_32x32x16_bf16 v[200:215], v[220:223], v[120:123], v[200:215]
    ds_read_b64_tr_b16 v[236:237], v28 offset:28672
    ds_read_b64_tr_b16 v[238:239], v28 offset:30720
    buffer_load_dwordx4 v[156:159], v23, s[8:11], s57 offen offset:512 sc1
    s_waitcnt lgkmcnt(4)
    v_mfma_f32_32x32x16_bf16 v[48:63], v[224:227], v[124:127], v[48:63]
    ds_read_b64_tr_b16 v[240:241], v25 offset:29696
    ds_read_b64_tr_b16 v[242:243], v25 offset:31744
    ds_read_b64_tr_b16 v[244:245], v28 offset:29696
    v_mfma_f32_32x32x16_bf16 v[200:215], v[228:231], v[124:127], v[200:215]
    ds_read_b64_tr_b16 v[246:247], v28 offset:31744
    v_cmp_gt_u32 vcc, 14, v10
    s_cbranch_vccnz L_pl_80
L_pb_81:
    s_waitcnt vmcnt(6)
    s_waitcnt lgkmcnt(4)
    v_mfma_f32_32x32x16_bf16 v[48:63], v[232:235], v[128:131], v[48:63]
    s_add_u32 s57, s47, 0x24000
    buffer_load_dwordx4 v[120:123], v23, s[8:11], s57 offen offset:0 sc1
    buffer_load_dwordx4 v[124:127], v23, s[8:11], s57 offen offset:512 sc1
    v_mfma_f32_32x32x16_bf16 v[200:215], v[236:239], v[128:131], v[200:215]
    s_waitcnt lgkmcnt(0)
    s_barrier
    ds_read_b64_tr_b16 v[216:217], v25 offset:36864
    ds_read_b64_tr_b16 v[218:219], v25 offset:38912
    v_mfma_f32_32x32x16_bf16 v[48:63], v[240:243], v[132:135], v[48:63]
    ds_read_b64_tr_b16 v[220:221], v28 offset:36864
    ds_read_b64_tr_b16 v[222:223], v28 offset:38912
    ds_read_b64_tr_b16 v[224:225], v25 offset:37888
    v_mfma_f32_32x32x16_bf16 v[200:215], v[244:247], v[132:135], v[200:215]
    ds_read_b64_tr_b16 v[226:227], v25 offset:39936
    ds_read_b64_tr_b16 v[228:229], v28 offset:37888
    ds_read_b64_tr_b16 v[230:231], v28 offset:39936
    s_waitcnt vmcnt(6)
    s_waitcnt lgkmcnt(4)
    v_mfma_f32_32x32x16_bf16 v[48:63], v[216:219], v[136:139], v[48:63]
    s_add_u32 s57, s47, 0x2a000
    buffer_load_dwordx4 v[128:131], v23, s[8:11], s57 offen offset:0 sc1
    ds_read_b64_tr_b16 v[232:233], v25 offset:45056
    ds_read_b64_tr_b16 v[234:235], v25 offset:47104
    v_mfma_f32_32x32x16_bf16 v[200:215], v[220:223], v[136:139], v[200:215]
    ds_read_b64_tr_b16 v[236:237], v28 offset:45056
    ds_read_b64_tr_b16 v[238:239], v28 offset:47104
    buffer_load_dwordx4 v[132:135], v23, s[8:11], s57 offen offset:512 sc1
    s_waitcnt lgkmcnt(4)
    v_mfma_f32_32x32x16_bf16 v[48:63], v[224:227], v[140:143], v[48:63]
    ds_read_b64_tr_b16 v[240:241], v25 offset:46080
    ds_read_b64_tr_b16 v[242:243], v25 offset:48128
    v_mfma_f32_32x32x16_bf16 v[200:215], v[228:231], v[140:143], v[200:215]
    ds_read_b64_tr_b16 v[244:245], v28 offset:46080
    ds_read_b64_tr_b16 v[246:247], v28 offset:48128
    s_waitcnt vmcnt(6)
    s_waitcnt lgkmcnt(4)
    v_mfma_f32_32x32x16_bf16 v[48:63], v[232:235], v[144:147], v[48:63]
    s_add_u32 s57, s47, 0x30000
    buffer_load_dwordx4 v[136:139], v23, s[8:11], s57 offen offset:0 sc1
    buffer_load_dwordx4 v[140:143], v23, s[8:11], s57 offen offset:512 sc1
    v_mfma_f32_32x32x16_bf16 v[200:215], v[236:239], v[144:147], v[200:215]
    s_waitcnt lgkmcnt(0)
    s_barrier
    ds_read_b64_tr_b16 v[216:217], v26 offset:0
    ds_read_b64_tr_b16 v[218:219], v26 offset:2048
    v_mfma_f32_32x32x16_bf16 v[48:63], v[240:243], v[148:151], v[48:63]
    ds_read_b64_tr_b16 v[220:221], v29 offset:0
    ds_read_b64_tr_b16 v[222:223], v29 offset:2048
    ds_read_b64_tr_b16 v[224:225], v26 offset:1024
    v_mfma_f32_32x32x16_bf16 v[200:215], v[244:247], v[148:151], v[200:215]
    ds_read_b64_tr_b16 v[226:227], v26 offset:3072
    ds_read_b64_tr_b16 v[228:229], v29 offset:1024
    ds_read_b64_tr_b16 v[230:231], v29 offset:3072
    s_waitcnt vmcnt(6)
    s_waitcnt lgkmcnt(4)
    v_mfma_f32_32x32x16_bf16 v[48:63], v[216:219], v[152:155], v[48:63]
    s_add_u32 s57, s47, 0x36000
    buffer_load_dwordx4 v[144:147], v23, s[8:11], s57 offen offset:0 sc1
    ds_read_b64_tr_b16 v[232:233], v26 offset:8192
    ds_read_b64_tr_b16 v[234:235], v26 offset:10240
    v_mfma_f32_32x32x16_bf16 v[200:215], v[220:223], v[152:155], v[200:215]
    ds_read_b64_tr_b16 v[236:237], v29 offset:8192
    ds_read_b64_tr_b16 v[238:239], v29 offset:10240
    buffer_load_dwordx4 v[148:151], v23, s[8:11], s57 offen offset:512 sc1
    s_waitcnt lgkmcnt(4)
    v_mfma_f32_32x32x16_bf16 v[48:63], v[224:227], v[156:159], v[48:63]
    ds_read_b64_tr_b16 v[240:241], v26 offset:9216
    ds_read_b64_tr_b16 v[242:243], v26 offset:11264
    v_mfma_f32_32x32x16_bf16 v[200:215], v[228:231], v[156:159], v[200:215]
    ds_read_b64_tr_b16 v[244:245], v29 offset:9216
    ds_read_b64_tr_b16 v[246:247], v29 offset:11264
    s_waitcnt vmcnt(6)
    s_waitcnt lgkmcnt(4)
    v_mfma_f32_32x32x16_bf16 v[48:63], v[232:235], v[120:123], v[48:63]
    s_add_u32 s57, s47, 0x3c000
    buffer_load_dwordx4 v[152:155], v23, s[8:11], s57 offen offset:0 sc1
    buffer_load_dwordx4 v[156:159], v23, s[8:11], s57 offen offset:512 sc1
    v_mfma_f32_32x32x16_bf16 v[200:215], v[236:239], v[120:123], v[200:215]
    s_waitcnt lgkmcnt(0)
    s_barrier
    ds_read_b64_tr_b16 v[216:217], v26 offset:16384
    ds_read_b64_tr_b16 v[218:219], v26 offset:18432
    v_mfma_f32_32x32x16_bf16 v[48:63], v[240:243], v[124:127], v[48:63]
    ds_read_b64_tr_b16 v[220:221], v29 offset:16384
    ds_read_b64_tr_b16 v[222:223], v29 offset:18432
    ds_read_b64_tr_b16 v[224:225], v26 offset:17408
    v_mfma_f32_32x32x16_bf16 v[200:215], v[244:247], v[124:127], v[200:215]
    ds_read_b64_tr_b16 v[226:227], v26 offset:19456
    ds_read_b64_tr_b16 v[228:229], v29 offset:17408
    ds_read_b64_tr_b16 v[230:231], v29 offset:19456
    s_waitcnt vmcnt(6)
    s_waitcnt lgkmcnt(4)
    v_mfma_f32_32x32x16_bf16 v[48:63], v[216:219], v[128:131], v[48:63]
    s_add_u32 s57, s47, 0x42000
    buffer_load_dwordx4 v[120:123], v23, s[8:11], s57 offen offset:0 sc1
    ds_read_b64_tr_b16 v[232:233], v26 offset:24576
    ds_read_b64_tr_b16 v[234:235], v26 offset:26624
    v_mfma_f32_32x32x16_bf16 v[200:215], v[220:223], v[128:131], v[200:215]
    ds_read_b64_tr_b16 v[236:237], v29 offset:24576
    ds_read_b64_tr_b16 v[238:239], v29 offset:26624
    buffer_load_dwordx4 v[124:127], v23, s[8:11], s57 offen offset:512 sc1
    s_waitcnt lgkmcnt(4)
    v_mfma_f32_32x32x16_bf16 v[48:63], v[224:227], v[132:135], v[48:63]
    ds_read_b64_tr_b16 v[240:241], v26 offset:25600
    ds_read_b64_tr_b16 v[242:243], v26 offset:27648
    v_mfma_f32_32x32x16_bf16 v[200:215], v[228:231], v[132:135], v[200:215]
    ds_read_b64_tr_b16 v[244:245], v29 offset:25600
    ds_read_b64_tr_b16 v[246:247], v29 offset:27648
    s_waitcnt vmcnt(6)
    s_waitcnt lgkmcnt(4)
    v_mfma_f32_32x32x16_bf16 v[48:63], v[232:235], v[136:139], v[48:63]
    s_add_u32 s57, s47, 0x48000
    buffer_load_dwordx4 v[128:131], v23, s[8:11], s57 offen offset:0 sc1
    buffer_load_dwordx4 v[132:135], v23, s[8:11], s57 offen offset:512 sc1
    v_mfma_f32_32x32x16_bf16 v[200:215], v[236:239], v[136:139], v[200:215]
    s_waitcnt lgkmcnt(0)
    s_barrier
    ds_read_b64_tr_b16 v[216:217], v26 offset:32768
    ds_read_b64_tr_b16 v[218:219], v26 offset:34816
    v_mfma_f32_32x32x16_bf16 v[48:63], v[240:243], v[140:143], v[48:63]
    ds_read_b64_tr_b16 v[220:221], v29 offset:32768
    ds_read_b64_tr_b16 v[222:223], v29 offset:34816
    ds_read_b64_tr_b16 v[224:225], v26 offset:33792
    v_mfma_f32_32x32x16_bf16 v[200:215], v[244:247], v[140:143], v[200:215]
    ds_read_b64_tr_b16 v[226:227], v26 offset:35840
    ds_read_b64_tr_b16 v[228:229], v29 offset:33792
    ds_read_b64_tr_b16 v[230:231], v29 offset:35840
    s_waitcnt vmcnt(6)
    s_waitcnt lgkmcnt(4)
    v_mfma_f32_32x32x16_bf16 v[48:63], v[216:219], v[144:147], v[48:63]
    ds_read_b64_tr_b16 v[232:233], v26 offset:40960
    ds_read_b64_tr_b16 v[234:235], v26 offset:43008
    v_mfma_f32_32x32x16_bf16 v[200:215], v[220:223], v[144:147], v[200:215]
    ds_read_b64_tr_b16 v[236:237], v29 offset:40960
    ds_read_b64_tr_b16 v[238:239], v29 offset:43008
    s_waitcnt lgkmcnt(4)
    v_mfma_f32_32x32x16_bf16 v[48:63], v[224:227], v[148:151], v[48:63]
    ds_read_b64_tr_b16 v[240:241], v26 offset:41984
    ds_read_b64_tr_b16 v[242:243], v26 offset:44032
    v_mfma_f32_32x32x16_bf16 v[200:215], v[228:231], v[148:151], v[200:215]
    ds_read_b64_tr_b16 v[244:245], v29 offset:41984
    ds_read_b64_tr_b16 v[246:247], v29 offset:44032
    s_waitcnt vmcnt(4)
    s_waitcnt lgkmcnt(4)
    v_mfma_f32_32x32x16_bf16 v[48:63], v[232:235], v[152:155], v[48:63]
    v_mfma_f32_32x32x16_bf16 v[200:215], v[236:239], v[152:155], v[200:215]
    s_waitcnt lgkmcnt(0)
    s_barrier
    ds_read_b64_tr_b16 v[216:217], v24 offset:0
    ds_read_b64_tr_b16 v[218:219], v24 offset:2048
    v_mfma_f32_32x32x16_bf16 v[48:63], v[240:243], v[156:159], v[48:63]
    ds_read_b64_tr_b16 v[220:221], v27 offset:0
    ds_read_b64_tr_b16 v[222:223], v27 offset:2048
    ds_read_b64_tr_b16 v[224:225], v24 offset:1024
    v_mfma_f32_32x32x16_bf16 v[200:215], v[244:247], v[156:159], v[200:215]
    ds_read_b64_tr_b16 v[226:227], v24 offset:3072
    ds_read_b64_tr_b16 v[228:229], v27 offset:1024
    ds_read_b64_tr_b16 v[230:231], v27 offset:3072
    s_waitcnt vmcnt(2)
    s_waitcnt lgkmcnt(4)
    v_mfma_f32_32x32x16_bf16 v[48:63], v[216:219], v[120:123], v[48:63]
    ds_read_b64_tr_b16 v[236:237], v27 offset:8192
    ds_read_b64_tr_b16 v[238:239], v27 offset:10240
    v_mfma_f32_32x32x16_bf16 v[200:215], v[220:223], v[120:123], v[200:215]
    ds_read_b64_tr_b16 v[244:245], v27 offset:9216
    ds_read_b64_tr_b16 v[246:247], v27 offset:11264
    s_waitcnt lgkmcnt(4)
    v_mfma_f32_32x32x16_bf16 v[48:63], v[224:227], v[124:127], v[48:63]
    ds_read_b64_tr_b16 v[232:233], v24 offset:8192
    ds_read_b64_tr_b16 v[234:235], v24 offset:10240
    v_mfma_f32_32x32x16_bf16 v[200:215], v[228:231], v[124:127], v[200:215]
    ds_read_b64_tr_b16 v[240:241], v24 offset:9216
    ds_read_b64_tr_b16 v[242:243], v24 offset:11264
    s_waitcnt vmcnt(0)
    s_waitcnt lgkmcnt(4)
    v_mfma_f32_32x32x16_bf16 v[200:215], v[236:239], v[128:131], v[200:215]
    v_mfma_f32_32x32x16_bf16 v[200:215], v[244:247], v[132:135], v[200:215]
    s_cmp_lt_u32 s46, 2
    s_mov_b32 s53, 0x20000
    s_cselect_b32 s53, 0x1e000, s53
    s_lshl_b32 s52, s51, 12
    v_lshlrev_b32 v9, 4, v0
    v_add_u32 v9, s53, v9
    s_waitcnt lgkmcnt(0)
    v_mfma_f32_32x32x16_bf16 v[48:63], v[232:235], v[128:131], v[48:63]
    v_add_u32 v8, s52, v9
    s_xor_b32 s52, s52, 0x1000
    v_add_u32 v9, s52, v9
    v_mfma_f32_32x32x16_bf16 v[48:63], v[240:243], v[132:135], v[48:63]
    s_nop 0
    ds_write_b128 v8, v[200:203] offset:0
    ds_write_b128 v8, v[204:207] offset:1024
    ds_write_b128 v8, v[208:211] offset:2048
    ds_write_b128 v8, v[212:215] offset:3072
    s_waitcnt lgkmcnt(0)
    s_barrier
    ds_read_b128 v[200:203], v9 offset:0
    ds_read_b128 v[204:207], v9 offset:1024
    ds_read_b128 v[208:211], v9 offset:2048
    ds_read_b128 v[212:215], v9 offset:3072
    s_movk_i32 s53, 0x4000
    v_and_b32 v5, 1, v0
    v_bfe_u32 v6, v0, 1, 1
    v_lshl_add_u32 v5, v5, 1, v6
    v_and_b32 v6, 60, v0
    v_lshl_add_u32 v5, v5, 6, v6
    s_waitcnt lgkmcnt(3)
    v_pk_add_f32 v[48:49], v[48:49], v[200:201]
    v_pk_add_f32 v[50:51], v[50:51], v[202:203]
    s_waitcnt lgkmcnt(2)
    v_pk_add_f32 v[52:53], v[52:53], v[204:205]
    v_pk_add_f32 v[54:55], v[54:55], v[206:207]
    s_waitcnt lgkmcnt(1)
    v_pk_add_f32 v[56:57], v[56:57], v[208:209]
    v_pk_add_f32 v[58:59], v[58:59], v[210:211]
    s_waitcnt lgkmcnt(0)
    .p2align 3
    v_pk_add_f32 v[60:61], v[60:61], v[212:213]
    v_pk_add_f32 v[62:63], v[62:63], v[214:215]
    v_cvt_pk_bf16_f32 v184, v48, v49
    v_cvt_pk_bf16_f32 v185, v50, v51
    v_cvt_pk_bf16_f32 v186, v52, v53
    v_cvt_pk_bf16_f32 v187, v54, v55
    v_cvt_pk_bf16_f32 v188, v56, v57
    v_cvt_pk_bf16_f32 v189, v58, v59
    v_cvt_pk_bf16_f32 v190, v60, v61
    v_cvt_pk_bf16_f32 v191, v62, v63
    v_permlane32_swap_b32 v184, v186
    v_permlane32_swap_b32 v185, v187
    v_permlane32_swap_b32 v188, v190
    v_permlane32_swap_b32 v189, v191
    s_nop 1
    v_permlane16_swap_b32 v184, v188
    v_permlane16_swap_b32 v185, v189
    v_permlane16_swap_b32 v186, v190
    v_permlane16_swap_b32 v187, v191
    ds_bpermute_b32 v192, v5, v184
    ds_bpermute_b32 v193, v5, v185
    ds_bpermute_b32 v194, v5, v186
    ds_bpermute_b32 v195, v5, v187
    ds_bpermute_b32 v196, v5, v188
    ds_bpermute_b32 v197, v5, v189
    ds_bpermute_b32 v198, v5, v190
    ds_bpermute_b32 v199, v5, v191
    s_waitcnt lgkmcnt(4)
    buffer_store_dwordx4 v[192:195], v15, s[28:31], 0 offen
    s_waitcnt lgkmcnt(0)
    buffer_store_dwordx4 v[196:199], v15, s[28:31], s53 offen
    s_endpgm
L_sl_1:
    buffer_store_dwordx4 v[192:195], v14, s[8:11], s56 offen sc1
    buffer_store_dwordx4 v[196:199], v14, s[8:11], s52 offen sc1
    s_branch L_sb_2
L_sl_3:
    s_mov_b64 exec, 1
    buffer_store_dword v4, v16, s[8:11], s47 offen sc1
    s_mov_b64 exec, -1
    s_branch L_sb_4
L_sl_7:
    buffer_store_dwordx4 v[184:187], v23, s[8:11], s56 offen offset:0 sc1
    buffer_store_dwordx4 v[188:191], v23, s[8:11], s56 offen offset:512 sc1
    s_branch L_sb_8
L_sl_9:
    buffer_store_dword v192, v19, s[8:11], s53 offen sc1
    s_branch L_sb_10
L_sl_11:
    s_mov_b64 exec, 1
    buffer_store_dword v4, v16, s[8:11], s47 offen sc1
    s_mov_b64 exec, -1
    s_branch L_sb_12
L_sl_13:
    buffer_store_dwordx4 v[188:191], v14, s[8:11], s52 offen sc1
    buffer_store_dwordx4 v[192:195], v14, s[8:11], s53 offen sc1
    s_branch L_sb_14
L_sl_15:
    buffer_store_dwordx4 v[196:199], v14, s[8:11], s52 offen sc1
    buffer_store_dwordx4 v[200:203], v14, s[8:11], s53 offen sc1
    s_branch L_sb_16
L_sl_17:
    s_mov_b64 exec, 1
    buffer_store_dword v4, v16, s[8:11], s47 offen sc1
    s_mov_b64 exec, -1
    s_branch L_sb_18
L_sl_19:
    buffer_store_dwordx4 v[204:207], v14, s[8:11], s52 offen sc1
    buffer_store_dwordx4 v[208:211], v14, s[8:11], s53 offen sc1
    s_branch L_sb_20
L_sl_21:
    s_mov_b64 exec, 1
    buffer_store_dword v4, v16, s[8:11], s47 offen sc1
    s_mov_b64 exec, -1
    s_branch L_sb_22
L_pl_23:
L_poll_25:
    buffer_load_dword v10, v22, s[8:11], 0 offen sc1
    s_waitcnt vmcnt(0)
    v_cmp_gt_u32 vcc, 4, v10
    s_cbranch_vccz L_polld_26
    s_add_u32 s58, s58, 1
    s_cmp_lt_u32 s58, 0x493e0
    s_cbranch_scc1 L_poll_25
L_polld_26:
    s_branch L_pb_24
L_sl_27:
    s_mov_b64 exec, 1
    buffer_store_dword v4, v16, s[8:11], s47 offen sc1
    s_mov_b64 exec, -1
    s_branch L_sb_28
L_pl_29:
L_poll_31:
    buffer_load_dword v10, v22, s[8:11], 0 offen sc1
    s_waitcnt vmcnt(0)
    v_cmp_gt_u32 vcc, 5, v10
    s_cbranch_vccz L_polld_32
    s_add_u32 s58, s58, 1
    s_cmp_lt_u32 s58, 0x493e0
    s_cbranch_scc1 L_poll_31
L_polld_32:
    s_branch L_pb_30
L_pl_33:
L_poll_35:
    buffer_load_dword v10, v22, s[8:11], 0 offen sc1
    s_waitcnt vmcnt(0)
    v_cmp_gt_u32 vcc, 6, v10
    s_cbranch_vccz L_polld_36
    s_add_u32 s58, s58, 1
    s_cmp_lt_u32 s58, 0x493e0
    s_cbranch_scc1 L_poll_35
L_polld_36:
    s_branch L_pb_34
L_sl_37:
    buffer_store_dwordx4 v[184:187], v23, s[8:11], s56 offen offset:0 sc1
    buffer_store_dwordx4 v[188:191], v23, s[8:11], s56 offen offset:512 sc1
    s_branch L_sb_38
L_sl_39:
    buffer_store_dword v192, v19, s[8:11], s53 offen sc1
    s_branch L_sb_40
L_sl_44:
    s_mov_b64 exec, 1
    buffer_store_dword v4, v16, s[8:11], s47 offen sc1
    s_mov_b64 exec, -1
    s_branch L_sb_45
L_sl_46:
    s_mov_b64 exec, 1
    buffer_store_dword v4, v16, s[8:11], s47 offen sc1
    s_mov_b64 exec, -1
    s_branch L_sb_47
L_sl_48:
    buffer_store_dwordx4 v[192:195], v14, s[8:11], s56 offen sc1
    buffer_store_dwordx4 v[196:199], v14, s[8:11], s52 offen sc1
    s_branch L_sb_49
L_sl_50:
    s_mov_b64 exec, 1
    buffer_store_dword v4, v16, s[8:11], s47 offen sc1
    s_mov_b64 exec, -1
    s_branch L_sb_51
L_sl_54:
    buffer_store_dwordx4 v[184:187], v23, s[8:11], s56 offen offset:0 sc1
    buffer_store_dwordx4 v[188:191], v23, s[8:11], s56 offen offset:512 sc1
    s_branch L_sb_55
L_sl_56:
    buffer_store_dword v192, v19, s[8:11], s53 offen sc1
    s_branch L_sb_57
L_sl_58:
    s_mov_b64 exec, 1
    buffer_store_dword v4, v16, s[8:11], s47 offen sc1
    s_mov_b64 exec, -1
    s_branch L_sb_59
L_sl_60:
    buffer_store_dwordx4 v[188:191], v14, s[8:11], s52 offen sc1
    buffer_store_dwordx4 v[192:195], v14, s[8:11], s53 offen sc1
    s_branch L_sb_61
L_sl_62:
    s_mov_b64 exec, 1
    buffer_store_dword v4, v16, s[8:11], s47 offen sc1
    s_mov_b64 exec, -1
    s_branch L_sb_63
L_sl_64:
    buffer_store_dwordx4 v[196:199], v14, s[8:11], s52 offen sc1
    buffer_store_dwordx4 v[200:203], v14, s[8:11], s53 offen sc1
    s_branch L_sb_65
L_pl_66:
L_poll_68:
    buffer_load_dword v10, v22, s[8:11], 0 offen sc1
    s_waitcnt vmcnt(0)
    v_cmp_gt_u32 vcc, 12, v10
    s_cbranch_vccz L_polld_69
    s_add_u32 s58, s58, 1
    s_cmp_lt_u32 s58, 0x493e0
    s_cbranch_scc1 L_poll_68
L_polld_69:
    s_branch L_pb_67
L_sl_70:
    s_mov_b64 exec, 1
    buffer_store_dword v4, v16, s[8:11], s47 offen sc1
    s_mov_b64 exec, -1
    s_branch L_sb_71
L_sl_72:
    buffer_store_dwordx4 v[204:207], v14, s[8:11], s52 offen sc1
    buffer_store_dwordx4 v[208:211], v14, s[8:11], s53 offen sc1
    s_branch L_sb_73
L_sl_74:
    s_mov_b64 exec, 1
    buffer_store_dword v4, v16, s[8:11], s47 offen sc1
    s_mov_b64 exec, -1
    s_branch L_sb_75
L_pl_76:
L_poll_78:
    buffer_load_dword v10, v22, s[8:11], 0 offen sc1
    s_waitcnt vmcnt(0)
    v_cmp_gt_u32 vcc, 13, v10
    s_cbranch_vccz L_polld_79
    s_add_u32 s58, s58, 1
    s_cmp_lt_u32 s58, 0x493e0
    s_cbranch_scc1 L_poll_78
L_polld_79:
    s_branch L_pb_77
L_pl_80:
L_poll_82:
    buffer_load_dword v10, v22, s[8:11], 0 offen sc1
    s_waitcnt vmcnt(0)
    v_cmp_gt_u32 vcc, 14, v10
    s_cbranch_vccz L_polld_83
    s_add_u32 s58, s58, 1
    s_cmp_lt_u32 s58, 0x493e0
    s_cbranch_scc1 L_poll_82
L_polld_83:
    s_branch L_pb_81
L_LB2:
    s_add_u32 m0, s59, 0x18000
    s_add_u32 s56, s86, 0x18000
    buffer_load_dwordx4 v6, s[12:15], s56 offen lds
    buffer_load_dwordx4 v7, s[12:15], s56 offen offset:1024 lds
    s_add_u32 m0, s59, 0x19000
    s_add_u32 s56, s86, 0x18400
    buffer_load_dwordx4 v6, s[12:15], s56 offen lds
    buffer_load_dwordx4 v7, s[12:15], s56 offen offset:1024 lds
    s_add_u32 m0, s59, 0x1a000
    s_add_u32 s56, s86, 0x18800
    buffer_load_dwordx4 v6, s[12:15], s56 offen lds
    buffer_load_dwordx4 v7, s[12:15], s56 offen offset:1024 lds
    s_add_u32 s86, s91, 3
    s_and_b32 s86, s86, 7
    s_mul_i32 s86, s86, 0x30000
    s_add_u32 m0, s59, 0x1e000
    s_add_u32 s56, s86, 0x0
    buffer_load_dwordx4 v6, s[12:15], s56 offen lds
    buffer_load_dwordx4 v7, s[12:15], s56 offen offset:1024 lds
    s_add_u32 m0, s59, 0x1f000
    s_add_u32 s56, s86, 0x400
    buffer_load_dwordx4 v6, s[12:15], s56 offen lds
    buffer_load_dwordx4 v7, s[12:15], s56 offen offset:1024 lds
    s_add_u32 m0, s59, 0x20000
    s_add_u32 s56, s86, 0x800
    buffer_load_dwordx4 v6, s[12:15], s56 offen lds
    buffer_load_dwordx4 v7, s[12:15], s56 offen offset:1024 lds
    s_waitcnt vmcnt(18)
    s_barrier
    s_add_u32 m0, s59, 0x21000
    s_add_u32 s56, s86, 0x18000
    buffer_load_dwordx4 v6, s[12:15], s56 offen lds
    buffer_load_dwordx4 v7, s[12:15], s56 offen offset:1024 lds
    s_add_u32 m0, s59, 0x22000
    s_add_u32 s56, s86, 0x18400
    buffer_load_dwordx4 v6, s[12:15], s56 offen lds
    buffer_load_dwordx4 v7, s[12:15], s56 offen offset:1024 lds
    s_add_u32 m0, s59, 0x23000
    s_add_u32 s56, s86, 0x18800
    buffer_load_dwordx4 v6, s[12:15], s56 offen lds
    buffer_load_dwordx4 v7, s[12:15], s56 offen offset:1024 lds
    s_add_u32 s86, s91, 4
    s_and_b32 s86, s86, 7
    s_mul_i32 s86, s86, 0x30000
    s_add_u32 m0, s59, 0x0
    s_add_u32 s56, s86, 0x0
    buffer_load_dwordx4 v6, s[12:15], s56 offen lds
    buffer_load_dwordx4 v7, s[12:15], s56 offen offset:1024 lds
    s_add_u32 m0, s59, 0x1000
    s_add_u32 s56, s86, 0x400
    buffer_load_dwordx4 v6, s[12:15], s56 offen lds
    buffer_load_dwordx4 v7, s[12:15], s56 offen offset:1024 lds
    s_add_u32 m0, s59, 0x2000
    s_add_u32 s56, s86, 0x800
    buffer_load_dwordx4 v6, s[12:15], s56 offen lds
    buffer_load_dwordx4 v7, s[12:15], s56 offen offset:1024 lds
    s_waitcnt vmcnt(18)
    s_barrier
    s_add_u32 m0, s59, 0x3000
    s_add_u32 s56, s86, 0x18000
    buffer_load_dwordx4 v6, s[12:15], s56 offen lds
    buffer_load_dwordx4 v7, s[12:15], s56 offen offset:1024 lds
    s_add_u32 m0, s59, 0x4000
    s_add_u32 s56, s86, 0x18400
    buffer_load_dwordx4 v6, s[12:15], s56 offen lds
    buffer_load_dwordx4 v7, s[12:15], s56 offen offset:1024 lds
    s_add_u32 m0, s59, 0x5000
    s_add_u32 s56, s86, 0x18800
    buffer_load_dwordx4 v6, s[12:15], s56 offen lds
    buffer_load_dwordx4 v7, s[12:15], s56 offen offset:1024 lds
    s_add_u32 s86, s91, 5
    s_and_b32 s86, s86, 7
    s_mul_i32 s86, s86, 0x30000
    s_add_u32 m0, s59, 0x9000
    s_add_u32 s56, s86, 0x0
    buffer_load_dwordx4 v6, s[12:15], s56 offen lds
    buffer_load_dwordx4 v7, s[12:15], s56 offen offset:1024 lds
    s_add_u32 m0, s59, 0xa000
    s_add_u32 s56, s86, 0x400
    buffer_load_dwordx4 v6, s[12:15], s56 offen lds
    buffer_load_dwordx4 v7, s[12:15], s56 offen offset:1024 lds
    s_add_u32 m0, s59, 0xb000
    s_add_u32 s56, s86, 0x800
    buffer_load_dwordx4 v6, s[12:15], s56 offen lds
    buffer_load_dwordx4 v7, s[12:15], s56 offen offset:1024 lds
    s_waitcnt vmcnt(18)
    s_barrier
    s_add_u32 m0, s59, 0xc000
    s_add_u32 s56, s86, 0x18000
    buffer_load_dwordx4 v6, s[12:15], s56 offen lds
    buffer_load_dwordx4 v7, s[12:15], s56 offen offset:1024 lds
    s_add_u32 m0, s59, 0xd000
    s_add_u32 s56, s86, 0x18400
    buffer_load_dwordx4 v6, s[12:15], s56 offen lds
    buffer_load_dwordx4 v7, s[12:15], s56 offen offset:1024 lds
    s_add_u32 m0, s59, 0xe000
    s_add_u32 s56, s86, 0x18800
    buffer_load_dwordx4 v6, s[12:15], s56 offen lds
    buffer_load_dwordx4 v7, s[12:15], s56 offen offset:1024 lds
    s_add_u32 s86, s91, 6
    s_and_b32 s86, s86, 7
    s_mul_i32 s86, s86, 0x30000
    s_add_u32 m0, s59, 0x12000
    s_add_u32 s56, s86, 0x0
    buffer_load_dwordx4 v6, s[12:15], s56 offen lds
    buffer_load_dwordx4 v7, s[12:15], s56 offen offset:1024 lds
    s_add_u32 m0, s59, 0x13000
    s_add_u32 s56, s86, 0x400
    buffer_load_dwordx4 v6, s[12:15], s56 offen lds
    buffer_load_dwordx4 v7, s[12:15], s56 offen offset:1024 lds
    s_add_u32 m0, s59, 0x14000
    s_add_u32 s56, s86, 0x800
    buffer_load_dwordx4 v6, s[12:15], s56 offen lds
    buffer_load_dwordx4 v7, s[12:15], s56 offen offset:1024 lds
    ds_read_b128 v[100:103], v14 offset:16384
    ds_read_b128 v[104:107], v14 offset:20480
    ds_read_b128 v[108:111], v14 offset:24576
    ds_read_b128 v[112:115], v14 offset:28672
    ds_read_b128 v[116:119], v14 offset:32768
    ds_read_b128 v[120:123], v14 offset:36864
    s_waitcnt vmcnt(18)
    s_waitcnt lgkmcnt(0)
    s_barrier
    s_add_u32 m0, s59, 0x15000
    s_add_u32 s56, s86, 0x18000
    buffer_load_dwordx4 v6, s[12:15], s56 offen lds
    buffer_load_dwordx4 v7, s[12:15], s56 offen offset:1024 lds
    s_add_u32 m0, s59, 0x16000
    s_add_u32 s56, s86, 0x18400
    buffer_load_dwordx4 v6, s[12:15], s56 offen lds
    buffer_load_dwordx4 v7, s[12:15], s56 offen offset:1024 lds
    s_add_u32 m0, s59, 0x17000
    s_add_u32 s56, s86, 0x18800
    buffer_load_dwordx4 v6, s[12:15], s56 offen lds
    buffer_load_dwordx4 v7, s[12:15], s56 offen offset:1024 lds
    s_add_u32 s86, s91, 7
    s_and_b32 s86, s86, 7
    s_mul_i32 s86, s86, 0x30000
    s_add_u32 m0, s59, 0x1b000
    s_add_u32 s56, s86, 0x0
    buffer_load_dwordx4 v6, s[12:15], s56 offen lds
    buffer_load_dwordx4 v7, s[12:15], s56 offen offset:1024 lds
    s_add_u32 m0, s59, 0x1c000
    s_add_u32 s56, s86, 0x400
    buffer_load_dwordx4 v6, s[12:15], s56 offen lds
    buffer_load_dwordx4 v7, s[12:15], s56 offen offset:1024 lds
    s_add_u32 m0, s59, 0x1d000
    s_add_u32 s56, s86, 0x800
    buffer_load_dwordx4 v6, s[12:15], s56 offen lds
    buffer_load_dwordx4 v7, s[12:15], s56 offen offset:1024 lds
    s_add_u32 m0, s59, 0x1e000
    s_add_u32 s56, s86, 0x18000
    buffer_load_dwordx4 v6, s[12:15], s56 offen lds
    buffer_load_dwordx4 v7, s[12:15], s56 offen offset:1024 lds
    ds_read_b128 v[124:127], v12 offset:0
    ds_read_b128 v[128:131], v12 offset:4096
    ds_read_b128 v[132:135], v12 offset:8192
    ds_read_b128 v[136:139], v12 offset:12288
    ds_read_b128 v[140:143], v12 offset:16384
    ds_read_b128 v[144:147], v12 offset:20480
    s_waitcnt vmcnt(20)
    s_waitcnt lgkmcnt(0)
    s_barrier
    s_add_u32 m0, s59, 0x1f000
    s_add_u32 s56, s86, 0x18400
    buffer_load_dwordx4 v6, s[12:15], s56 offen lds
    buffer_load_dwordx4 v7, s[12:15], s56 offen offset:1024 lds
    s_add_u32 m0, s59, 0x20000
    s_add_u32 s56, s86, 0x18800
    buffer_load_dwordx4 v6, s[12:15], s56 offen lds
    buffer_load_dwordx4 v7, s[12:15], s56 offen offset:1024 lds
    s_add_u32 m0, s59, 0x21000
    s_mov_b32 s56, 0x0
    buffer_load_dwordx4 v8, s[16:19], s56 offen lds
    buffer_load_dwordx4 v9, s[16:19], s56 offen offset:1024 lds
    s_add_u32 m0, s59, 0x22000
    s_mov_b32 s56, 0x8000
    buffer_load_dwordx4 v8, s[16:19], s56 offen lds
    buffer_load_dwordx4 v9, s[16:19], s56 offen offset:1024 lds
    s_add_u32 m0, s59, 0x23000
    s_mov_b32 s56, 0x10000
    buffer_load_dwordx4 v8, s[16:19], s56 offen lds
    buffer_load_dwordx4 v9, s[16:19], s56 offen offset:1024 lds
    s_add_u32 m0, s59, 0x24000
    s_mov_b32 s56, 0x18000
    buffer_load_dwordx4 v8, s[16:19], s56 offen lds
    buffer_load_dwordx4 v9, s[16:19], s56 offen offset:1024 lds
    s_add_u32 m0, s59, 0x25000
    s_mov_b32 s56, 0x20000
    buffer_load_dwordx4 v8, s[16:19], s56 offen lds
    buffer_load_dwordx4 v9, s[16:19], s56 offen offset:1024 lds
    ds_read_b128 v[148:151], v12 offset:36864
    ds_read_b128 v[152:155], v12 offset:40960
    ds_read_b128 v[156:159], v12 offset:45056
    ds_read_b128 v[160:163], v12 offset:49152
    ds_read_b128 v[164:167], v13 offset:0
    ds_read_b128 v[168:171], v13 offset:4096
    s_waitcnt vmcnt(22)
    s_waitcnt lgkmcnt(0)
    s_barrier
    s_add_u32 m0, s59, 0x26000
    s_mov_b32 s56, 0x28000
    buffer_load_dwordx4 v8, s[16:19], s56 offen lds
    buffer_load_dwordx4 v9, s[16:19], s56 offen offset:1024 lds
    s_add_u32 m0, s59, 0x0
    s_mov_b32 s56, 0x30000
    buffer_load_dwordx4 v8, s[16:19], s56 offen lds
    buffer_load_dwordx4 v9, s[16:19], s56 offen offset:1024 lds
    s_add_u32 m0, s59, 0x1000
    s_mov_b32 s56, 0x38000
    buffer_load_dwordx4 v8, s[16:19], s56 offen lds
    buffer_load_dwordx4 v9, s[16:19], s56 offen offset:1024 lds
    s_add_u32 m0, s59, 0x2000
    s_mov_b32 s56, 0x40000
    buffer_load_dwordx4 v8, s[16:19], s56 offen lds
    buffer_load_dwordx4 v9, s[16:19], s56 offen offset:1024 lds
    s_add_u32 m0, s59, 0x3000
    s_mov_b32 s56, 0x48000
    buffer_load_dwordx4 v8, s[16:19], s56 offen lds
    buffer_load_dwordx4 v9, s[16:19], s56 offen offset:1024 lds
    s_add_u32 m0, s59, 0x4000
    s_mov_b32 s56, 0x50000
    buffer_load_dwordx4 v8, s[16:19], s56 offen lds
    buffer_load_dwordx4 v9, s[16:19], s56 offen offset:1024 lds
    ds_read_b128 v[172:175], v13 offset:20480
    ds_read_b128 v[176:179], v13 offset:24576
    ds_read_b128 v[180:183], v13 offset:28672
    ds_read_b128 v[184:187], v13 offset:32768
    ds_read_b128 v[188:191], v13 offset:36864
    ds_read_b128 v[192:195], v13 offset:40960
    s_waitcnt vmcnt(22)
    s_waitcnt lgkmcnt(0)
    s_barrier
    s_add_u32 m0, s59, 0x5000
    s_mov_b32 s56, 0x58000
    buffer_load_dwordx4 v8, s[16:19], s56 offen lds
    buffer_load_dwordx4 v9, s[16:19], s56 offen offset:1024 lds
    s_add_u32 m0, s59, 0x6000
    s_mov_b32 s56, 0x60000
    buffer_load_dwordx4 v8, s[16:19], s56 offen lds
    buffer_load_dwordx4 v9, s[16:19], s56 offen offset:1024 lds
    s_add_u32 m0, s59, 0x7000
    s_mov_b32 s56, 0x68000
    buffer_load_dwordx4 v8, s[16:19], s56 offen lds
    buffer_load_dwordx4 v9, s[16:19], s56 offen offset:1024 lds
    s_add_u32 m0, s59, 0x8000
    s_mov_b32 s56, 0x70000
    buffer_load_dwordx4 v8, s[16:19], s56 offen lds
    buffer_load_dwordx4 v9, s[16:19], s56 offen offset:1024 lds
    s_add_u32 m0, s59, 0x9000
    s_mov_b32 s56, 0x78000
    buffer_load_dwordx4 v8, s[16:19], s56 offen lds
    buffer_load_dwordx4 v9, s[16:19], s56 offen offset:1024 lds
    s_add_u32 s86, s45, 0
    s_and_b32 s86, s86, 7
    s_mul_i32 s86, s86, 0x2b000
    s_add_u32 s87, s86, s62
    s_add_u32 m0, s59, 0xa000
    s_add_u32 s56, s86, 0x0
    buffer_load_dwordx4 v10, s[20:23], s56 offen lds
    buffer_load_dwordx4 v11, s[20:23], s56 offen offset:1024 lds
    s_add_u32 m0, s59, 0xb000
    s_add_u32 s56, s87, 0x80
    buffer_load_dwordx4 v10, s[20:23], s56 offen lds
    buffer_load_dwordx4 v11, s[20:23], s56 offen offset:1024 lds
    ds_read_b128 v[196:199], v14 offset:4096
    ds_read_b128 v[200:203], v14 offset:8192
    ds_read_b128 v[204:207], v14 offset:12288
    s_waitcnt lgkmcnt(0)
    s_barrier
    s_add_u32 m0, s59, 0xc000
    s_add_u32 s56, s87, 0x100
    buffer_load_dwordx4 v10, s[20:23], s56 offen lds
    buffer_load_dwordx4 v11, s[20:23], s56 offen offset:1024 lds
    s_add_u32 m0, s59, 0xd000
    s_add_u32 s56, s86, 0x15800
    buffer_load_dwordx4 v10, s[20:23], s56 offen lds
    buffer_load_dwordx4 v11, s[20:23], s56 offen offset:1024 lds
    s_add_u32 m0, s59, 0xe000
    s_add_u32 s56, s87, 0x15880
    buffer_load_dwordx4 v10, s[20:23], s56 offen lds
    buffer_load_dwordx4 v11, s[20:23], s56 offen offset:1024 lds
    s_add_u32 m0, s59, 0xf000
    s_add_u32 s56, s87, 0x15900
    buffer_load_dwordx4 v10, s[20:23], s56 offen lds
    buffer_load_dwordx4 v11, s[20:23], s56 offen offset:1024 lds
    s_barrier
    s_add_u32 s86, s45, 1
    s_and_b32 s86, s86, 7
    s_mul_i32 s86, s86, 0x2b000
    s_add_u32 s87, s86, s62
    s_add_u32 m0, s59, 0x12000
    s_add_u32 s56, s86, 0x0
    buffer_load_dwordx4 v10, s[20:23], s56 offen lds
    buffer_load_dwordx4 v11, s[20:23], s56 offen offset:1024 lds
    s_add_u32 m0, s59, 0x13000
    s_add_u32 s56, s87, 0x80
    buffer_load_dwordx4 v10, s[20:23], s56 offen lds
    buffer_load_dwordx4 v11, s[20:23], s56 offen offset:1024 lds
    s_add_u32 m0, s59, 0x14000
    s_add_u32 s56, s87, 0x100
    buffer_load_dwordx4 v10, s[20:23], s56 offen lds
    buffer_load_dwordx4 v11, s[20:23], s56 offen offset:1024 lds
    s_add_u32 m0, s59, 0x15000
    s_add_u32 s56, s86, 0x15800
    buffer_load_dwordx4 v10, s[20:23], s56 offen lds
    buffer_load_dwordx4 v11, s[20:23], s56 offen offset:1024 lds
    s_add_u32 m0, s59, 0x16000
    s_add_u32 s56, s87, 0x15880
    buffer_load_dwordx4 v10, s[20:23], s56 offen lds
    buffer_load_dwordx4 v11, s[20:23], s56 offen offset:1024 lds
    s_add_u32 m0, s59, 0x17000
    s_add_u32 s56, s87, 0x15900
    buffer_load_dwordx4 v10, s[20:23], s56 offen lds
    buffer_load_dwordx4 v11, s[20:23], s56 offen offset:1024 lds
    s_add_u32 s86, s45, 2
    s_and_b32 s86, s86, 7
    s_mul_i32 s86, s86, 0x2b000
    s_add_u32 s87, s86, s62
    s_add_u32 m0, s59, 0x1a000
    s_add_u32 s56, s86, 0x0
    buffer_load_dwordx4 v10, s[20:23], s56 offen lds
    buffer_load_dwordx4 v11, s[20:23], s56 offen offset:1024 lds
    s_add_u32 m0, s59, 0x1b000
    s_add_u32 s56, s87, 0x80
    buffer_load_dwordx4 v10, s[20:23], s56 offen lds
    buffer_load_dwordx4 v11, s[20:23], s56 offen offset:1024 lds
    s_add_u32 m0, s59, 0x1c000
    s_add_u32 s56, s87, 0x100
    buffer_load_dwordx4 v10, s[20:23], s56 offen lds
    buffer_load_dwordx4 v11, s[20:23], s56 offen offset:1024 lds
    s_add_u32 m0, s59, 0x1d000
    s_add_u32 s56, s86, 0x15800
    s_waitcnt vmcnt(56)
    buffer_load_dwordx4 v10, s[20:23], s56 offen lds
    buffer_load_dwordx4 v11, s[20:23], s56 offen offset:1024 lds
    s_add_u32 m0, s59, 0x1e000
    s_add_u32 s56, s87, 0x15880
    buffer_load_dwordx4 v10, s[20:23], s56 offen lds
    buffer_load_dwordx4 v11, s[20:23], s56 offen offset:1024 lds
    s_add_u32 m0, s59, 0x1f000
    s_add_u32 s56, s87, 0x15900
    buffer_load_dwordx4 v10, s[20:23], s56 offen lds
    buffer_load_dwordx4 v11, s[20:23], s56 offen offset:1024 lds
    s_barrier
    v_bfe_u32 v1, v0, 3, 2
    v_lshrrev_b32 v2, 5, v0
    v_lshl_add_u32 v1, v2, 3, v1
    s_lshl_b32 s52, s51, 4
    s_and_b32 s53, s46, 2
    s_lshl1_add_u32 s52, s53, s52
    v_add_u32 v1, s52, v1
    v_bfe_u32 v5, v0, 4, 1
    v_lshl_add_u32 v2, v5, 1, v2
    v_lshlrev_b32 v2, 1, v2
    v_and_b32 v5, 7, v0
    v_xor_b32 v2, v2, v5
    v_lshlrev_b32 v2, 4, v2
    v_mul_u32_u24 v1, 2752, v1
    s_mul_i32 s52, s45, 384
    v_add3_u32 v5, v1, v2, s52
    s_add_u32 s53, s45, 3
    s_and_b32 s53, s53, 7
    s_mul_i32 s53, s53, 0x2b000
    s_add_u32 s52, s53, 0x0
    s_waitcnt vmcnt(56)
    buffer_load_dwordx4 v[52:55], v5, s[20:23], s52 offen
    s_add_u32 s53, s45, 3
    s_and_b32 s53, s53, 7
    s_mul_i32 s53, s53, 0x2b000
    s_add_u32 s53, s53, s62
    s_add_u32 s52, s53, 0x80
    buffer_load_dwordx4 v[56:59], v5, s[20:23], s52 offen
    s_add_u32 s53, s45, 3
    s_and_b32 s53, s53, 7
    s_mul_i32 s53, s53, 0x2b000
    s_add_u32 s53, s53, s62
    s_add_u32 s52, s53, 0x100
    buffer_load_dwordx4 v[60:63], v5, s[20:23], s52 offen
    s_add_u32 s53, s45, 3
    s_and_b32 s53, s53, 7
    s_mul_i32 s53, s53, 0x2b000
    s_add_u32 s52, s53, 0x15800
    buffer_load_dwordx4 v[64:67], v5, s[20:23], s52 offen
    s_add_u32 s53, s45, 3
    s_and_b32 s53, s53, 7
    s_mul_i32 s53, s53, 0x2b000
    s_add_u32 s53, s53, s62
    s_add_u32 s52, s53, 0x15880
    buffer_load_dwordx4 v[68:71], v5, s[20:23], s52 offen
    s_add_u32 s53, s45, 3
    s_and_b32 s53, s53, 7
    s_mul_i32 s53, s53, 0x2b000
    s_add_u32 s53, s53, s62
    s_add_u32 s52, s53, 0x15900
    buffer_load_dwordx4 v[72:75], v5, s[20:23], s52 offen
    s_add_u32 s53, s45, 4
    s_and_b32 s53, s53, 7
    s_mul_i32 s53, s53, 0x2b000
    s_add_u32 s52, s53, 0x0
    s_waitcnt vmcnt(56)
    buffer_load_dwordx4 v[76:79], v5, s[20:23], s52 offen
    s_add_u32 s53, s45, 4
    s_and_b32 s53, s53, 7
    s_mul_i32 s53, s53, 0x2b000
    s_add_u32 s53, s53, s62
    s_add_u32 s52, s53, 0x80
    buffer_load_dwordx4 v[80:83], v5, s[20:23], s52 offen
    s_add_u32 s53, s45, 4
    s_and_b32 s53, s53, 7
    s_mul_i32 s53, s53, 0x2b000
    s_add_u32 s53, s53, s62
    s_add_u32 s52, s53, 0x100
    buffer_load_dwordx4 v[84:87], v5, s[20:23], s52 offen
    s_add_u32 s53, s45, 4
    s_and_b32 s53, s53, 7
    s_mul_i32 s53, s53, 0x2b000
    s_add_u32 s52, s53, 0x15800
    buffer_load_dwordx4 v[88:91], v5, s[20:23], s52 offen
    s_add_u32 s53, s45, 4
    s_and_b32 s53, s53, 7
    s_mul_i32 s53, s53, 0x2b000
    s_add_u32 s53, s53, s62
    s_add_u32 s52, s53, 0x15880
    buffer_load_dwordx4 v[92:95], v5, s[20:23], s52 offen
    s_add_u32 s53, s45, 4
    s_and_b32 s53, s53, 7
    s_mul_i32 s53, s53, 0x2b000
    s_add_u32 s53, s53, s62
    s_add_u32 s52, s53, 0x15900
    buffer_load_dwordx4 v[96:99], v5, s[20:23], s52 offen
    s_barrier
    s_barrier
    s_waitcnt vmcnt(56)
    s_barrier
    s_waitcnt vmcnt(48)
    s_barrier
    s_barrier
    s_waitcnt vmcnt(0)
    ds_write_b128 v14, v[52:55] offset:32768
    ds_write_b128 v14, v[56:59] offset:36864
    ds_write_b128 v14, v[60:63] offset:40960
    ds_write_b128 v14, v[64:67] offset:45056
    ds_write_b128 v14, v[68:71] offset:49152
    ds_write_b128 v12, v[72:75] offset:0
    s_waitcnt lgkmcnt(0)
    s_barrier
    ds_write_b128 v12, v[76:79] offset:12288
    ds_write_b128 v12, v[80:83] offset:16384
    ds_write_b128 v12, v[84:87] offset:20480
    ds_write_b128 v12, v[88:91] offset:24576
    ds_write_b128 v12, v[92:95] offset:28672
    ds_write_b128 v12, v[96:99] offset:32768
    s_waitcnt lgkmcnt(0)
    s_barrier
    s_barrier
    s_barrier
    s_add_u32 s86, s45, 5
    s_and_b32 s86, s86, 7
    s_mul_i32 s86, s86, 0x2b000
    s_add_u32 s87, s86, s62
    s_add_u32 m0, s59, 0xb000
    s_add_u32 s56, s86, 0x0
    buffer_load_dwordx4 v10, s[20:23], s56 offen lds
    buffer_load_dwordx4 v11, s[20:23], s56 offen offset:1024 lds
    s_add_u32 m0, s59, 0xc000
    s_add_u32 s56, s87, 0x80
    buffer_load_dwordx4 v10, s[20:23], s56 offen lds
    buffer_load_dwordx4 v11, s[20:23], s56 offen offset:1024 lds
    s_add_u32 m0, s59, 0xd000
    s_add_u32 s56, s87, 0x100
    buffer_load_dwordx4 v10, s[20:23], s56 offen lds
    buffer_load_dwordx4 v11, s[20:23], s56 offen offset:1024 lds
    s_add_u32 m0, s59, 0xe000
    s_add_u32 s56, s86, 0x15800
    buffer_load_dwordx4 v10, s[20:23], s56 offen lds
    buffer_load_dwordx4 v11, s[20:23], s56 offen offset:1024 lds
    ds_read_b128 v[208:211], v13 offset:28672
    ds_read_b128 v[212:215], v13 offset:32768
    ds_read_b128 v[216:219], v13 offset:36864
    ds_read_b128 v[220:223], v13 offset:40960
    s_waitcnt lgkmcnt(0)
    s_barrier
    s_add_u32 m0, s59, 0xf000
    s_add_u32 s56, s87, 0x15880
    buffer_load_dwordx4 v10, s[20:23], s56 offen lds
    buffer_load_dwordx4 v11, s[20:23], s56 offen offset:1024 lds
    s_add_u32 m0, s59, 0x10000
    s_add_u32 s56, s87, 0x15900
    buffer_load_dwordx4 v10, s[20:23], s56 offen lds
    buffer_load_dwordx4 v11, s[20:23], s56 offen offset:1024 lds
    s_add_u32 s86, s45, 6
    s_and_b32 s86, s86, 7
    s_mul_i32 s86, s86, 0x2b000
    s_add_u32 s87, s86, s62
    s_add_u32 m0, s59, 0x13000
    s_add_u32 s56, s86, 0x0
    buffer_load_dwordx4 v10, s[20:23], s56 offen lds
    buffer_load_dwordx4 v11, s[20:23], s56 offen offset:1024 lds
    ds_read_b128 v[224:227], v14 offset:0
    ds_read_b128 v[228:231], v14 offset:4096
    ds_read_b128 v[232:235], v14 offset:8192
    ds_read_b128 v[236:239], v14 offset:12288
    ds_read_b128 v[240:243], v14 offset:16384
    ds_read_b128 v[244:247], v14 offset:20480
    s_waitcnt lgkmcnt(0)
    s_barrier
    s_add_u32 m0, s59, 0x14000
    s_add_u32 s56, s87, 0x80
    buffer_load_dwordx4 v10, s[20:23], s56 offen lds
    buffer_load_dwordx4 v11, s[20:23], s56 offen offset:1024 lds
    s_add_u32 m0, s59, 0x15000
    s_add_u32 s56, s87, 0x100
    buffer_load_dwordx4 v10, s[20:23], s56 offen lds
    buffer_load_dwordx4 v11, s[20:23], s56 offen offset:1024 lds
    s_add_u32 m0, s59, 0x16000
    s_add_u32 s56, s86, 0x15800
    buffer_load_dwordx4 v10, s[20:23], s56 offen lds
    buffer_load_dwordx4 v11, s[20:23], s56 offen offset:1024 lds
    s_barrier
    s_add_u32 m0, s59, 0x17000
    s_add_u32 s56, s87, 0x15880
    buffer_load_dwordx4 v10, s[20:23], s56 offen lds
    buffer_load_dwordx4 v11, s[20:23], s56 offen offset:1024 lds
    s_add_u32 m0, s59, 0x18000
    s_add_u32 s56, s87, 0x15900
    buffer_load_dwordx4 v10, s[20:23], s56 offen lds
    buffer_load_dwordx4 v11, s[20:23], s56 offen offset:1024 lds
    s_add_u32 s86, s45, 7
    s_and_b32 s86, s86, 7
    s_mul_i32 s86, s86, 0x2b000
    s_add_u32 s87, s86, s62
    s_add_u32 m0, s59, 0x1b000
    s_add_u32 s56, s86, 0x0
    buffer_load_dwordx4 v10, s[20:23], s56 offen lds
    buffer_load_dwordx4 v11, s[20:23], s56 offen offset:1024 lds
    s_waitcnt vmcnt(14)
    s_barrier
    s_add_u32 m0, s59, 0x1c000
    s_add_u32 s56, s87, 0x80
    buffer_load_dwordx4 v10, s[20:23], s56 offen lds
    buffer_load_dwordx4 v11, s[20:23], s56 offen offset:1024 lds
    s_add_u32 m0, s59, 0x1d000
    s_add_u32 s56, s87, 0x100
    buffer_load_dwordx4 v10, s[20:23], s56 offen lds
    buffer_load_dwordx4 v11, s[20:23], s56 offen offset:1024 lds
    s_add_u32 m0, s59, 0x1e000
    s_add_u32 s56, s86, 0x15800
    buffer_load_dwordx4 v10, s[20:23], s56 offen lds
    buffer_load_dwordx4 v11, s[20:23], s56 offen offset:1024 lds
    s_add_u32 m0, s59, 0x1f000
    s_add_u32 s56, s87, 0x15880
    buffer_load_dwordx4 v10, s[20:23], s56 offen lds
    buffer_load_dwordx4 v11, s[20:23], s56 offen offset:1024 lds
    s_add_u32 m0, s59, 0x20000
    s_add_u32 s56, s87, 0x15900
    buffer_load_dwordx4 v10, s[20:23], s56 offen lds
    buffer_load_dwordx4 v11, s[20:23], s56 offen offset:1024 lds
    s_waitcnt vmcnt(12)
    s_barrier
    s_add_u32 m0, s59, 0x23000
    s_mov_b32 s56, 0x0
    buffer_load_dwordx4 v8, s[24:27], s56 offen lds
    buffer_load_dwordx4 v9, s[24:27], s56 offen offset:1024 lds
    s_add_u32 m0, s59, 0x24000
    s_mov_b32 s56, 0x8000
    buffer_load_dwordx4 v8, s[24:27], s56 offen lds
    buffer_load_dwordx4 v9, s[24:27], s56 offen offset:1024 lds
    s_add_u32 m0, s59, 0x25000
    s_mov_b32 s56, 0x30000
    buffer_load_dwordx4 v8, s[24:27], s56 offen lds
    buffer_load_dwordx4 v9, s[24:27], s56 offen offset:1024 lds
    s_add_u32 m0, s59, 0x26000
    s_mov_b32 s56, 0x38000
    buffer_load_dwordx4 v8, s[24:27], s56 offen lds
    buffer_load_dwordx4 v9, s[24:27], s56 offen offset:1024 lds
    s_add_u32 m0, s59, 0x0
    s_mov_b32 s56, 0x60000
    buffer_load_dwordx4 v8, s[24:27], s56 offen lds
    buffer_load_dwordx4 v9, s[24:27], s56 offen offset:1024 lds
    s_waitcnt vmcnt(10)
    s_barrier
    s_add_u32 m0, s59, 0x1000
    s_mov_b32 s56, 0x68000
    buffer_load_dwordx4 v8, s[24:27], s56 offen lds
    buffer_load_dwordx4 v9, s[24:27], s56 offen offset:1024 lds
    s_add_u32 m0, s59, 0x2000
    s_mov_b32 s56, 0x90000
    buffer_load_dwordx4 v8, s[24:27], s56 offen lds
    buffer_load_dwordx4 v9, s[24:27], s56 offen offset:1024 lds
    s_add_u32 m0, s59, 0x3000
    s_mov_b32 s56, 0x98000
    buffer_load_dwordx4 v8, s[24:27], s56 offen lds
    buffer_load_dwordx4 v9, s[24:27], s56 offen offset:1024 lds
    s_add_u32 m0, s59, 0x4000
    s_mov_b32 s56, 0xc0000
    buffer_load_dwordx4 v8, s[24:27], s56 offen lds
    buffer_load_dwordx4 v9, s[24:27], s56 offen offset:1024 lds
    s_add_u32 m0, s59, 0x5000
    s_mov_b32 s56, 0xc8000
    buffer_load_dwordx4 v8, s[24:27], s56 offen lds
    buffer_load_dwordx4 v9, s[24:27], s56 offen offset:1024 lds
    s_barrier
    s_add_u32 m0, s59, 0x6000
    s_mov_b32 s56, 0xf0000
    buffer_load_dwordx4 v8, s[24:27], s56 offen lds
    buffer_load_dwordx4 v9, s[24:27], s56 offen offset:1024 lds
    s_add_u32 m0, s59, 0x7000
    s_mov_b32 s56, 0xf8000
    buffer_load_dwordx4 v8, s[24:27], s56 offen lds
    buffer_load_dwordx4 v9, s[24:27], s56 offen offset:1024 lds
    s_add_u32 m0, s59, 0x8000
    s_mov_b32 s56, 0x120000
    buffer_load_dwordx4 v8, s[24:27], s56 offen lds
    buffer_load_dwordx4 v9, s[24:27], s56 offen offset:1024 lds
    s_add_u32 m0, s59, 0x9000
    s_mov_b32 s56, 0x128000
    buffer_load_dwordx4 v8, s[24:27], s56 offen lds
    buffer_load_dwordx4 v9, s[24:27], s56 offen offset:1024 lds
    s_add_u32 m0, s59, 0xa000
    s_mov_b32 s56, 0x150000
    buffer_load_dwordx4 v8, s[24:27], s56 offen lds
    buffer_load_dwordx4 v9, s[24:27], s56 offen offset:1024 lds
    s_add_u32 m0, s59, 0xb000
    s_mov_b32 s56, 0x158000
    buffer_load_dwordx4 v8, s[24:27], s56 offen lds
    buffer_load_dwordx4 v9, s[24:27], s56 offen offset:1024 lds
    s_add_u32 m0, s59, 0xc000
    s_mov_b32 s56, 0x10000
    buffer_load_dwordx4 v8, s[24:27], s56 offen lds
    buffer_load_dwordx4 v9, s[24:27], s56 offen offset:1024 lds
    s_add_u32 m0, s59, 0xd000
    s_mov_b32 s56, 0x18000
    buffer_load_dwordx4 v8, s[24:27], s56 offen lds
    buffer_load_dwordx4 v9, s[24:27], s56 offen offset:1024 lds
    s_add_u32 m0, s59, 0xe000
    s_mov_b32 s56, 0x40000
    buffer_load_dwordx4 v8, s[24:27], s56 offen lds
    buffer_load_dwordx4 v9, s[24:27], s56 offen offset:1024 lds
    s_add_u32 m0, s59, 0xf000
    s_mov_b32 s56, 0x48000
    buffer_load_dwordx4 v8, s[24:27], s56 offen lds
    buffer_load_dwordx4 v9, s[24:27], s56 offen offset:1024 lds
    s_add_u32 m0, s59, 0x10000
    s_mov_b32 s56, 0x70000
    buffer_load_dwordx4 v8, s[24:27], s56 offen lds
    buffer_load_dwordx4 v9, s[24:27], s56 offen offset:1024 lds
    s_add_u32 m0, s59, 0x11000
    s_mov_b32 s56, 0x78000
    buffer_load_dwordx4 v8, s[24:27], s56 offen lds
    buffer_load_dwordx4 v9, s[24:27], s56 offen offset:1024 lds
    s_add_u32 m0, s59, 0x12000
    s_mov_b32 s56, 0xa0000
    buffer_load_dwordx4 v8, s[24:27], s56 offen lds
    buffer_load_dwordx4 v9, s[24:27], s56 offen offset:1024 lds
    s_add_u32 m0, s59, 0x13000
    s_mov_b32 s56, 0xa8000
    buffer_load_dwordx4 v8, s[24:27], s56 offen lds
    buffer_load_dwordx4 v9, s[24:27], s56 offen offset:1024 lds
    s_add_u32 m0, s59, 0x14000
    s_mov_b32 s56, 0xd0000
    buffer_load_dwordx4 v8, s[24:27], s56 offen lds
    buffer_load_dwordx4 v9, s[24:27], s56 offen offset:1024 lds
    s_add_u32 m0, s59, 0x15000
    s_mov_b32 s56, 0xd8000
    buffer_load_dwordx4 v8, s[24:27], s56 offen lds
    buffer_load_dwordx4 v9, s[24:27], s56 offen offset:1024 lds
    s_add_u32 m0, s59, 0x16000
    s_mov_b32 s56, 0x100000
    buffer_load_dwordx4 v8, s[24:27], s56 offen lds
    buffer_load_dwordx4 v9, s[24:27], s56 offen offset:1024 lds
    s_add_u32 m0, s59, 0x17000
    s_mov_b32 s56, 0x108000
    buffer_load_dwordx4 v8, s[24:27], s56 offen lds
    buffer_load_dwordx4 v9, s[24:27], s56 offen offset:1024 lds
    s_add_u32 m0, s59, 0x18000
    s_mov_b32 s56, 0x130000
    buffer_load_dwordx4 v8, s[24:27], s56 offen lds
    buffer_load_dwordx4 v9, s[24:27], s56 offen offset:1024 lds
    s_add_u32 m0, s59, 0x19000
    s_mov_b32 s56, 0x138000
    buffer_load_dwordx4 v8, s[24:27], s56 offen lds
    buffer_load_dwordx4 v9, s[24:27], s56 offen offset:1024 lds
    s_add_u32 m0, s59, 0x1a000
    s_mov_b32 s56, 0x20000
    buffer_load_dwordx4 v8, s[24:27], s56 offen lds
    buffer_load_dwordx4 v9, s[24:27], s56 offen offset:1024 lds
    s_add_u32 m0, s59, 0x1b000
    s_mov_b32 s56, 0x28000
    s_waitcnt vmcnt(56)
    buffer_load_dwordx4 v8, s[24:27], s56 offen lds
    buffer_load_dwordx4 v9, s[24:27], s56 offen offset:1024 lds
    s_waitcnt vmcnt(56)
    s_barrier
    s_add_u32 m0, s59, 0x1c000
    s_mov_b32 s56, 0x50000
    buffer_load_dwordx4 v8, s[24:27], s56 offen lds
    buffer_load_dwordx4 v9, s[24:27], s56 offen offset:1024 lds
    s_add_u32 m0, s59, 0x1d000
    s_mov_b32 s56, 0x58000
    buffer_load_dwordx4 v8, s[24:27], s56 offen lds
    buffer_load_dwordx4 v9, s[24:27], s56 offen offset:1024 lds
    s_add_u32 m0, s59, 0x1e000
    s_mov_b32 s56, 0x80000
    buffer_load_dwordx4 v8, s[24:27], s56 offen lds
    buffer_load_dwordx4 v9, s[24:27], s56 offen offset:1024 lds
    s_waitcnt vmcnt(60)
    s_add_u32 m0, s59, 0x1f000
    s_mov_b32 s56, 0x88000
    buffer_load_dwordx4 v8, s[24:27], s56 offen lds
    buffer_load_dwordx4 v9, s[24:27], s56 offen offset:1024 lds
    s_waitcnt vmcnt(60)
    s_waitcnt vmcnt(56)
    s_barrier
    s_add_u32 m0, s59, 0x20000
    s_mov_b32 s56, 0xb0000
    buffer_load_dwordx4 v8, s[24:27], s56 offen lds
    buffer_load_dwordx4 v9, s[24:27], s56 offen offset:1024 lds
    s_add_u32 m0, s59, 0x21000
    s_mov_b32 s56, 0xb8000
    buffer_load_dwordx4 v8, s[24:27], s56 offen lds
    buffer_load_dwordx4 v9, s[24:27], s56 offen offset:1024 lds
    s_add_u32 m0, s59, 0x22000
    s_mov_b32 s56, 0xe0000
    buffer_load_dwordx4 v8, s[24:27], s56 offen lds
    buffer_load_dwordx4 v9, s[24:27], s56 offen offset:1024 lds
    s_add_u32 m0, s59, 0x23000
    s_mov_b32 s56, 0xe8000
    s_waitcnt vmcnt(56)
    buffer_load_dwordx4 v8, s[24:27], s56 offen lds
    buffer_load_dwordx4 v9, s[24:27], s56 offen offset:1024 lds
    s_waitcnt vmcnt(56)
    s_barrier
    s_add_u32 m0, s59, 0x24000
    s_mov_b32 s56, 0x110000
    buffer_load_dwordx4 v8, s[24:27], s56 offen lds
    buffer_load_dwordx4 v9, s[24:27], s56 offen offset:1024 lds
    s_add_u32 m0, s59, 0x25000
    s_mov_b32 s56, 0x118000
    buffer_load_dwordx4 v8, s[24:27], s56 offen lds
    buffer_load_dwordx4 v9, s[24:27], s56 offen offset:1024 lds
    s_add_u32 m0, s59, 0x0
    s_mov_b32 s56, 0x140000
    buffer_load_dwordx4 v8, s[24:27], s56 offen lds
    buffer_load_dwordx4 v9, s[24:27], s56 offen offset:1024 lds
    s_add_u32 m0, s59, 0x1000
    s_mov_b32 s56, 0x148000
    s_waitcnt vmcnt(56)
    buffer_load_dwordx4 v8, s[24:27], s56 offen lds
    buffer_load_dwordx4 v9, s[24:27], s56 offen offset:1024 lds
    s_waitcnt vmcnt(56)
    s_barrier
    s_waitcnt vmcnt(48)
    s_barrier
    s_waitcnt vmcnt(40)
    s_barrier
    s_waitcnt vmcnt(32)
    s_barrier
    s_waitcnt vmcnt(24)
    s_barrier
    s_waitcnt vmcnt(16)
    s_barrier
    ds_read_b128 v[248:251], v12 offset:8192
    ds_write_b128 v12, v[100:103] offset:8192
    ds_read_b128 v[100:103], v12 offset:12288
    ds_write_b128 v12, v[104:107] offset:12288
    s_waitcnt vmcnt(8)
    s_barrier
    ds_read_b128 v[104:107], v12 offset:16384
    ds_write_b128 v12, v[108:111] offset:16384
    ds_read_b128 v[108:111], v12 offset:20480
    ds_write_b128 v12, v[112:115] offset:20480
    s_waitcnt vmcnt(0)
    s_barrier
    s_barrier
    ds_read_b128 v[112:115], v12 offset:24576
    ds_write_b128 v12, v[116:119] offset:24576
    ds_read_b128 v[116:119], v12 offset:28672
    ds_write_b128 v12, v[120:123] offset:28672
    ds_read_b128 v[120:123], v12 offset:45056
    ds_write_b128 v12, v[124:127] offset:45056
    ds_read_b128 v[124:127], v12 offset:49152
    ds_write_b128 v12, v[128:131] offset:49152
    ds_read_b128 v[128:131], v13 offset:0
    ds_write_b128 v13, v[132:135] offset:0
    ds_read_b128 v[132:135], v13 offset:4096
    ds_write_b128 v13, v[136:139] offset:4096
    ds_read_b128 v[136:139], v13 offset:8192
    ds_write_b128 v13, v[140:143] offset:8192
    ds_read_b128 v[140:143], v13 offset:12288
    ds_write_b128 v13, v[144:147] offset:12288
    s_waitcnt lgkmcnt(0)
    s_barrier
    ds_read_b128 v[144:147], v13 offset:28672
    ds_write_b128 v13, v[148:151] offset:28672
    ds_read_b128 v[148:151], v13 offset:32768
    ds_write_b128 v13, v[152:155] offset:32768
    ds_read_b128 v[152:155], v13 offset:36864
    ds_write_b128 v13, v[156:159] offset:36864
    ds_read_b128 v[156:159], v13 offset:40960
    ds_write_b128 v13, v[160:163] offset:40960
    ds_read_b128 v[160:163], v13 offset:45056
    ds_write_b128 v13, v[164:167] offset:45056
    ds_read_b128 v[164:167], v13 offset:49152
    ds_write_b128 v13, v[168:171] offset:49152
    ds_read_b128 v[168:171], v14 offset:12288
    ds_write_b128 v14, v[172:175] offset:12288
    ds_read_b128 v[172:175], v14 offset:16384
    ds_write_b128 v14, v[176:179] offset:16384
    ds_read_b128 v[176:179], v14 offset:20480
    ds_write_b128 v14, v[180:183] offset:20480
    ds_read_b128 v[180:183], v14 offset:24576
    ds_write_b128 v14, v[184:187] offset:24576
    ds_write_b128 v14, v[188:191] offset:28672
    ds_write_b128 v14, v[192:195] offset:32768
    ds_read_b128 v[184:187], v14 offset:49152
    ds_write_b128 v14, v[196:199] offset:49152
    s_waitcnt lgkmcnt(0)
    v_lshlrev_b32 v1, 4, v0
    s_lshl_b32 s60, s51, 10
    v_add_u32 v1, s60, v1
    v_and_b32 v2, 31, v0
    v_lshlrev_b32 v2, 2, v2
    v_add_u32 v2, s47, v2
    s_mov_b32 s63, 0
L_hv_107:
    s_add_u32 s53, s91, 3
    s_and_b32 s53, s53, 7
    s_lshl_b32 s53, s53, 11
    s_add_u32 s53, s53, s50
    s_add_u32 s53, s53, 0x4000
    buffer_load_dwordx4 v[16:19], v1, s[8:11], s53 offen sc1
    s_add_u32 s53, s91, 4
    s_and_b32 s53, s53, 7
    s_lshl_b32 s53, s53, 11
    s_add_u32 s53, s53, s50
    s_add_u32 s53, s53, 0x4000
    buffer_load_dwordx4 v[20:23], v1, s[8:11], s53 offen sc1
    s_add_u32 s53, s91, 5
    s_and_b32 s53, s53, 7
    s_lshl_b32 s53, s53, 11
    s_add_u32 s53, s53, s50
    s_add_u32 s53, s53, 0x4000
    buffer_load_dwordx4 v[24:27], v1, s[8:11], s53 offen sc1
    s_add_u32 s53, s91, 6
    s_and_b32 s53, s53, 7
    s_lshl_b32 s53, s53, 11
    s_add_u32 s53, s53, s50
    s_add_u32 s53, s53, 0x4000
    buffer_load_dwordx4 v[28:31], v1, s[8:11], s53 offen sc1
    s_add_u32 s53, s91, 7
    s_and_b32 s53, s53, 7
    s_lshl_b32 s53, s53, 11
    s_add_u32 s53, s53, s50
    s_add_u32 s53, s53, 0x4000
    buffer_load_dwordx4 v[32:35], v1, s[8:11], s53 offen sc1
    s_add_u32 s53, s91, 8
    s_and_b32 s53, s53, 7
    s_lshl_b32 s53, s53, 11
    s_add_u32 s53, s53, s50
    s_add_u32 s53, s53, 0x4000
    buffer_load_dwordx4 v[36:39], v1, s[8:11], s53 offen sc1
    s_add_u32 s53, s91, 9
    s_and_b32 s53, s53, 7
    s_lshl_b32 s53, s53, 11
    s_add_u32 s53, s53, s50
    s_add_u32 s53, s53, 0x4000
    buffer_load_dwordx4 v[40:43], v1, s[8:11], s53 offen sc1
    s_add_u32 s53, s91, 10
    s_and_b32 s53, s53, 7
    s_lshl_b32 s53, s53, 11
    s_add_u32 s53, s53, s50
    s_add_u32 s53, s53, 0x4000
    buffer_load_dwordx4 v[44:47], v1, s[8:11], s53 offen sc1
    s_add_u32 s53, s50, 0x3000
    buffer_load_dwordx4 v[48:51], v1, s[8:11], s53 offen sc1
    s_cmp_lg_u32 s63, 0
    s_cbranch_scc1 L_hk_109
    ds_write_b128 v12, v[200:203] offset:0
    ds_write_b128 v12, v[204:207] offset:4096
    s_mov_b32 s63, 1
L_hk_109:
    s_waitcnt vmcnt(0)
    v_add_u32 v2, 0x8000, v1
    ds_write_b128 v2, v[16:19]
    v_add_u32 v2, 0x11000, v1
    ds_write_b128 v2, v[20:23]
    v_add_u32 v2, 0x1a000, v1
    ds_write_b128 v2, v[24:27]
    v_add_u32 v2, 0x23000, v1
    ds_write_b128 v2, v[28:31]
    v_mov_b32 v4, 0
    v_max3_u32 v4, v4, v16, v17
    v_max3_u32 v4, v4, v18, v19
    v_max3_u32 v4, v4, v20, v21
    v_max3_u32 v4, v4, v22, v23
    v_max3_u32 v4, v4, v24, v25
    v_max3_u32 v4, v4, v26, v27
    v_max3_u32 v4, v4, v28, v29
    v_max3_u32 v4, v4, v30, v31
    v_max3_u32 v4, v4, v32, v33
    v_max3_u32 v4, v4, v34, v35
    v_max3_u32 v4, v4, v36, v37
    v_max3_u32 v4, v4, v38, v39
    v_max3_u32 v4, v4, v40, v41
    v_max3_u32 v4, v4, v42, v43
    v_max3_u32 v4, v4, v44, v45
    v_max3_u32 v4, v4, v46, v47
    v_max3_u32 v4, v4, v48, v49
    v_max3_u32 v4, v4, v50, v51
    v_cmp_eq_u32 vcc, -1, v4
    s_waitcnt lgkmcnt(0)
    s_cbranch_vccz L_hvd_108
    s_add_u32 s58, s58, 1
    s_cmp_lt_u32 s58, 0x493e0
    s_cbranch_scc1 L_hv_107
L_hvd_108:
    s_waitcnt lgkmcnt(0)
    s_barrier
    s_barrier
    s_add_u32 s86, s91, 7
    s_and_b32 s86, s86, 7
    s_mul_i32 s86, s86, 0x30000
    s_add_u32 m0, s59, 0x2000
    s_add_u32 s56, s86, 0x18000
    buffer_load_dwordx4 v6, s[12:15], s56 offen lds
    buffer_load_dwordx4 v7, s[12:15], s56 offen offset:1024 lds
    s_add_u32 m0, s59, 0x3000
    s_add_u32 s56, s86, 0x18400
    buffer_load_dwordx4 v6, s[12:15], s56 offen lds
    buffer_load_dwordx4 v7, s[12:15], s56 offen offset:1024 lds
    s_add_u32 m0, s59, 0x4000
    s_add_u32 s56, s86, 0x18800
    buffer_load_dwordx4 v6, s[12:15], s56 offen lds
    buffer_load_dwordx4 v7, s[12:15], s56 offen offset:1024 lds
    s_add_u32 s86, s91, 8
    s_and_b32 s86, s86, 7
    s_mul_i32 s86, s86, 0x30000
    s_add_u32 m0, s59, 0x8000
    s_add_u32 s56, s86, 0x0
    buffer_load_dwordx4 v6, s[12:15], s56 offen lds
    buffer_load_dwordx4 v7, s[12:15], s56 offen offset:1024 lds
    s_barrier
    s_add_u32 m0, s59, 0x9000
    s_add_u32 s56, s86, 0x400
    buffer_load_dwordx4 v6, s[12:15], s56 offen lds
    buffer_load_dwordx4 v7, s[12:15], s56 offen offset:1024 lds
    s_add_u32 m0, s59, 0xa000
    s_add_u32 s56, s86, 0x800
    buffer_load_dwordx4 v6, s[12:15], s56 offen lds
    buffer_load_dwordx4 v7, s[12:15], s56 offen offset:1024 lds
    s_add_u32 m0, s59, 0xb000
    s_add_u32 s56, s86, 0x18000
    buffer_load_dwordx4 v6, s[12:15], s56 offen lds
    buffer_load_dwordx4 v7, s[12:15], s56 offen offset:1024 lds
    s_add_u32 m0, s59, 0xc000
    s_add_u32 s56, s86, 0x18400
    buffer_load_dwordx4 v6, s[12:15], s56 offen lds
    buffer_load_dwordx4 v7, s[12:15], s56 offen offset:1024 lds
    s_barrier
    s_add_u32 m0, s59, 0xd000
    s_add_u32 s56, s86, 0x18800
    buffer_load_dwordx4 v6, s[12:15], s56 offen lds
    buffer_load_dwordx4 v7, s[12:15], s56 offen offset:1024 lds
    s_add_u32 s86, s91, 9
    s_and_b32 s86, s86, 7
    s_mul_i32 s86, s86, 0x30000
    s_add_u32 m0, s59, 0x11000
    s_add_u32 s56, s86, 0x0
    buffer_load_dwordx4 v6, s[12:15], s56 offen lds
    buffer_load_dwordx4 v7, s[12:15], s56 offen offset:1024 lds
    s_add_u32 m0, s59, 0x12000
    s_add_u32 s56, s86, 0x400
    buffer_load_dwordx4 v6, s[12:15], s56 offen lds
    buffer_load_dwordx4 v7, s[12:15], s56 offen offset:1024 lds
    s_add_u32 m0, s59, 0x13000
    s_add_u32 s56, s86, 0x800
    buffer_load_dwordx4 v6, s[12:15], s56 offen lds
    buffer_load_dwordx4 v7, s[12:15], s56 offen offset:1024 lds
    s_waitcnt vmcnt(18)
    s_barrier
    s_add_u32 m0, s59, 0x14000
    s_add_u32 s56, s86, 0x18000
    buffer_load_dwordx4 v6, s[12:15], s56 offen lds
    buffer_load_dwordx4 v7, s[12:15], s56 offen offset:1024 lds
    s_add_u32 m0, s59, 0x15000
    s_add_u32 s56, s86, 0x18400
    buffer_load_dwordx4 v6, s[12:15], s56 offen lds
    buffer_load_dwordx4 v7, s[12:15], s56 offen offset:1024 lds
    s_add_u32 m0, s59, 0x16000
    s_add_u32 s56, s86, 0x18800
    buffer_load_dwordx4 v6, s[12:15], s56 offen lds
    buffer_load_dwordx4 v7, s[12:15], s56 offen offset:1024 lds
    s_add_u32 s86, s91, 10
    s_and_b32 s86, s86, 7
    s_mul_i32 s86, s86, 0x30000
    s_add_u32 m0, s59, 0x1a000
    s_add_u32 s56, s86, 0x0
    buffer_load_dwordx4 v6, s[12:15], s56 offen lds
    buffer_load_dwordx4 v7, s[12:15], s56 offen offset:1024 lds
    s_waitcnt vmcnt(14)
    s_barrier
    s_add_u32 m0, s59, 0x1b000
    s_add_u32 s56, s86, 0x400
    buffer_load_dwordx4 v6, s[12:15], s56 offen lds
    buffer_load_dwordx4 v7, s[12:15], s56 offen offset:1024 lds
    s_add_u32 m0, s59, 0x1c000
    s_add_u32 s56, s86, 0x800
    buffer_load_dwordx4 v6, s[12:15], s56 offen lds
    buffer_load_dwordx4 v7, s[12:15], s56 offen offset:1024 lds
    s_add_u32 m0, s59, 0x1d000
    s_add_u32 s56, s86, 0x18000
    buffer_load_dwordx4 v6, s[12:15], s56 offen lds
    buffer_load_dwordx4 v7, s[12:15], s56 offen offset:1024 lds
    s_add_u32 m0, s59, 0x1e000
    s_add_u32 s56, s86, 0x18400
    buffer_load_dwordx4 v6, s[12:15], s56 offen lds
    buffer_load_dwordx4 v7, s[12:15], s56 offen offset:1024 lds
    s_add_u32 m0, s59, 0x1f000
    s_add_u32 s56, s86, 0x18800
    buffer_load_dwordx4 v6, s[12:15], s56 offen lds
    buffer_load_dwordx4 v7, s[12:15], s56 offen offset:1024 lds
    s_waitcnt vmcnt(12)
    s_barrier
    s_add_u32 m0, s59, 0x23000
    s_mov_b32 s56, 0x0
    buffer_load_dwordx4 v8, s[16:19], s56 offen lds
    buffer_load_dwordx4 v9, s[16:19], s56 offen offset:1024 lds
    s_add_u32 m0, s59, 0x24000
    s_mov_b32 s56, 0x8000
    buffer_load_dwordx4 v8, s[16:19], s56 offen lds
    buffer_load_dwordx4 v9, s[16:19], s56 offen offset:1024 lds
    s_add_u32 m0, s59, 0x25000
    s_mov_b32 s56, 0x10000
    buffer_load_dwordx4 v8, s[16:19], s56 offen lds
    buffer_load_dwordx4 v9, s[16:19], s56 offen offset:1024 lds
    s_add_u32 m0, s59, 0x26000
    s_mov_b32 s56, 0x18000
    buffer_load_dwordx4 v8, s[16:19], s56 offen lds
    buffer_load_dwordx4 v9, s[16:19], s56 offen offset:1024 lds
    s_add_u32 m0, s59, 0x0
    s_mov_b32 s56, 0x20000
    buffer_load_dwordx4 v8, s[16:19], s56 offen lds
    buffer_load_dwordx4 v9, s[16:19], s56 offen offset:1024 lds
    s_add_u32 m0, s59, 0x1000
    s_mov_b32 s56, 0x28000
    buffer_load_dwordx4 v8, s[16:19], s56 offen lds
    buffer_load_dwordx4 v9, s[16:19], s56 offen offset:1024 lds
    s_waitcnt vmcnt(12)
    s_barrier
    s_add_u32 m0, s59, 0x2000
    s_mov_b32 s56, 0x30000
    buffer_load_dwordx4 v8, s[16:19], s56 offen lds
    buffer_load_dwordx4 v9, s[16:19], s56 offen offset:1024 lds
    s_add_u32 m0, s59, 0x3000
    s_mov_b32 s56, 0x38000
    buffer_load_dwordx4 v8, s[16:19], s56 offen lds
    buffer_load_dwordx4 v9, s[16:19], s56 offen offset:1024 lds
    s_add_u32 m0, s59, 0x4000
    s_mov_b32 s56, 0x40000
    buffer_load_dwordx4 v8, s[16:19], s56 offen lds
    buffer_load_dwordx4 v9, s[16:19], s56 offen offset:1024 lds
    s_add_u32 m0, s59, 0x5000
    s_mov_b32 s56, 0x48000
    buffer_load_dwordx4 v8, s[16:19], s56 offen lds
    buffer_load_dwordx4 v9, s[16:19], s56 offen offset:1024 lds
    s_add_u32 m0, s59, 0x6000
    s_mov_b32 s56, 0x50000
    buffer_load_dwordx4 v8, s[16:19], s56 offen lds
    buffer_load_dwordx4 v9, s[16:19], s56 offen offset:1024 lds
    s_add_u32 m0, s59, 0x7000
    s_mov_b32 s56, 0x58000
    buffer_load_dwordx4 v8, s[16:19], s56 offen lds
    buffer_load_dwordx4 v9, s[16:19], s56 offen offset:1024 lds
    s_barrier
    s_add_u32 m0, s59, 0x8000
    s_mov_b32 s56, 0x60000
    buffer_load_dwordx4 v8, s[16:19], s56 offen lds
    buffer_load_dwordx4 v9, s[16:19], s56 offen offset:1024 lds
    s_add_u32 m0, s59, 0x9000
    s_mov_b32 s56, 0x68000
    buffer_load_dwordx4 v8, s[16:19], s56 offen lds
    buffer_load_dwordx4 v9, s[16:19], s56 offen offset:1024 lds
    s_add_u32 m0, s59, 0xa000
    s_mov_b32 s56, 0x70000
    buffer_load_dwordx4 v8, s[16:19], s56 offen lds
    buffer_load_dwordx4 v9, s[16:19], s56 offen offset:1024 lds
    s_add_u32 m0, s59, 0xb000
    s_mov_b32 s56, 0x78000
    buffer_load_dwordx4 v8, s[16:19], s56 offen lds
    buffer_load_dwordx4 v9, s[16:19], s56 offen offset:1024 lds
    s_add_u32 s86, s45, 0
    s_and_b32 s86, s86, 7
    s_mul_i32 s86, s86, 0x2b000
    s_add_u32 s87, s86, s62
    s_add_u32 m0, s59, 0xc000
    s_add_u32 s56, s86, 0x0
    buffer_load_dwordx4 v10, s[20:23], s56 offen lds
    buffer_load_dwordx4 v11, s[20:23], s56 offen offset:1024 lds
    s_add_u32 m0, s59, 0xd000
    s_add_u32 s56, s87, 0x80
    buffer_load_dwordx4 v10, s[20:23], s56 offen lds
    buffer_load_dwordx4 v11, s[20:23], s56 offen offset:1024 lds
    s_add_u32 m0, s59, 0xe000
    s_add_u32 s56, s87, 0x100
    buffer_load_dwordx4 v10, s[20:23], s56 offen lds
    buffer_load_dwordx4 v11, s[20:23], s56 offen offset:1024 lds
    s_add_u32 m0, s59, 0xf000
    s_add_u32 s56, s86, 0x15800
    buffer_load_dwordx4 v10, s[20:23], s56 offen lds
    buffer_load_dwordx4 v11, s[20:23], s56 offen offset:1024 lds
    s_add_u32 m0, s59, 0x10000
    s_add_u32 s56, s87, 0x15880
    buffer_load_dwordx4 v10, s[20:23], s56 offen lds
    buffer_load_dwordx4 v11, s[20:23], s56 offen offset:1024 lds
    s_add_u32 m0, s59, 0x11000
    s_add_u32 s56, s87, 0x15900
    buffer_load_dwordx4 v10, s[20:23], s56 offen lds
    buffer_load_dwordx4 v11, s[20:23], s56 offen offset:1024 lds
    s_add_u32 s86, s45, 1
    s_and_b32 s86, s86, 7
    s_mul_i32 s86, s86, 0x2b000
    s_add_u32 s87, s86, s62
    s_add_u32 m0, s59, 0x14000
    s_add_u32 s56, s86, 0x0
    buffer_load_dwordx4 v10, s[20:23], s56 offen lds
    buffer_load_dwordx4 v11, s[20:23], s56 offen offset:1024 lds
    s_add_u32 m0, s59, 0x15000
    s_add_u32 s56, s87, 0x80
    buffer_load_dwordx4 v10, s[20:23], s56 offen lds
    buffer_load_dwordx4 v11, s[20:23], s56 offen offset:1024 lds
    s_waitcnt vmcnt(40)
    s_barrier
    ds_write_b128 v13, v[208:211] offset:36864
    ds_write_b128 v13, v[212:215] offset:40960
    ds_write_b128 v13, v[216:219] offset:45056
    ds_write_b128 v13, v[220:223] offset:49152
    ds_write_b128 v14, v[224:227] offset:8192
    ds_write_b128 v14, v[228:231] offset:12288
    ds_write_b128 v14, v[232:235] offset:16384
    ds_write_b128 v14, v[236:239] offset:20480
    ds_write_b128 v14, v[240:243] offset:24576
    s_waitcnt vmcnt(32)
    s_waitcnt lgkmcnt(0)
    s_barrier
    s_waitcnt vmcnt(24)
    s_barrier
    s_waitcnt vmcnt(16)
    s_barrier
    v_bfe_u32 v1, v0, 3, 2
    v_lshrrev_b32 v2, 5, v0
    v_lshl_add_u32 v1, v2, 3, v1
    s_lshl_b32 s52, s51, 4
    s_and_b32 s53, s46, 2
    s_lshl1_add_u32 s52, s53, s52
    v_add_u32 v1, s52, v1
    v_bfe_u32 v5, v0, 4, 1
    v_lshl_add_u32 v2, v5, 1, v2
    v_lshlrev_b32 v2, 1, v2
    v_and_b32 v5, 7, v0
    v_xor_b32 v2, v2, v5
    v_lshlrev_b32 v2, 4, v2
    v_mul_u32_u24 v1, 1024, v1
    s_mul_i32 s52, s45, 128
    v_add3_u32 v5, v1, v2, s52
    s_mov_b32 s52, 0x28000
    buffer_load_dwordx4 v[208:211], v5, s[24:27], s52 offen
    s_mov_b32 s52, 0x50000
    buffer_load_dwordx4 v[212:215], v5, s[24:27], s52 offen
    s_mov_b32 s52, 0xb8000
    buffer_load_dwordx4 v[216:219], v5, s[24:27], s52 offen
    s_mov_b32 s52, 0xe0000
    buffer_load_dwordx4 v[220:223], v5, s[24:27], s52 offen
    s_mov_b32 s52, 0xe8000
    buffer_load_dwordx4 v[224:227], v5, s[24:27], s52 offen
    s_mov_b32 s52, 0x110000
    buffer_load_dwordx4 v[228:231], v5, s[24:27], s52 offen
    s_mov_b32 s52, 0x118000
    buffer_load_dwordx4 v[232:235], v5, s[24:27], s52 offen
    s_mov_b32 s52, 0x140000
    buffer_load_dwordx4 v[236:239], v5, s[24:27], s52 offen
    s_mov_b32 s52, 0x148000
    buffer_load_dwordx4 v[240:243], v5, s[24:27], s52 offen
    s_barrier
    ds_write_b128 v14, v[244:247] offset:28672
    ds_write_b128 v14, v[52:55] offset:40960
    ds_write_b128 v14, v[56:59] offset:45056
    ds_write_b128 v14, v[60:63] offset:49152
    ds_write_b128 v12, v[64:67] offset:0
    ds_write_b128 v12, v[68:71] offset:4096
    s_waitcnt lgkmcnt(0)
    s_barrier
    ds_write_b128 v12, v[72:75] offset:8192
    ds_write_b128 v12, v[76:79] offset:20480
    ds_write_b128 v12, v[80:83] offset:24576
    ds_write_b128 v12, v[84:87] offset:28672
    ds_write_b128 v12, v[88:91] offset:32768
    ds_write_b128 v12, v[92:95] offset:36864
    ds_write_b128 v12, v[96:99] offset:40960
    s_waitcnt lgkmcnt(0)
    s_barrier
    s_waitcnt vmcnt(13)
    s_barrier
    s_waitcnt vmcnt(9)
    s_barrier
    s_add_u32 s86, s45, 5
    s_and_b32 s86, s86, 7
    s_mul_i32 s86, s86, 0x2b000
    s_add_u32 s87, s86, s62
    s_add_u32 m0, s59, 0xd000
    s_add_u32 s56, s86, 0x0
    buffer_load_dwordx4 v10, s[20:23], s56 offen lds
    buffer_load_dwordx4 v11, s[20:23], s56 offen offset:1024 lds
    s_add_u32 m0, s59, 0xe000
    s_add_u32 s56, s87, 0x80
    buffer_load_dwordx4 v10, s[20:23], s56 offen lds
    buffer_load_dwordx4 v11, s[20:23], s56 offen offset:1024 lds
    s_add_u32 m0, s59, 0xf000
    s_add_u32 s56, s87, 0x100
    buffer_load_dwordx4 v10, s[20:23], s56 offen lds
    buffer_load_dwordx4 v11, s[20:23], s56 offen offset:1024 lds
    s_barrier
    s_add_u32 m0, s59, 0x10000
    s_add_u32 s56, s86, 0x15800
    buffer_load_dwordx4 v10, s[20:23], s56 offen lds
    buffer_load_dwordx4 v11, s[20:23], s56 offen offset:1024 lds
    s_add_u32 m0, s59, 0x11000
    s_add_u32 s56, s87, 0x15880
    buffer_load_dwordx4 v10, s[20:23], s56 offen lds
    buffer_load_dwordx4 v11, s[20:23], s56 offen offset:1024 lds
    s_add_u32 m0, s59, 0x12000
    s_add_u32 s56, s87, 0x15900
    buffer_load_dwordx4 v10, s[20:23], s56 offen lds
    buffer_load_dwordx4 v11, s[20:23], s56 offen offset:1024 lds
    s_add_u32 s86, s45, 6
    s_and_b32 s86, s86, 7
    s_mul_i32 s86, s86, 0x2b000
    s_add_u32 s87, s86, s62
    s_add_u32 m0, s59, 0x15000
    s_add_u32 s56, s86, 0x0
    buffer_load_dwordx4 v10, s[20:23], s56 offen lds
    buffer_load_dwordx4 v11, s[20:23], s56 offen offset:1024 lds
    s_barrier
    s_add_u32 m0, s59, 0x16000
    s_add_u32 s56, s87, 0x80
    buffer_load_dwordx4 v10, s[20:23], s56 offen lds
    buffer_load_dwordx4 v11, s[20:23], s56 offen offset:1024 lds
    s_add_u32 m0, s59, 0x17000
    s_add_u32 s56, s87, 0x100
    buffer_load_dwordx4 v10, s[20:23], s56 offen lds
    buffer_load_dwordx4 v11, s[20:23], s56 offen offset:1024 lds
    s_add_u32 m0, s59, 0x18000
    s_add_u32 s56, s86, 0x15800
    buffer_load_dwordx4 v10, s[20:23], s56 offen lds
    buffer_load_dwordx4 v11, s[20:23], s56 offen offset:1024 lds
    s_barrier
    s_add_u32 m0, s59, 0x19000
    s_add_u32 s56, s87, 0x15880
    buffer_load_dwordx4 v10, s[20:23], s56 offen lds
    buffer_load_dwordx4 v11, s[20:23], s56 offen offset:1024 lds
    s_add_u32 m0, s59, 0x1a000
    s_add_u32 s56, s87, 0x15900
    buffer_load_dwordx4 v10, s[20:23], s56 offen lds
    buffer_load_dwordx4 v11, s[20:23], s56 offen offset:1024 lds
    s_add_u32 s86, s45, 7
    s_and_b32 s86, s86, 7
    s_mul_i32 s86, s86, 0x2b000
    s_add_u32 s87, s86, s62
    s_add_u32 m0, s59, 0x1d000
    s_add_u32 s56, s86, 0x0
    buffer_load_dwordx4 v10, s[20:23], s56 offen lds
    buffer_load_dwordx4 v11, s[20:23], s56 offen offset:1024 lds
    s_waitcnt vmcnt(14)
    s_barrier
    s_add_u32 m0, s59, 0x1e000
    s_add_u32 s56, s87, 0x80
    buffer_load_dwordx4 v10, s[20:23], s56 offen lds
    buffer_load_dwordx4 v11, s[20:23], s56 offen offset:1024 lds
    s_add_u32 m0, s59, 0x1f000
    s_add_u32 s56, s87, 0x100
    buffer_load_dwordx4 v10, s[20:23], s56 offen lds
    buffer_load_dwordx4 v11, s[20:23], s56 offen offset:1024 lds
    s_add_u32 m0, s59, 0x20000
    s_add_u32 s56, s86, 0x15800
    buffer_load_dwordx4 v10, s[20:23], s56 offen lds
    buffer_load_dwordx4 v11, s[20:23], s56 offen offset:1024 lds
    s_add_u32 m0, s59, 0x21000
    s_add_u32 s56, s87, 0x15880
    buffer_load_dwordx4 v10, s[20:23], s56 offen lds
    buffer_load_dwordx4 v11, s[20:23], s56 offen offset:1024 lds
    s_add_u32 m0, s59, 0x22000
    s_add_u32 s56, s87, 0x15900
    buffer_load_dwordx4 v10, s[20:23], s56 offen lds
    buffer_load_dwordx4 v11, s[20:23], s56 offen offset:1024 lds
    s_waitcnt vmcnt(12)
    s_barrier
    s_add_u32 m0, s59, 0x25000
    s_mov_b32 s56, 0x0
    buffer_load_dwordx4 v8, s[24:27], s56 offen lds
    buffer_load_dwordx4 v9, s[24:27], s56 offen offset:1024 lds
    s_add_u32 m0, s59, 0x26000
    s_mov_b32 s56, 0x8000
    buffer_load_dwordx4 v8, s[24:27], s56 offen lds
    buffer_load_dwordx4 v9, s[24:27], s56 offen offset:1024 lds
    s_add_u32 m0, s59, 0x0
    s_mov_b32 s56, 0x30000
    buffer_load_dwordx4 v8, s[24:27], s56 offen lds
    buffer_load_dwordx4 v9, s[24:27], s56 offen offset:1024 lds
    s_add_u32 m0, s59, 0x2000
    s_mov_b32 s56, 0x60000
    buffer_load_dwordx4 v8, s[24:27], s56 offen lds
    buffer_load_dwordx4 v9, s[24:27], s56 offen offset:1024 lds
    s_waitcnt vmcnt(8)
    s_barrier
    s_add_u32 m0, s59, 0x3000
    s_mov_b32 s56, 0x68000
    buffer_load_dwordx4 v8, s[24:27], s56 offen lds
    buffer_load_dwordx4 v9, s[24:27], s56 offen offset:1024 lds
    s_add_u32 m0, s59, 0xa000
    s_mov_b32 s56, 0x120000
    buffer_load_dwordx4 v8, s[24:27], s56 offen lds
    buffer_load_dwordx4 v9, s[24:27], s56 offen offset:1024 lds
    s_add_u32 m0, s59, 0xb000
    s_mov_b32 s56, 0x128000
    buffer_load_dwordx4 v8, s[24:27], s56 offen lds
    buffer_load_dwordx4 v9, s[24:27], s56 offen offset:1024 lds
    s_add_u32 m0, s59, 0xc000
    s_mov_b32 s56, 0x150000
    buffer_load_dwordx4 v8, s[24:27], s56 offen lds
    buffer_load_dwordx4 v9, s[24:27], s56 offen offset:1024 lds
    s_barrier
    ds_write_b128 v12, v[184:187] offset:4096
    ds_write_b128 v12, v[248:251] offset:16384
    ds_write_b128 v12, v[100:103] offset:20480
    ds_write_b128 v12, v[104:107] offset:24576
    ds_write_b128 v12, v[108:111] offset:28672
    ds_write_b128 v12, v[112:115] offset:32768
    ds_write_b128 v12, v[116:119] offset:36864
    ds_write_b128 v13, v[120:123] offset:0
    ds_write_b128 v13, v[124:127] offset:4096
    ds_write_b128 v13, v[128:131] offset:8192
    ds_write_b128 v13, v[132:135] offset:12288
    ds_write_b128 v13, v[136:139] offset:16384
    ds_write_b128 v13, v[140:143] offset:20480
    ds_write_b128 v13, v[144:147] offset:36864
    ds_write_b128 v13, v[148:151] offset:40960
    ds_write_b128 v13, v[152:155] offset:45056
    ds_write_b128 v13, v[156:159] offset:49152
    ds_write_b128 v14, v[160:163] offset:0
    ds_write_b128 v14, v[164:167] offset:4096
    ds_write_b128 v14, v[208:211] offset:12288
    ds_write_b128 v14, v[212:215] offset:16384
    ds_write_b128 v14, v[168:171] offset:20480
    ds_write_b128 v14, v[172:175] offset:24576
    ds_write_b128 v14, v[176:179] offset:28672
    ds_write_b128 v14, v[180:183] offset:32768
    ds_write_b128 v14, v[216:219] offset:36864
    s_add_u32 m0, s59, 0x13000
    s_mov_b32 s56, 0x78000
    buffer_load_dwordx4 v8, s[24:27], s56 offen lds
    buffer_load_dwordx4 v9, s[24:27], s56 offen offset:1024 lds
    s_add_u32 m0, s59, 0x14000
    s_mov_b32 s56, 0xa0000
    buffer_load_dwordx4 v8, s[24:27], s56 offen lds
    buffer_load_dwordx4 v9, s[24:27], s56 offen offset:1024 lds
    s_add_u32 m0, s59, 0x15000
    s_mov_b32 s56, 0xa8000
    buffer_load_dwordx4 v8, s[24:27], s56 offen lds
    buffer_load_dwordx4 v9, s[24:27], s56 offen offset:1024 lds
    s_add_u32 m0, s59, 0x1c000
    s_mov_b32 s56, 0x20000
    buffer_load_dwordx4 v8, s[24:27], s56 offen lds
    buffer_load_dwordx4 v9, s[24:27], s56 offen offset:1024 lds
    s_waitcnt vmcnt(18)
    s_waitcnt lgkmcnt(0)
    s_barrier
    s_waitcnt vmcnt(14)
    s_barrier
    ds_write_b128 v14, v[220:223] offset:40960
    ds_write_b128 v14, v[224:227] offset:45056
    s_waitcnt lgkmcnt(0)
    s_barrier
    ds_write_b128 v12, v[228:231] offset:0
    ds_write_b128 v12, v[232:235] offset:4096
    s_waitcnt vmcnt(8)
    s_waitcnt lgkmcnt(0)
    s_barrier
    ds_write_b128 v12, v[236:239] offset:8192
    ds_write_b128 v12, v[240:243] offset:12288
    s_waitcnt lgkmcnt(0)
    s_barrier
    s_waitcnt vmcnt(2)
    s_barrier
    s_barrier
    s_waitcnt vmcnt(0)
    s_barrier
    s_barrier
    s_barrier
    s_barrier
    s_barrier
    s_waitcnt vmcnt(0)
    s_endpgm
L_LA2:
    s_add_u32 m0, s59, 0x1b800
    s_add_u32 s86, s91, 3
    s_and_b32 s86, s86, 7
    s_lshl_b32 s56, s86, 7
    buffer_load_dwordx4 v20, s[4:7], s56 offen offset:0 lds
    buffer_load_dwordx4 v21, s[4:7], s56 offen offset:1024 lds
    buffer_load_dwordx4 v22, s[4:7], s56 offen offset:2048 lds
    buffer_load_dwordx4 v23, s[4:7], s56 offen offset:3072 lds
    s_add_u32 m0, s60, 0x1b000
    s_nop 0
    buffer_load_dwordx4 v8, s[4:7], s56 offen lds
    s_lshl_b32 s52, s45, 4
    v_lshlrev_b32 v4, 2, v0
    v_add_u32 v4, s52, v4
    s_lshl_b32 s52, s45, 7
    s_add_u32 s52, s52, 0x400
    v_writelane_b32 v4, s52, 4
    s_add_u32 s52, s52, 4
    v_writelane_b32 v4, s52, 5
    v_mov_b32 v32, 0
    v_mov_b32 v28, -1
    v_mov_b32 v29, -1
    v_mov_b32 v30, -1
    v_mov_b32 v31, -1
    s_mov_b64 exec, 15
    buffer_store_dword v32, v4, s[8:11], s47 offen sc1
    s_lshl1_add_u32 s53, s45, s51
    s_lshl_b32 s52, s53, 7
    s_add_u32 s52, s52, s47
    s_add_u32 s52, s52, 0x3000
    s_mov_b64 exec, 0xff
    buffer_store_dwordx4 v[28:31], v13, s[8:11], s52 offen sc1
    s_mov_b64 exec, -1
    s_lshl_b32 s52, s53, 10
    s_add_u32 s52, s52, s47
    s_add_u32 s52, s52, 0x4000
    buffer_store_dwordx4 v[28:31], v13, s[8:11], s52 offen sc1
    s_mov_b64 exec, -1
    s_and_b32 s52, s44, 3
    s_cmp_lg_u32 s52, 0
    s_cbranch_scc1 L_stg_84
    s_lshl1_add_u32 s52, s2, s51
    s_mul_i32 s52, s52, 1024
    s_mov_b64 exec, 0xff
    buffer_load_dword v3, v14, s[16:19], s52 offen
    s_lshl1_add_u32 s52, s2, s51
    s_mul_i32 s52, s52, 2816
    s_mov_b64 exec, 0x3fffff
    buffer_load_dword v3, v14, s[20:23], s52 offen
    s_lshl1_add_u32 s52, s2, s51
    s_mul_i32 s52, s52, 2816
    s_mov_b64 exec, 0x3fffff
    buffer_load_dword v3, v14, s[24:27], s52 offen
    s_mov_b64 exec, -1
L_stg_84:
    s_waitcnt vmcnt(13)
    s_barrier
    s_add_u32 m0, s59, 0x24800
    s_add_u32 s86, s91, 4
    s_and_b32 s86, s86, 7
    s_lshl_b32 s56, s86, 7
    buffer_load_dwordx4 v20, s[4:7], s56 offen offset:0 lds
    buffer_load_dwordx4 v21, s[4:7], s56 offen offset:1024 lds
    buffer_load_dwordx4 v22, s[4:7], s56 offen offset:2048 lds
    buffer_load_dwordx4 v23, s[4:7], s56 offen offset:3072 lds
    s_add_u32 m0, s60, 0x24000
    s_nop 0
    buffer_load_dwordx4 v8, s[4:7], s56 offen lds
    s_and_b32 s52, s44, 3
    s_cmp_lg_u32 s52, 1
    s_cbranch_scc1 L_stg_85
    s_lshl1_add_u32 s52, s2, s51
    s_mul_i32 s52, s52, 1024
    s_mov_b64 exec, 0xff
    buffer_load_dword v3, v14, s[16:19], s52 offen
    s_lshl1_add_u32 s52, s2, s51
    s_mul_i32 s52, s52, 2816
    s_mov_b64 exec, 0x3fffff
    buffer_load_dword v3, v14, s[20:23], s52 offen
    s_lshl1_add_u32 s52, s2, s51
    s_mul_i32 s52, s52, 2816
    s_mov_b64 exec, 0x3fffff
    buffer_load_dword v3, v14, s[24:27], s52 offen
    s_mov_b64 exec, -1
L_stg_85:
    s_waitcnt vmcnt(13)
    s_waitcnt vmcnt(5)
    s_barrier
    s_add_u32 m0, s59, 0x6800
    s_add_u32 s86, s91, 5
    s_and_b32 s86, s86, 7
    s_lshl_b32 s56, s86, 7
    buffer_load_dwordx4 v20, s[4:7], s56 offen offset:0 lds
    buffer_load_dwordx4 v21, s[4:7], s56 offen offset:1024 lds
    buffer_load_dwordx4 v22, s[4:7], s56 offen offset:2048 lds
    buffer_load_dwordx4 v23, s[4:7], s56 offen offset:3072 lds
    s_add_u32 m0, s60, 0x6000
    s_nop 0
    buffer_load_dwordx4 v8, s[4:7], s56 offen lds
    s_add_u32 s52, s44, 2
    s_and_b32 s52, s52, 0
    s_lshl4_add_u32 s52, s51, s52
    s_cmp_lg_u32 s52, 0
    s_cbranch_scc1 L_noarr_86
    s_getreg_b32 s52, hwreg(HW_REG_XCC_ID, 0, 3)
    s_lshl_b32 s52, s52, 3
    s_lshl_b64 s[54:55], 1, s52
    v_mov_b32 v34, s54
    v_mov_b32 v35, s55
    s_mov_b64 exec, 1
    global_atomic_add_x2 v24, v[34:35], s[36:37] sc1
    s_mov_b64 exec, -1
L_noarr_86:
    s_and_b32 s52, s44, 3
    s_cmp_lg_u32 s52, 2
    s_cbranch_scc1 L_stg_87
    s_lshl1_add_u32 s52, s2, s51
    s_mul_i32 s52, s52, 1024
    s_mov_b64 exec, 0xff
    buffer_load_dword v3, v14, s[16:19], s52 offen
    s_lshl1_add_u32 s52, s2, s51
    s_mul_i32 s52, s52, 2816
    s_mov_b64 exec, 0x3fffff
    buffer_load_dword v3, v14, s[20:23], s52 offen
    s_lshl1_add_u32 s52, s2, s51
    s_mul_i32 s52, s52, 2816
    s_mov_b64 exec, 0x3fffff
    buffer_load_dword v3, v14, s[24:27], s52 offen
    s_mov_b64 exec, -1
L_stg_87:
    s_barrier
    s_add_u32 m0, s59, 0xf800
    s_add_u32 s86, s91, 6
    s_and_b32 s86, s86, 7
    s_lshl_b32 s56, s86, 7
    buffer_load_dwordx4 v20, s[4:7], s56 offen offset:0 lds
    buffer_load_dwordx4 v21, s[4:7], s56 offen offset:1024 lds
    buffer_load_dwordx4 v22, s[4:7], s56 offen offset:2048 lds
    buffer_load_dwordx4 v23, s[4:7], s56 offen offset:3072 lds
    s_add_u32 m0, s60, 0xf000
    s_nop 0
    buffer_load_dwordx4 v8, s[4:7], s56 offen lds
    s_and_b32 s52, s44, 3
    s_cmp_lg_u32 s52, 3
    s_cbranch_scc1 L_stg_88
    s_lshl1_add_u32 s52, s2, s51
    s_mul_i32 s52, s52, 1024
    s_mov_b64 exec, 0xff
    buffer_load_dword v3, v14, s[16:19], s52 offen
    s_lshl1_add_u32 s52, s2, s51
    s_mul_i32 s52, s52, 2816
    s_mov_b64 exec, 0x3fffff
    buffer_load_dword v3, v14, s[20:23], s52 offen
    s_lshl1_add_u32 s52, s2, s51
    s_mul_i32 s52, s52, 2816
    s_mov_b64 exec, 0x3fffff
    buffer_load_dword v3, v14, s[24:27], s52 offen
    s_mov_b64 exec, -1
L_stg_88:
    ds_read_b128 v[96:99], v46 offset:16384
    ds_read_b128 v[100:103], v46 offset:20480
    ds_read_b128 v[104:107], v46 offset:24576
    ds_read_b128 v[108:111], v46 offset:28672
    ds_read_b128 v[112:115], v46 offset:32768
    ds_read_b128 v[116:119], v46 offset:36864
    s_waitcnt vmcnt(10)
    s_waitcnt lgkmcnt(0)
    s_barrier
    s_add_u32 m0, s59, 0x18800
    s_add_u32 s86, s91, 7
    s_and_b32 s86, s86, 7
    s_lshl_b32 s56, s86, 7
    buffer_load_dwordx4 v20, s[4:7], s56 offen offset:0 lds
    buffer_load_dwordx4 v21, s[4:7], s56 offen offset:1024 lds
    buffer_load_dwordx4 v22, s[4:7], s56 offen offset:2048 lds
    buffer_load_dwordx4 v23, s[4:7], s56 offen offset:3072 lds
    s_add_u32 m0, s60, 0x18000
    s_nop 0
    buffer_load_dwordx4 v8, s[4:7], s56 offen lds
    s_and_b32 s52, s44, 3
    s_cmp_lg_u32 s52, 0
    s_cbranch_scc1 L_stg_89
    s_lshl1_add_u32 s52, s45, s51
    s_mul_i32 s52, s52, 4096
    s_add_u32 s52, s52, s47
    s_add_u32 s52, s52, 0x20000
    s_mov_b32 exec_lo, 0xffffffff
    s_mov_b32 exec_hi, 0x0
    buffer_load_dword v3, v14, s[8:11], s52 offen sc1
    s_lshl1_add_u32 s52, s45, s51
    s_mul_i32 s52, s52, 4096
    s_add_u32 s52, s52, s47
    s_add_u32 s52, s52, 0x10000
    s_mov_b32 exec_lo, 0xffffffff
    s_mov_b32 exec_hi, 0x0
    buffer_load_dword v3, v14, s[8:11], s52 offen sc1
    s_lshl1_add_u32 s52, s45, s51
    s_mul_i32 s52, s52, 512
    s_add_u32 s52, s52, s47
    s_add_u32 s52, s52, 0x1000
    s_mov_b32 exec_lo, 0xf
    s_mov_b32 exec_hi, 0x0
    buffer_load_dword v3, v14, s[8:11], s52 offen sc1
    s_mov_b64 exec, -1
L_stg_89:
    ds_read_b128 v[120:123], v44 offset:0
    ds_read_b128 v[124:127], v44 offset:4096
    ds_read_b128 v[128:131], v44 offset:8192
    ds_read_b128 v[132:135], v44 offset:12288
    ds_read_b128 v[136:139], v44 offset:16384
    ds_read_b128 v[140:143], v44 offset:20480
    s_waitcnt vmcnt(10)
    s_waitcnt lgkmcnt(0)
    s_barrier
    s_lshr_b32 s52, s2, 3
    s_lshl_b32 s52, s52, 1
    s_add_u32 s52, s52, s51
    s_mul_i32 s52, s52, 8192
    v_lshlrev_b32 v7, 10, v0
    s_mov_b64 exec, 0xff
    buffer_load_dword v12, v7, s[16:19], s52 offen offset:384
    s_mov_b64 exec, -1
    s_and_b32 s52, s44, 3
    s_cmp_lg_u32 s52, 1
    s_cbranch_scc1 L_stg_90
    s_lshl1_add_u32 s52, s45, s51
    s_mul_i32 s52, s52, 4096
    s_add_u32 s52, s52, s47
    s_add_u32 s52, s52, 0x20000
    s_mov_b32 exec_lo, 0xffffffff
    s_mov_b32 exec_hi, 0x0
    buffer_load_dword v3, v14, s[8:11], s52 offen sc1
    s_lshl1_add_u32 s52, s45, s51
    s_mul_i32 s52, s52, 4096
    s_add_u32 s52, s52, s47
    s_add_u32 s52, s52, 0x10000
    s_mov_b32 exec_lo, 0xffffffff
    s_mov_b32 exec_hi, 0x0
    buffer_load_dword v3, v14, s[8:11], s52 offen sc1
    s_lshl1_add_u32 s52, s45, s51
    s_mul_i32 s52, s52, 512
    s_add_u32 s52, s52, s47
    s_add_u32 s52, s52, 0x1000
    s_mov_b32 exec_lo, 0xf
    s_mov_b32 exec_hi, 0x0
    buffer_load_dword v3, v14, s[8:11], s52 offen sc1
    s_mov_b64 exec, -1
L_stg_90:
    ds_read_b128 v[144:147], v44 offset:36864
    ds_read_b128 v[148:151], v44 offset:40960
    ds_read_b128 v[152:155], v44 offset:45056
    ds_read_b128 v[156:159], v44 offset:49152
    ds_read_b128 v[160:163], v45 offset:0
    ds_read_b128 v[164:167], v45 offset:4096
    s_waitcnt vmcnt(6)
    s_waitcnt lgkmcnt(0)
    s_barrier
    s_and_b32 s52, s44, 3
    s_cmp_lg_u32 s52, 2
    s_cbranch_scc1 L_stg_91
    s_lshl1_add_u32 s52, s45, s51
    s_mul_i32 s52, s52, 4096
    s_add_u32 s52, s52, s47
    s_add_u32 s52, s52, 0x20000
    s_mov_b32 exec_lo, 0xffffffff
    s_mov_b32 exec_hi, 0x0
    buffer_load_dword v3, v14, s[8:11], s52 offen sc1
    s_lshl1_add_u32 s52, s45, s51
    s_mul_i32 s52, s52, 4096
    s_add_u32 s52, s52, s47
    s_add_u32 s52, s52, 0x10000
    s_mov_b32 exec_lo, 0xffffffff
    s_mov_b32 exec_hi, 0x0
    buffer_load_dword v3, v14, s[8:11], s52 offen sc1
    s_lshl1_add_u32 s52, s45, s51
    s_mul_i32 s52, s52, 512
    s_add_u32 s52, s52, s47
    s_add_u32 s52, s52, 0x1000
    s_mov_b32 exec_lo, 0xf
    s_mov_b32 exec_hi, 0x0
    buffer_load_dword v3, v14, s[8:11], s52 offen sc1
    s_mov_b64 exec, -1
L_stg_91:
    s_getpc_b64 s[54:55]
L_pc_92:
    s_sub_u32 s54, s54, L_pc_92-interleave_layers__sliding_local_dilated__dense_activation_mish__prompt_kernel
    s_subb_u32 s55, s55, 0
    s_lshr_b32 s52, s2, 3
    s_lshl1_add_u32 s52, s52, s51
    s_lshl_b32 s52, s52, 7
    v_lshlrev_b32 v7, 13, v0
    v_add_u32 v7, s52, v7
    v_min_u32 v7, L_end-interleave_layers__sliding_local_dilated__dense_activation_mish__prompt_kernel, v7
    s_mov_b64 exec, 127
    global_load_dword v12, v7, s[54:55]
    s_mov_b64 exec, -1
    ds_read_b128 v[168:171], v45 offset:20480
    ds_read_b128 v[172:175], v45 offset:24576
    ds_read_b128 v[176:179], v45 offset:28672
    ds_read_b128 v[180:183], v45 offset:32768
    ds_read_b128 v[184:187], v45 offset:36864
    ds_read_b128 v[188:191], v45 offset:40960
    s_waitcnt vmcnt(2)
    s_waitcnt lgkmcnt(0)
    s_barrier
    s_and_b32 s52, s44, 3
    s_cmp_lg_u32 s52, 3
    s_cbranch_scc1 L_stg_93
    s_lshl1_add_u32 s52, s45, s51
    s_mul_i32 s52, s52, 4096
    s_add_u32 s52, s52, s47
    s_add_u32 s52, s52, 0x20000
    s_mov_b32 exec_lo, 0xffffffff
    s_mov_b32 exec_hi, 0x0
    buffer_load_dword v3, v14, s[8:11], s52 offen sc1
    s_lshl1_add_u32 s52, s45, s51
    s_mul_i32 s52, s52, 4096
    s_add_u32 s52, s52, s47
    s_add_u32 s52, s52, 0x10000
    s_mov_b32 exec_lo, 0xffffffff
    s_mov_b32 exec_hi, 0x0
    buffer_load_dword v3, v14, s[8:11], s52 offen sc1
    s_lshl1_add_u32 s52, s45, s51
    s_mul_i32 s52, s52, 512
    s_add_u32 s52, s52, s47
    s_add_u32 s52, s52, 0x1000
    s_mov_b32 exec_lo, 0xf
    s_mov_b32 exec_hi, 0x0
    buffer_load_dword v3, v14, s[8:11], s52 offen sc1
    s_mov_b64 exec, -1
L_stg_93:
    ds_read_b128 v[192:195], v46 offset:4096
    ds_read_b128 v[196:199], v46 offset:8192
    ds_read_b128 v[200:203], v46 offset:12288
    s_waitcnt lgkmcnt(0)
    s_waitcnt lgkmcnt(0)
    s_barrier
    s_barrier
    global_load_dwordx2 v[18:19], v24, s[36:37] sc1
    s_branch L_hsc_95
L_hs_94:
    global_load_dwordx2 v[18:19], v24, s[36:37] sc1
L_hsc_95:
    s_waitcnt vmcnt(0)
    v_add_u32 v5, v18, v19
    v_mul_lo_u32 v5, v5, v6
    v_lshrrev_b32 v5, 24, v5
    v_cmp_gt_u32 vcc, 8, v5
    s_cbranch_vccz L_hsd_96
    s_add_u32 s58, s58, 1
    s_cmp_lt_u32 s58, 0x493e0
    s_cbranch_scc1 L_hs_94
L_hsd_96:
    buffer_load_dword v12, v10, s[8:11], 0 offen sc1
    v_or_b32 v5, v18, v19
    v_and_b32 v5, 0x08080808, v5
    v_or_b32 v5, 1, v5
    v_mov_b32 v4, 0x27d00
    s_mov_b64 exec, 1
    ds_write_b32 v4, v5
    s_mov_b64 exec, -1
    v_lshlrev_b32 v8, 4, v0
    v_add_u32 v8, s60, v8
    s_waitcnt lgkmcnt(0)
    s_barrier
    v_bfe_u32 v4, v0, 3, 2
    v_lshrrev_b32 v5, 5, v0
    v_lshl_add_u32 v4, v5, 3, v4
    s_lshl_b32 s52, s51, 4
    s_and_b32 s53, s46, 2
    s_lshl1_add_u32 s52, s53, s52
    v_add_u32 v4, s52, v4
    v_bfe_u32 v7, v0, 4, 1
    v_lshl_add_u32 v5, v7, 1, v5
    v_lshlrev_b32 v5, 1, v5
    v_and_b32 v7, 7, v0
    v_xor_b32 v5, v5, v7
    v_lshlrev_b32 v5, 4, v5
    v_mul_u32_u24 v4, 2752, v4
    s_mul_i32 s52, s45, 384
    v_add3_u32 v7, v4, v5, s52
    s_add_u32 s53, s45, 3
    s_and_b32 s53, s53, 7
    s_mul_i32 s53, s53, 0x2b000
    s_add_u32 s52, s53, 0x0
    buffer_load_dwordx4 v[48:51], v7, s[20:23], s52 offen
    s_add_u32 s53, s45, 3
    s_and_b32 s53, s53, 7
    s_mul_i32 s53, s53, 0x2b000
    s_add_u32 s53, s53, s62
    s_add_u32 s52, s53, 0x80
    buffer_load_dwordx4 v[52:55], v7, s[20:23], s52 offen
    s_add_u32 s53, s45, 3
    s_and_b32 s53, s53, 7
    s_mul_i32 s53, s53, 0x2b000
    s_add_u32 s53, s53, s62
    s_add_u32 s52, s53, 0x100
    buffer_load_dwordx4 v[56:59], v7, s[20:23], s52 offen
    s_add_u32 s53, s45, 3
    s_and_b32 s53, s53, 7
    s_mul_i32 s53, s53, 0x2b000
    s_add_u32 s52, s53, 0x15800
    buffer_load_dwordx4 v[60:63], v7, s[20:23], s52 offen
    s_add_u32 s53, s45, 3
    s_and_b32 s53, s53, 7
    s_mul_i32 s53, s53, 0x2b000
    s_add_u32 s53, s53, s62
    s_add_u32 s52, s53, 0x15880
    buffer_load_dwordx4 v[64:67], v7, s[20:23], s52 offen
    s_add_u32 s53, s45, 3
    s_and_b32 s53, s53, 7
    s_mul_i32 s53, s53, 0x2b000
    s_add_u32 s53, s53, s62
    s_add_u32 s52, s53, 0x15900
    buffer_load_dwordx4 v[68:71], v7, s[20:23], s52 offen
    s_add_u32 s53, s45, 4
    s_and_b32 s53, s53, 7
    s_mul_i32 s53, s53, 0x2b000
    s_add_u32 s52, s53, 0x0
    buffer_load_dwordx4 v[72:75], v7, s[20:23], s52 offen
    s_add_u32 s53, s45, 4
    s_and_b32 s53, s53, 7
    s_mul_i32 s53, s53, 0x2b000
    s_add_u32 s53, s53, s62
    s_add_u32 s52, s53, 0x80
    buffer_load_dwordx4 v[76:79], v7, s[20:23], s52 offen
    s_add_u32 s53, s45, 4
    s_and_b32 s53, s53, 7
    s_mul_i32 s53, s53, 0x2b000
    s_add_u32 s53, s53, s62
    s_add_u32 s52, s53, 0x100
    buffer_load_dwordx4 v[80:83], v7, s[20:23], s52 offen
    s_add_u32 s53, s45, 4
    s_and_b32 s53, s53, 7
    s_mul_i32 s53, s53, 0x2b000
    s_add_u32 s52, s53, 0x15800
    buffer_load_dwordx4 v[84:87], v7, s[20:23], s52 offen
    s_add_u32 s53, s45, 4
    s_and_b32 s53, s53, 7
    s_mul_i32 s53, s53, 0x2b000
    s_add_u32 s53, s53, s62
    s_add_u32 s52, s53, 0x15880
    buffer_load_dwordx4 v[88:91], v7, s[20:23], s52 offen
    s_add_u32 s53, s45, 4
    s_and_b32 s53, s53, 7
    s_mul_i32 s53, s53, 0x2b000
    s_add_u32 s53, s53, s62
    s_add_u32 s52, s53, 0x15900
    buffer_load_dwordx4 v[92:95], v7, s[20:23], s52 offen
    s_barrier
    s_barrier
    s_barrier
    s_lshl1_add_u32 s52, s45, s51
    s_mul_i32 s52, s52, 7168
    s_add_u32 s52, s52, s47
    s_add_u32 s52, s52, 0x30000
    s_mov_b32 exec_lo, 0xffffffff
    s_mov_b32 exec_hi, 0xffffff
    buffer_load_dword v12, v14, s[8:11], s52 offen sc1
    s_mov_b64 exec, -1
    s_barrier
    s_barrier
    s_waitcnt vmcnt(1)
    ds_write_b128 v46, v[48:51] offset:32768
    ds_write_b128 v46, v[52:55] offset:36864
    ds_write_b128 v46, v[56:59] offset:40960
    ds_write_b128 v46, v[60:63] offset:45056
    ds_write_b128 v46, v[64:67] offset:49152
    ds_write_b128 v44, v[68:71] offset:0
    s_waitcnt lgkmcnt(0)
    s_barrier
    ds_write_b128 v44, v[72:75] offset:12288
    ds_write_b128 v44, v[76:79] offset:16384
    ds_write_b128 v44, v[80:83] offset:20480
    ds_write_b128 v44, v[84:87] offset:24576
    ds_write_b128 v44, v[88:91] offset:28672
    ds_write_b128 v44, v[92:95] offset:32768
    s_waitcnt lgkmcnt(0)
    s_barrier
    s_add_u32 m0, s59, 0x10000
    s_add_u32 s86, s45, 0
    s_and_b32 s86, s86, 7
    s_lshl_b32 s56, s86, 13
    s_add_u32 s56, s56, s47
    s_add_u32 s56, s56, 0x10000
    buffer_load_dwordx4 v9, s[8:11], s56 offen offset:0 sc1 lds
    buffer_load_dwordx4 v9, s[8:11], s56 offen offset:1024 sc1 lds
    buffer_load_dwordx4 v9, s[8:11], s56 offen offset:2048 sc1 lds
    buffer_load_dwordx4 v9, s[8:11], s56 offen offset:3072 sc1 lds
    s_mov_b32 exec_hi, 0
    buffer_load_dword v12, v10, s[8:11], 0 offen sc1
L_poll_97:
    buffer_load_dword v18, v10, s[8:11], 0 offen sc1
    s_waitcnt vmcnt(1)
    v_cmp_gt_u32 vcc, 2, v12
    s_cbranch_vccz L_polld_98
    buffer_load_dword v12, v10, s[8:11], 0 offen sc1
    s_waitcnt vmcnt(1)
    v_cmp_gt_u32 vcc, 2, v18
    s_cbranch_vccz L_polld_98
    s_add_u32 s58, s58, 1
    s_cmp_lt_u32 s58, 0x493e0
    s_cbranch_scc1 L_poll_97
L_polld_98:
    s_mov_b32 exec_hi, -1
    s_add_u32 m0, s59, 0x18000
    s_add_u32 s86, s45, 1
    s_and_b32 s86, s86, 7
    s_lshl_b32 s56, s86, 13
    s_add_u32 s56, s56, s47
    s_add_u32 s56, s56, 0x10000
    buffer_load_dwordx4 v9, s[8:11], s56 offen offset:0 sc1 lds
    buffer_load_dwordx4 v9, s[8:11], s56 offen offset:1024 sc1 lds
    buffer_load_dwordx4 v9, s[8:11], s56 offen offset:2048 sc1 lds
    buffer_load_dwordx4 v9, s[8:11], s56 offen offset:3072 sc1 lds
    s_add_u32 m0, s59, 0x20000
    s_add_u32 s86, s45, 2
    s_and_b32 s86, s86, 7
    s_lshl_b32 s56, s86, 13
    s_add_u32 s56, s56, s47
    s_add_u32 s56, s56, 0x10000
    buffer_load_dwordx4 v9, s[8:11], s56 offen offset:0 sc1 lds
    buffer_load_dwordx4 v9, s[8:11], s56 offen offset:1024 sc1 lds
    buffer_load_dwordx4 v9, s[8:11], s56 offen offset:2048 sc1 lds
    buffer_load_dwordx4 v9, s[8:11], s56 offen offset:3072 sc1 lds
    s_barrier
    s_add_u32 m0, s59, 0x1000
    s_add_u32 s86, s45, 3
    s_and_b32 s86, s86, 7
    s_lshl_b32 s56, s86, 13
    s_add_u32 s56, s56, s47
    s_add_u32 s56, s56, 0x10000
    buffer_load_dwordx4 v9, s[8:11], s56 offen offset:0 sc1 lds
    buffer_load_dwordx4 v9, s[8:11], s56 offen offset:1024 sc1 lds
    buffer_load_dwordx4 v9, s[8:11], s56 offen offset:2048 sc1 lds
    buffer_load_dwordx4 v9, s[8:11], s56 offen offset:3072 sc1 lds
    s_add_u32 s54, s47, 0x1000
    buffer_load_dwordx4 v[20:23], v9, s[8:11], s54 offen offset:0 sc1
    buffer_load_dwordx4 v[24:27], v9, s[8:11], s54 offen offset:1024 sc1
    buffer_load_dwordx4 v[28:31], v9, s[8:11], s54 offen offset:2048 sc1
    buffer_load_dwordx4 v[32:35], v9, s[8:11], s54 offen offset:3072 sc1
    s_waitcnt vmcnt(12)
    s_barrier
    s_add_u32 m0, s59, 0x9000
    s_add_u32 s86, s45, 4
    s_and_b32 s86, s86, 7
    s_lshl_b32 s56, s86, 13
    s_add_u32 s56, s56, s47
    s_add_u32 s56, s56, 0x10000
    buffer_load_dwordx4 v9, s[8:11], s56 offen offset:0 sc1 lds
    buffer_load_dwordx4 v9, s[8:11], s56 offen offset:1024 sc1 lds
    buffer_load_dwordx4 v9, s[8:11], s56 offen offset:2048 sc1 lds
    buffer_load_dwordx4 v9, s[8:11], s56 offen offset:3072 sc1 lds
    s_waitcnt vmcnt(4)
    s_mov_b32 s40, 0xf0f0f0f0
    s_mov_b32 s41, 0xf0f0f0f0
    v_add_f32 v20, v20, v24
    v_add_f32 v28, v28, v32
    v_add_f32 v21, v21, v25
    v_add_f32 v29, v29, v33
    v_add_f32 v22, v22, v26
    v_add_f32 v30, v30, v34
    v_add_f32 v23, v23, v27
    v_add_f32 v31, v31, v35
    v_permlane16_swap_b32 v20, v21
    v_permlane16_swap_b32 v28, v29
    v_permlane16_swap_b32 v22, v23
    s_lshr_b32 s52, s2, 3
    s_lshl_b32 s52, s52, 1
    s_add_u32 s52, s52, s51
    s_mul_i32 s52, s52, 22528
    v_lshlrev_b32 v7, 10, v0
    s_mov_b64 exec, 0x3fffff
    buffer_load_dword v12, v7, s[24:27], s52 offen offset:384
    s_mov_b64 exec, -1
    ds_read_b128 v[204:207], v45 offset:28672
    ds_read_b128 v[208:211], v45 offset:32768
    ds_read_b128 v[212:215], v45 offset:36864
    ds_read_b128 v[216:219], v45 offset:40960
    s_waitcnt lgkmcnt(0)
    s_barrier
    s_add_u32 m0, s59, 0x11000
    s_add_u32 s86, s45, 5
    s_and_b32 s86, s86, 7
    s_lshl_b32 s56, s86, 13
    s_add_u32 s56, s56, s47
    s_add_u32 s56, s56, 0x10000
    buffer_load_dwordx4 v9, s[8:11], s56 offen offset:0 sc1 lds
    buffer_load_dwordx4 v9, s[8:11], s56 offen offset:1024 sc1 lds
    buffer_load_dwordx4 v9, s[8:11], s56 offen offset:2048 sc1 lds
    buffer_load_dwordx4 v9, s[8:11], s56 offen offset:3072 sc1 lds
    s_mov_b32 s40, 0xf0f0f0f0
    s_mov_b32 s41, 0xf0f0f0f0
    v_permlane16_swap_b32 v30, v31
    v_add_f32 v20, v20, v21
    v_add_f32 v28, v28, v29
    v_add_f32 v22, v22, v23
    v_add_f32 v30, v30, v31
    s_nop 0
    v_permlane32_swap_b32 v20, v22
    v_permlane32_swap_b32 v28, v30
    v_add_f32 v20, v20, v22
    v_add_f32 v28, v28, v30
    s_nop 0
    v_add_f32_dpp v20, v20, v20 row_ror:8 row_mask:0xf bank_mask:0xf
    s_getpc_b64 s[54:55]
L_pc_99:
    s_sub_u32 s54, s54, L_pc_99-interleave_layers__sliding_local_dilated__dense_activation_mish__prompt_kernel
    s_subb_u32 s55, s55, 0
    s_lshr_b32 s52, s2, 3
    s_lshl1_add_u32 s52, s52, s51
    s_lshl_b32 s52, s52, 7
    v_lshlrev_b32 v7, 13, v0
    v_add_u32 v7, s52, v7
    v_min_u32 v7, L_end-interleave_layers__sliding_local_dilated__dense_activation_mish__prompt_kernel, v7
    s_mov_b64 exec, 127
    global_load_dword v12, v7, s[54:55]
    s_mov_b64 exec, -1
    ds_read_b128 v[220:223], v46 offset:0
    ds_read_b128 v[224:227], v46 offset:4096
    ds_read_b128 v[228:231], v46 offset:8192
    ds_read_b128 v[232:235], v46 offset:12288
    ds_read_b128 v[236:239], v46 offset:16384
    ds_read_b128 v[240:243], v46 offset:20480
    s_waitcnt lgkmcnt(0)
    s_barrier
    s_add_u32 m0, s59, 0x19000
    s_add_u32 s86, s45, 6
    s_and_b32 s86, s86, 7
    s_lshl_b32 s56, s86, 13
    s_add_u32 s56, s56, s47
    s_add_u32 s56, s56, 0x10000
    buffer_load_dwordx4 v9, s[8:11], s56 offen offset:0 sc1 lds
    buffer_load_dwordx4 v9, s[8:11], s56 offen offset:1024 sc1 lds
    buffer_load_dwordx4 v9, s[8:11], s56 offen offset:2048 sc1 lds
    buffer_load_dwordx4 v9, s[8:11], s56 offen offset:3072 sc1 lds
    s_mov_b32 s40, 0xf0f0f0f0
    s_mov_b32 s41, 0xf0f0f0f0
    v_add_f32_dpp v28, v28, v28 row_ror:8 row_mask:0xf bank_mask:0xf
    v_mul_f32 v20, 0x3b000000, v20
    v_mul_f32 v28, 0x3b000000, v28
    s_nop 0
    v_mov_b32_dpp v21, v20 row_ror:4 row_mask:0xf bank_mask:0xf
    v_mov_b32_dpp v29, v28 row_ror:4 row_mask:0xf bank_mask:0xf
    v_cndmask_b32_e64 v24, v20, v21, s[40:41]
    v_cndmask_b32_e64 v32, v28, v29, s[40:41]
    v_cndmask_b32_e64 v25, v21, v20, s[40:41]
    v_cndmask_b32_e64 v33, v29, v28, s[40:41]
    v_fma_f32 v25, -v24, v24, v25
    v_fma_f32 v33, -v32, v32, v33
    s_waitcnt vmcnt(10)
    s_barrier
    s_add_u32 m0, s59, 0x21000
    s_add_u32 s86, s45, 7
    s_and_b32 s86, s86, 7
    s_lshl_b32 s56, s86, 13
    s_add_u32 s56, s56, s47
    s_add_u32 s56, s56, 0x10000
    buffer_load_dwordx4 v9, s[8:11], s56 offen offset:0 sc1 lds
    buffer_load_dwordx4 v9, s[8:11], s56 offen offset:1024 sc1 lds
    buffer_load_dwordx4 v9, s[8:11], s56 offen offset:2048 sc1 lds
    buffer_load_dwordx4 v9, s[8:11], s56 offen offset:3072 sc1 lds
    s_mov_b32 s40, 0xf0f0f0f0
    s_mov_b32 s41, 0xf0f0f0f0
    v_max_f32 v25, 0, v25
    v_max_f32 v33, 0, v33
    v_add_f32 v25, 0x3727c5ac, v25
    v_add_f32 v33, 0x3727c5ac, v33
    v_rsq_f32 v22, v25
    v_rsq_f32 v30, v33
    v_mul_f32 v22, 0x3fb8aa3b, v22
    v_mul_f32 v30, 0x3fb8aa3b, v30
    v_mul_f32 v23, v22, v24
    v_mul_f32 v31, v30, v32
    v_cndmask_b32_e64 v20, v22, v23, s[40:41]
    v_cndmask_b32_e64 v28, v30, v31, s[40:41]
    s_mov_b32 exec_lo, 0x00ff00ff
    s_mov_b32 exec_hi, 0x00ff00ff
    buffer_store_dword v20, v15, s[8:11], s61 offen offset:0 sc1
    buffer_store_dword v28, v15, s[8:11], s61 offen offset:128 sc1
    s_mov_b64 exec, -1
    s_waitcnt vmcnt(11)
    s_barrier
    s_waitcnt vmcnt(6)
    s_barrier
    s_waitcnt vmcnt(0)
    s_lshl_b32 s52, s51, 8
    s_add_u32 m0, s52, 0x27800
    s_bfm_b64 exec, 16, 0
    buffer_load_dwordx4 v13, s[8:11], s61 offen sc1 lds
    s_mov_b64 exec, -1
    s_lshr_b32 s52, s2, 3
    s_lshl_b32 s52, s52, 1
    s_add_u32 s52, s52, s51
    s_mul_i32 s52, s52, 24576
    v_lshlrev_b32 v7, 10, v0
    s_mov_b64 exec, 0xffffff
    buffer_load_dword v12, v7, s[12:15], s52 offen offset:384
    s_mov_b64 exec, -1
    s_barrier
    s_waitcnt vmcnt(1)
    s_waitcnt lgkmcnt(0)
    s_barrier
    s_barrier
    s_barrier
    s_getpc_b64 s[54:55]
L_pc_100:
    s_sub_u32 s54, s54, L_pc_100-interleave_layers__sliding_local_dilated__dense_activation_mish__prompt_kernel
    s_subb_u32 s55, s55, 0
    s_lshr_b32 s52, s2, 3
    s_lshl1_add_u32 s52, s52, s51
    s_lshl_b32 s52, s52, 7
    v_lshlrev_b32 v7, 13, v0
    v_add_u32 v7, s52, v7
    v_min_u32 v7, L_end-interleave_layers__sliding_local_dilated__dense_activation_mish__prompt_kernel, v7
    s_mov_b64 exec, 127
    global_load_dword v12, v7, s[54:55]
    s_mov_b64 exec, -1
    s_barrier
    s_barrier
    s_barrier
    s_barrier
    s_barrier
    s_barrier
    s_barrier
    ds_read_b128 v[244:247], v44 offset:8192
    ds_write_b128 v44, v[96:99] offset:8192
    ds_read_b128 v[96:99], v44 offset:12288
    ds_write_b128 v44, v[100:103] offset:12288
    s_barrier
    ds_read_b128 v[100:103], v44 offset:16384
    ds_write_b128 v44, v[104:107] offset:16384
    ds_read_b128 v[104:107], v44 offset:20480
    ds_write_b128 v44, v[108:111] offset:20480
    s_barrier
    s_barrier
    ds_read_b128 v[108:111], v44 offset:24576
    ds_write_b128 v44, v[112:115] offset:24576
    ds_read_b128 v[112:115], v44 offset:28672
    ds_write_b128 v44, v[116:119] offset:28672
    ds_read_b128 v[116:119], v44 offset:45056
    ds_write_b128 v44, v[120:123] offset:45056
    ds_read_b128 v[120:123], v44 offset:49152
    ds_write_b128 v44, v[124:127] offset:49152
    ds_read_b128 v[124:127], v45 offset:0
    ds_write_b128 v45, v[128:131] offset:0
    ds_read_b128 v[128:131], v45 offset:4096
    ds_write_b128 v45, v[132:135] offset:4096
    ds_read_b128 v[132:135], v45 offset:8192
    ds_write_b128 v45, v[136:139] offset:8192
    ds_read_b128 v[136:139], v45 offset:12288
    ds_write_b128 v45, v[140:143] offset:12288
    s_waitcnt lgkmcnt(0)
    s_barrier
    ds_read_b128 v[140:143], v45 offset:28672
    ds_write_b128 v45, v[144:147] offset:28672
    ds_read_b128 v[144:147], v45 offset:32768
    ds_write_b128 v45, v[148:151] offset:32768
    ds_read_b128 v[148:151], v45 offset:36864
    ds_write_b128 v45, v[152:155] offset:36864
    ds_read_b128 v[152:155], v45 offset:40960
    ds_write_b128 v45, v[156:159] offset:40960
    ds_read_b128 v[156:159], v45 offset:45056
    ds_write_b128 v45, v[160:163] offset:45056
    ds_read_b128 v[160:163], v45 offset:49152
    ds_write_b128 v45, v[164:167] offset:49152
    ds_read_b128 v[164:167], v46 offset:12288
    ds_write_b128 v46, v[168:171] offset:12288
    ds_read_b128 v[168:171], v46 offset:16384
    ds_write_b128 v46, v[172:175] offset:16384
    ds_read_b128 v[172:175], v46 offset:20480
    ds_write_b128 v46, v[176:179] offset:20480
    ds_read_b128 v[176:179], v46 offset:24576
    ds_write_b128 v46, v[180:183] offset:24576
    ds_write_b128 v46, v[184:187] offset:28672
    ds_write_b128 v46, v[188:191] offset:32768
    ds_read_b128 v[180:183], v46 offset:49152
    ds_write_b128 v46, v[192:195] offset:49152
    s_mov_b32 exec_hi, 0
    buffer_load_dword v12, v10, s[8:11], 0 offen sc1
L_poll_101:
    buffer_load_dword v18, v10, s[8:11], 0 offen sc1
    s_waitcnt vmcnt(1)
    v_cmp_gt_u32 vcc, 7, v12
    s_cbranch_vccz L_polld_102
    buffer_load_dword v12, v10, s[8:11], 0 offen sc1
    s_waitcnt vmcnt(1)
    v_cmp_gt_u32 vcc, 7, v18
    s_cbranch_vccz L_polld_102
    s_add_u32 s58, s58, 1
    s_cmp_lt_u32 s58, 0x493e0
    s_cbranch_scc1 L_poll_101
L_polld_102:
    s_mov_b32 exec_hi, -1
    s_add_u32 m0, s59, 0x8800
    s_add_u32 s86, s91, 3
    s_and_b32 s86, s86, 7
    s_lshl_b32 s56, s86, 13
    s_add_u32 s56, s56, s47
    s_add_u32 s56, s56, 0x10000
    buffer_load_dwordx4 v9, s[8:11], s56 offen offset:0 sc1 lds
    buffer_load_dwordx4 v9, s[8:11], s56 offen offset:1024 sc1 lds
    buffer_load_dwordx4 v9, s[8:11], s56 offen offset:2048 sc1 lds
    buffer_load_dwordx4 v9, s[8:11], s56 offen offset:3072 sc1 lds
    s_add_u32 m0, s59, 0x11800
    s_add_u32 s86, s91, 4
    s_and_b32 s86, s86, 7
    s_lshl_b32 s56, s86, 13
    s_add_u32 s56, s56, s47
    s_add_u32 s56, s56, 0x10000
    buffer_load_dwordx4 v9, s[8:11], s56 offen offset:0 sc1 lds
    buffer_load_dwordx4 v9, s[8:11], s56 offen offset:1024 sc1 lds
    buffer_load_dwordx4 v9, s[8:11], s56 offen offset:2048 sc1 lds
    buffer_load_dwordx4 v9, s[8:11], s56 offen offset:3072 sc1 lds
    ds_write_b128 v44, v[196:199] offset:0
    ds_write_b128 v44, v[200:203] offset:4096
    s_waitcnt vmcnt(4)
    s_waitcnt lgkmcnt(0)
    s_barrier
    s_add_u32 m0, s59, 0x1a800
    s_add_u32 s86, s91, 5
    s_and_b32 s86, s86, 7
    s_lshl_b32 s56, s86, 13
    s_add_u32 s56, s56, s47
    s_add_u32 s56, s56, 0x10000
    buffer_load_dwordx4 v9, s[8:11], s56 offen offset:0 sc1 lds
    buffer_load_dwordx4 v9, s[8:11], s56 offen offset:1024 sc1 lds
    buffer_load_dwordx4 v9, s[8:11], s56 offen offset:2048 sc1 lds
    buffer_load_dwordx4 v9, s[8:11], s56 offen offset:3072 sc1 lds
    s_add_u32 m0, s59, 0x23800
    s_add_u32 s86, s91, 6
    s_and_b32 s86, s86, 7
    s_lshl_b32 s56, s86, 13
    s_add_u32 s56, s56, s47
    s_add_u32 s56, s56, 0x10000
    buffer_load_dwordx4 v9, s[8:11], s56 offen offset:0 sc1 lds
    buffer_load_dwordx4 v9, s[8:11], s56 offen offset:1024 sc1 lds
    buffer_load_dwordx4 v9, s[8:11], s56 offen offset:2048 sc1 lds
    buffer_load_dwordx4 v9, s[8:11], s56 offen offset:3072 sc1 lds
    s_add_u32 s54, s47, 0x1000
    buffer_load_dwordx4 v[20:23], v9, s[8:11], s54 offen offset:0 sc1
    buffer_load_dwordx4 v[24:27], v9, s[8:11], s54 offen offset:1024 sc1
    buffer_load_dwordx4 v[28:31], v9, s[8:11], s54 offen offset:2048 sc1
    buffer_load_dwordx4 v[32:35], v9, s[8:11], s54 offen offset:3072 sc1
    s_add_u32 s55, s50, 0x3000
    buffer_load_dwordx4 v[36:39], v13, s[8:11], s55 offen offset:0 sc1
    buffer_load_dwordx4 v[40:43], v13, s[8:11], s55 offen offset:1024 sc1
    s_waitcnt vmcnt(14)
    s_barrier
    s_add_u32 m0, s59, 0x5800
    s_add_u32 s86, s91, 7
    s_and_b32 s86, s86, 7
    s_lshl_b32 s56, s86, 13
    s_add_u32 s56, s56, s47
    s_add_u32 s56, s56, 0x10000
    buffer_load_dwordx4 v9, s[8:11], s56 offen offset:0 sc1 lds
    buffer_load_dwordx4 v9, s[8:11], s56 offen offset:1024 sc1 lds
    buffer_load_dwordx4 v9, s[8:11], s56 offen offset:2048 sc1 lds
    buffer_load_dwordx4 v9, s[8:11], s56 offen offset:3072 sc1 lds
    s_add_u32 m0, s60, 0x5000
    s_add_u32 s86, s91, 7
    s_and_b32 s86, s86, 7
    s_lshl_b32 s57, s86, 11
    s_add_u32 s57, s57, s50
    s_add_u32 s57, s57, 0x4000
    buffer_load_dwordx4 v8, s[8:11], s57 offen sc1 lds
    s_waitcnt vmcnt(5)
    s_mov_b32 s40, 0xf0f0f0f0
    s_mov_b32 s41, 0xf0f0f0f0
    v_add_f32 v20, v20, v24
    v_add_f32 v28, v28, v32
    v_add_f32 v36, v36, v40
    v_add_f32 v21, v21, v25
    v_add_f32 v29, v29, v33
    v_add_f32 v37, v37, v41
    v_add_f32 v22, v22, v26
    v_add_f32 v30, v30, v34
    v_add_f32 v38, v38, v42
    v_add_f32 v23, v23, v27
    v_add_f32 v31, v31, v35
    v_add_f32 v39, v39, v43
    v_permlane16_swap_b32 v20, v21
    v_permlane16_swap_b32 v28, v29
    v_permlane16_swap_b32 v36, v37
    s_lshr_b32 s52, s2, 3
    s_lshl_b32 s52, s52, 1
    s_add_u32 s52, s52, s51
    s_mul_i32 s52, s52, 8192
    v_lshlrev_b32 v7, 10, v0
    s_mov_b64 exec, 0xff
    buffer_load_dword v12, v7, s[16:19], s52 offen offset:384
    s_mov_b64 exec, -1
    s_barrier
    s_add_u32 m0, s59, 0xe800
    s_add_u32 s86, s91, 8
    s_and_b32 s86, s86, 7
    s_lshl_b32 s56, s86, 13
    s_add_u32 s56, s56, s47
    s_add_u32 s56, s56, 0x10000
    buffer_load_dwordx4 v9, s[8:11], s56 offen offset:0 sc1 lds
    buffer_load_dwordx4 v9, s[8:11], s56 offen offset:1024 sc1 lds
    buffer_load_dwordx4 v9, s[8:11], s56 offen offset:2048 sc1 lds
    buffer_load_dwordx4 v9, s[8:11], s56 offen offset:3072 sc1 lds
    s_add_u32 m0, s60, 0xe000
    s_add_u32 s86, s91, 8
    s_and_b32 s86, s86, 7
    s_lshl_b32 s57, s86, 11
    s_add_u32 s57, s57, s50
    s_add_u32 s57, s57, 0x4000
    buffer_load_dwordx4 v8, s[8:11], s57 offen sc1 lds
    s_mov_b32 s40, 0xf0f0f0f0
    s_mov_b32 s41, 0xf0f0f0f0
    v_permlane16_swap_b32 v22, v23
    v_permlane16_swap_b32 v30, v31
    v_permlane16_swap_b32 v38, v39
    v_add_f32 v20, v20, v21
    v_add_f32 v28, v28, v29
    v_add_f32 v36, v36, v37
    v_add_f32 v22, v22, v23
    v_add_f32 v30, v30, v31
    v_add_f32 v38, v38, v39
    v_permlane32_swap_b32 v20, v22
    v_permlane32_swap_b32 v28, v30
    v_permlane32_swap_b32 v36, v38
    v_add_f32 v20, v20, v22
    v_add_f32 v28, v28, v30
    v_add_f32 v36, v36, v38
    v_add_f32_dpp v20, v20, v20 row_ror:8 row_mask:0xf bank_mask:0xf
    s_getpc_b64 s[54:55]
L_pc_103:
    s_sub_u32 s54, s54, L_pc_103-interleave_layers__sliding_local_dilated__dense_activation_mish__prompt_kernel
    s_subb_u32 s55, s55, 0
    s_lshr_b32 s52, s2, 3
    s_lshl1_add_u32 s52, s52, s51
    s_lshl_b32 s52, s52, 7
    v_lshlrev_b32 v7, 13, v0
    v_add_u32 v7, s52, v7
    v_min_u32 v7, L_end-interleave_layers__sliding_local_dilated__dense_activation_mish__prompt_kernel, v7
    s_mov_b64 exec, 127
    global_load_dword v12, v7, s[54:55]
    s_mov_b64 exec, -1
    s_barrier
    s_add_u32 m0, s59, 0x17800
    s_add_u32 s86, s91, 9
    s_and_b32 s86, s86, 7
    s_lshl_b32 s56, s86, 13
    s_add_u32 s56, s56, s47
    s_add_u32 s56, s56, 0x10000
    buffer_load_dwordx4 v9, s[8:11], s56 offen offset:0 sc1 lds
    buffer_load_dwordx4 v9, s[8:11], s56 offen offset:1024 sc1 lds
    buffer_load_dwordx4 v9, s[8:11], s56 offen offset:2048 sc1 lds
    buffer_load_dwordx4 v9, s[8:11], s56 offen offset:3072 sc1 lds
    s_add_u32 m0, s60, 0x17000
    s_add_u32 s86, s91, 9
    s_and_b32 s86, s86, 7
    s_lshl_b32 s57, s86, 11
    s_add_u32 s57, s57, s50
    s_add_u32 s57, s57, 0x4000
    buffer_load_dwordx4 v8, s[8:11], s57 offen sc1 lds
    s_mov_b32 s40, 0xf0f0f0f0
    s_mov_b32 s41, 0xf0f0f0f0
    v_add_f32_dpp v28, v28, v28 row_ror:8 row_mask:0xf bank_mask:0xf
    v_add_f32_dpp v36, v36, v36 row_ror:8 row_mask:0xf bank_mask:0xf
    v_mul_f32 v20, 0x3b000000, v20
    v_mul_f32 v28, 0x3b000000, v28
    v_mul_f32 v36, 0x3b000000, v36
    v_mov_b32_dpp v21, v20 row_ror:4 row_mask:0xf bank_mask:0xf
    v_mov_b32_dpp v29, v28 row_ror:4 row_mask:0xf bank_mask:0xf
    v_mov_b32_dpp v37, v36 row_ror:4 row_mask:0xf bank_mask:0xf
    v_cndmask_b32_e64 v24, v20, v21, s[40:41]
    v_cndmask_b32_e64 v32, v28, v29, s[40:41]
    v_cndmask_b32_e64 v40, v36, v37, s[40:41]
    v_cndmask_b32_e64 v25, v21, v20, s[40:41]
    v_cndmask_b32_e64 v33, v29, v28, s[40:41]
    v_cndmask_b32_e64 v41, v37, v36, s[40:41]
    v_fma_f32 v25, -v24, v24, v25
    v_fma_f32 v33, -v32, v32, v33
    s_waitcnt vmcnt(12)
    s_barrier
    s_add_u32 m0, s59, 0x20800
    s_add_u32 s86, s91, 10
    s_and_b32 s86, s86, 7
    s_lshl_b32 s56, s86, 13
    s_add_u32 s56, s56, s47
    s_add_u32 s56, s56, 0x10000
    buffer_load_dwordx4 v9, s[8:11], s56 offen offset:0 sc1 lds
    buffer_load_dwordx4 v9, s[8:11], s56 offen offset:1024 sc1 lds
    buffer_load_dwordx4 v9, s[8:11], s56 offen offset:2048 sc1 lds
    buffer_load_dwordx4 v9, s[8:11], s56 offen offset:3072 sc1 lds
    s_add_u32 m0, s60, 0x20000
    s_add_u32 s86, s91, 10
    s_and_b32 s86, s86, 7
    s_lshl_b32 s57, s86, 11
    s_add_u32 s57, s57, s50
    s_add_u32 s57, s57, 0x4000
    buffer_load_dwordx4 v8, s[8:11], s57 offen sc1 lds
    s_mov_b32 s40, 0xf0f0f0f0
    s_mov_b32 s41, 0xf0f0f0f0
    v_fma_f32 v41, -v40, v40, v41
    v_max_f32 v25, 0, v25
    v_max_f32 v33, 0, v33
    v_max_f32 v41, 0, v41
    v_add_f32 v25, 0x3727c5ac, v25
    v_add_f32 v33, 0x3727c5ac, v33
    v_add_f32 v41, 0x3727c5ac, v41
    v_rsq_f32 v22, v25
    v_rsq_f32 v30, v33
    v_rsq_f32 v38, v41
    v_mul_f32 v23, v22, v24
    v_mul_f32 v31, v30, v32
    v_mul_f32 v39, v38, v40
    v_cndmask_b32_e64 v20, v22, v23, s[40:41]
    v_cndmask_b32_e64 v28, v30, v31, s[40:41]
    v_cndmask_b32_e64 v36, v38, v39, s[40:41]
    s_mov_b32 exec_lo, 0x00ff00ff
    s_mov_b32 exec_hi, 0x00ff00ff
    buffer_store_dword v20, v15, s[8:11], s61 offen offset:0 sc1
    buffer_store_dword v28, v15, s[8:11], s61 offen offset:128 sc1
    buffer_store_dword v36, v15, s[8:11], s61 offen offset:256 sc1
    s_mov_b64 exec, -1
    s_waitcnt vmcnt(14)
    s_barrier
    s_waitcnt vmcnt(8)
    s_barrier
    s_waitcnt vmcnt(0)
    s_lshl_b32 s52, s51, 8
    s_add_u32 m0, s52, 0x27880
    s_bfm_b64 exec, 16, 0
    buffer_load_dwordx4 v13, s[8:11], s61 offen sc1 lds
    s_mov_b32 m0, 0x27700
    s_mov_b64 exec, 0xff
    buffer_load_dwordx4 v13, s[8:11], s61 offen offset:256 sc1 lds
    s_mov_b64 exec, -1
    s_barrier
    s_waitcnt vmcnt(0)
    s_waitcnt lgkmcnt(0)
    s_barrier
    s_barrier
    ds_write_b128 v45, v[204:207] offset:36864
    ds_write_b128 v45, v[208:211] offset:40960
    ds_write_b128 v45, v[212:215] offset:45056
    ds_write_b128 v45, v[216:219] offset:49152
    ds_write_b128 v46, v[220:223] offset:8192
    ds_write_b128 v46, v[224:227] offset:12288
    ds_write_b128 v46, v[228:231] offset:16384
    ds_write_b128 v46, v[232:235] offset:20480
    ds_write_b128 v46, v[236:239] offset:24576
    s_waitcnt lgkmcnt(0)
    s_barrier
    s_barrier
    s_barrier
    v_bfe_u32 v4, v0, 3, 2
    v_lshrrev_b32 v5, 5, v0
    v_lshl_add_u32 v4, v5, 3, v4
    s_lshl_b32 s52, s51, 4
    s_and_b32 s53, s46, 2
    s_lshl1_add_u32 s52, s53, s52
    v_add_u32 v4, s52, v4
    v_bfe_u32 v7, v0, 4, 1
    v_lshl_add_u32 v5, v7, 1, v5
    v_lshlrev_b32 v5, 1, v5
    v_and_b32 v7, 7, v0
    v_xor_b32 v5, v5, v7
    v_lshlrev_b32 v5, 4, v5
    v_mul_u32_u24 v4, 1024, v4
    s_mul_i32 s52, s45, 128
    v_add3_u32 v7, v4, v5, s52
    s_mov_b32 s52, 0x28000
    buffer_load_dwordx4 v[204:207], v7, s[24:27], s52 offen
    s_mov_b32 s52, 0x50000
    buffer_load_dwordx4 v[208:211], v7, s[24:27], s52 offen
    s_mov_b32 s52, 0xb8000
    buffer_load_dwordx4 v[212:215], v7, s[24:27], s52 offen
    s_mov_b32 s52, 0xe0000
    buffer_load_dwordx4 v[216:219], v7, s[24:27], s52 offen
    s_mov_b32 s52, 0xe8000
    buffer_load_dwordx4 v[220:223], v7, s[24:27], s52 offen
    s_mov_b32 s52, 0x110000
    buffer_load_dwordx4 v[224:227], v7, s[24:27], s52 offen
    s_mov_b32 s52, 0x118000
    buffer_load_dwordx4 v[228:231], v7, s[24:27], s52 offen
    s_mov_b32 s52, 0x140000
    buffer_load_dwordx4 v[232:235], v7, s[24:27], s52 offen
    s_mov_b32 s52, 0x148000
    buffer_load_dwordx4 v[236:239], v7, s[24:27], s52 offen
    s_barrier
    ds_write_b128 v46, v[240:243] offset:28672
    ds_write_b128 v46, v[48:51] offset:40960
    ds_write_b128 v46, v[52:55] offset:45056
    ds_write_b128 v46, v[56:59] offset:49152
    ds_write_b128 v44, v[60:63] offset:0
    ds_write_b128 v44, v[64:67] offset:4096
    s_waitcnt lgkmcnt(0)
    s_barrier
    ds_write_b128 v44, v[68:71] offset:8192
    ds_write_b128 v44, v[72:75] offset:20480
    ds_write_b128 v44, v[76:79] offset:24576
    ds_write_b128 v44, v[80:83] offset:28672
    ds_write_b128 v44, v[84:87] offset:32768
    ds_write_b128 v44, v[88:91] offset:36864
    ds_write_b128 v44, v[92:95] offset:40960
    s_waitcnt lgkmcnt(0)
    s_barrier
    s_add_u32 m0, s59, 0x12000
    s_add_u32 s86, s45, 0
    s_and_b32 s86, s86, 7
    s_lshl_b32 s56, s86, 13
    s_add_u32 s56, s56, s47
    s_add_u32 s56, s56, 0x10000
    buffer_load_dwordx4 v9, s[8:11], s56 offen offset:0 sc1 lds
    buffer_load_dwordx4 v9, s[8:11], s56 offen offset:1024 sc1 lds
    buffer_load_dwordx4 v9, s[8:11], s56 offen offset:2048 sc1 lds
    buffer_load_dwordx4 v9, s[8:11], s56 offen offset:3072 sc1 lds
    s_mov_b32 exec_hi, 0
    buffer_load_dword v12, v10, s[8:11], 0 offen sc1
L_poll_104:
    buffer_load_dword v18, v10, s[8:11], 0 offen sc1
    s_waitcnt vmcnt(1)
    v_cmp_gt_u32 vcc, 10, v12
    s_cbranch_vccz L_polld_105
    buffer_load_dword v12, v10, s[8:11], 0 offen sc1
    s_waitcnt vmcnt(1)
    v_cmp_gt_u32 vcc, 10, v18
    s_cbranch_vccz L_polld_105
    s_add_u32 s58, s58, 1
    s_cmp_lt_u32 s58, 0x493e0
    s_cbranch_scc1 L_poll_104
L_polld_105:
    s_mov_b32 exec_hi, -1
    s_add_u32 m0, s59, 0x1a000
    s_add_u32 s86, s45, 1
    s_and_b32 s86, s86, 7
    s_lshl_b32 s56, s86, 13
    s_add_u32 s56, s56, s47
    s_add_u32 s56, s56, 0x10000
    buffer_load_dwordx4 v9, s[8:11], s56 offen offset:0 sc1 lds
    buffer_load_dwordx4 v9, s[8:11], s56 offen offset:1024 sc1 lds
    buffer_load_dwordx4 v9, s[8:11], s56 offen offset:2048 sc1 lds
    buffer_load_dwordx4 v9, s[8:11], s56 offen offset:3072 sc1 lds
    s_add_u32 m0, s59, 0x22000
    s_add_u32 s86, s45, 2
    s_and_b32 s86, s86, 7
    s_lshl_b32 s56, s86, 13
    s_add_u32 s56, s56, s47
    s_add_u32 s56, s56, 0x10000
    buffer_load_dwordx4 v9, s[8:11], s56 offen offset:0 sc1 lds
    buffer_load_dwordx4 v9, s[8:11], s56 offen offset:1024 sc1 lds
    buffer_load_dwordx4 v9, s[8:11], s56 offen offset:2048 sc1 lds
    buffer_load_dwordx4 v9, s[8:11], s56 offen offset:3072 sc1 lds
    s_barrier
    s_add_u32 m0, s59, 0x3000
    s_add_u32 s86, s45, 3
    s_and_b32 s86, s86, 7
    s_lshl_b32 s56, s86, 13
    s_add_u32 s56, s56, s47
    s_add_u32 s56, s56, 0x10000
    buffer_load_dwordx4 v9, s[8:11], s56 offen offset:0 sc1 lds
    buffer_load_dwordx4 v9, s[8:11], s56 offen offset:1024 sc1 lds
    buffer_load_dwordx4 v9, s[8:11], s56 offen offset:2048 sc1 lds
    buffer_load_dwordx4 v9, s[8:11], s56 offen offset:3072 sc1 lds
    s_add_u32 s54, s47, 0x1000
    buffer_load_dwordx4 v[20:23], v9, s[8:11], s54 offen offset:0 sc1
    buffer_load_dwordx4 v[24:27], v9, s[8:11], s54 offen offset:1024 sc1
    buffer_load_dwordx4 v[28:31], v9, s[8:11], s54 offen offset:2048 sc1
    buffer_load_dwordx4 v[32:35], v9, s[8:11], s54 offen offset:3072 sc1
    s_waitcnt vmcnt(12)
    s_barrier
    s_add_u32 m0, s59, 0xb000
    s_add_u32 s86, s45, 4
    s_and_b32 s86, s86, 7
    s_lshl_b32 s56, s86, 13
    s_add_u32 s56, s56, s47
    s_add_u32 s56, s56, 0x10000
    buffer_load_dwordx4 v9, s[8:11], s56 offen offset:0 sc1 lds
    buffer_load_dwordx4 v9, s[8:11], s56 offen offset:1024 sc1 lds
    buffer_load_dwordx4 v9, s[8:11], s56 offen offset:2048 sc1 lds
    buffer_load_dwordx4 v9, s[8:11], s56 offen offset:3072 sc1 lds
    s_waitcnt vmcnt(4)
    s_mov_b32 s40, 0xf0f0f0f0
    s_mov_b32 s41, 0xf0f0f0f0
    v_add_f32 v20, v20, v24
    v_add_f32 v28, v28, v32
    v_add_f32 v21, v21, v25
    v_add_f32 v29, v29, v33
    v_add_f32 v22, v22, v26
    v_add_f32 v30, v30, v34
    v_add_f32 v23, v23, v27
    v_add_f32 v31, v31, v35
    v_permlane16_swap_b32 v20, v21
    v_permlane16_swap_b32 v28, v29
    v_permlane16_swap_b32 v22, v23
    s_getpc_b64 s[54:55]
L_pc_106:
    s_sub_u32 s54, s54, L_pc_106-interleave_layers__sliding_local_dilated__dense_activation_mish__prompt_kernel
    s_subb_u32 s55, s55, 0
    s_lshr_b32 s52, s2, 3
    s_lshl1_add_u32 s52, s52, s51
    s_lshl_b32 s52, s52, 7
    v_lshlrev_b32 v7, 13, v0
    v_add_u32 v7, s52, v7
    v_min_u32 v7, L_end-interleave_layers__sliding_local_dilated__dense_activation_mish__prompt_kernel, v7
    s_mov_b64 exec, 127
    global_load_dword v12, v7, s[54:55]
    s_mov_b64 exec, -1
    s_barrier
    s_add_u32 m0, s59, 0x13000
    s_add_u32 s86, s45, 5
    s_and_b32 s86, s86, 7
    s_lshl_b32 s56, s86, 13
    s_add_u32 s56, s56, s47
    s_add_u32 s56, s56, 0x10000
    buffer_load_dwordx4 v9, s[8:11], s56 offen offset:0 sc1 lds
    buffer_load_dwordx4 v9, s[8:11], s56 offen offset:1024 sc1 lds
    buffer_load_dwordx4 v9, s[8:11], s56 offen offset:2048 sc1 lds
    buffer_load_dwordx4 v9, s[8:11], s56 offen offset:3072 sc1 lds
    s_mov_b32 s40, 0xf0f0f0f0
    s_mov_b32 s41, 0xf0f0f0f0
    v_permlane16_swap_b32 v30, v31
    v_add_f32 v20, v20, v21
    v_add_f32 v28, v28, v29
    v_add_f32 v22, v22, v23
    v_add_f32 v30, v30, v31
    s_nop 0
    v_permlane32_swap_b32 v20, v22
    v_permlane32_swap_b32 v28, v30
    v_add_f32 v20, v20, v22
    v_add_f32 v28, v28, v30
    s_nop 0
    v_add_f32_dpp v20, v20, v20 row_ror:8 row_mask:0xf bank_mask:0xf
    s_barrier
    s_add_u32 m0, s59, 0x1b000
    s_add_u32 s86, s45, 6
    s_and_b32 s86, s86, 7
    s_lshl_b32 s56, s86, 13
    s_add_u32 s56, s56, s47
    s_add_u32 s56, s56, 0x10000
    buffer_load_dwordx4 v9, s[8:11], s56 offen offset:0 sc1 lds
    buffer_load_dwordx4 v9, s[8:11], s56 offen offset:1024 sc1 lds
    buffer_load_dwordx4 v9, s[8:11], s56 offen offset:2048 sc1 lds
    buffer_load_dwordx4 v9, s[8:11], s56 offen offset:3072 sc1 lds
    s_mov_b32 s40, 0xf0f0f0f0
    s_mov_b32 s41, 0xf0f0f0f0
    v_add_f32_dpp v28, v28, v28 row_ror:8 row_mask:0xf bank_mask:0xf
    v_mul_f32 v20, 0x3b000000, v20
    v_mul_f32 v28, 0x3b000000, v28
    s_nop 0
    v_mov_b32_dpp v21, v20 row_ror:4 row_mask:0xf bank_mask:0xf
    v_mov_b32_dpp v29, v28 row_ror:4 row_mask:0xf bank_mask:0xf
    v_cndmask_b32_e64 v24, v20, v21, s[40:41]
    v_cndmask_b32_e64 v32, v28, v29, s[40:41]
    v_cndmask_b32_e64 v25, v21, v20, s[40:41]
    v_cndmask_b32_e64 v33, v29, v28, s[40:41]
    v_fma_f32 v25, -v24, v24, v25
    v_fma_f32 v33, -v32, v32, v33
    s_waitcnt vmcnt(9)
    s_barrier
    s_add_u32 m0, s59, 0x23000
    s_add_u32 s86, s45, 7
    s_and_b32 s86, s86, 7
    s_lshl_b32 s56, s86, 13
    s_add_u32 s56, s56, s47
    s_add_u32 s56, s56, 0x10000
    buffer_load_dwordx4 v9, s[8:11], s56 offen offset:0 sc1 lds
    buffer_load_dwordx4 v9, s[8:11], s56 offen offset:1024 sc1 lds
    buffer_load_dwordx4 v9, s[8:11], s56 offen offset:2048 sc1 lds
    buffer_load_dwordx4 v9, s[8:11], s56 offen offset:3072 sc1 lds
    s_mov_b32 s40, 0xf0f0f0f0
    s_mov_b32 s41, 0xf0f0f0f0
    v_max_f32 v25, 0, v25
    v_max_f32 v33, 0, v33
    v_add_f32 v25, 0x3727c5ac, v25
    v_add_f32 v33, 0x3727c5ac, v33
    v_rsq_f32 v22, v25
    v_rsq_f32 v30, v33
    v_mul_f32 v22, 0x3fb8aa3b, v22
    v_mul_f32 v30, 0x3fb8aa3b, v30
    v_mul_f32 v23, v22, v24
    v_mul_f32 v31, v30, v32
    v_cndmask_b32_e64 v20, v22, v23, s[40:41]
    v_cndmask_b32_e64 v28, v30, v31, s[40:41]
    s_mov_b32 exec_lo, 0x00ff00ff
    s_mov_b32 exec_hi, 0x00ff00ff
    buffer_store_dword v20, v15, s[8:11], s61 offen offset:0 sc1
    buffer_store_dword v28, v15, s[8:11], s61 offen offset:128 sc1
    s_mov_b64 exec, -1
    s_waitcnt vmcnt(10)
    s_barrier
    s_waitcnt vmcnt(6)
    s_barrier
    s_waitcnt vmcnt(0)
    s_lshl_b32 s52, s51, 8
    s_add_u32 m0, s52, 0x27800
    s_bfm_b64 exec, 16, 0
    buffer_load_dwordx4 v13, s[8:11], s61 offen sc1 lds
    s_mov_b64 exec, -1
    s_barrier
    s_waitcnt vmcnt(0)
    s_waitcnt lgkmcnt(0)
    s_barrier
    ds_write_b128 v44, v[180:183] offset:4096
    ds_write_b128 v44, v[244:247] offset:16384
    ds_write_b128 v44, v[96:99] offset:20480
    ds_write_b128 v44, v[100:103] offset:24576
    ds_write_b128 v44, v[104:107] offset:28672
    ds_write_b128 v44, v[108:111] offset:32768
    ds_write_b128 v44, v[112:115] offset:36864
    ds_write_b128 v45, v[116:119] offset:0
    ds_write_b128 v45, v[120:123] offset:4096
    ds_write_b128 v45, v[124:127] offset:8192
    ds_write_b128 v45, v[128:131] offset:12288
    ds_write_b128 v45, v[132:135] offset:16384
    ds_write_b128 v45, v[136:139] offset:20480
    ds_write_b128 v45, v[140:143] offset:36864
    ds_write_b128 v45, v[144:147] offset:40960
    ds_write_b128 v45, v[148:151] offset:45056
    ds_write_b128 v45, v[152:155] offset:49152
    ds_write_b128 v46, v[156:159] offset:0
    ds_write_b128 v46, v[160:163] offset:4096
    ds_write_b128 v46, v[204:207] offset:12288
    ds_write_b128 v46, v[208:211] offset:16384
    ds_write_b128 v46, v[164:167] offset:20480
    ds_write_b128 v46, v[168:171] offset:24576
    ds_write_b128 v46, v[172:175] offset:28672
    ds_write_b128 v46, v[176:179] offset:32768
    ds_write_b128 v46, v[212:215] offset:36864
    s_waitcnt lgkmcnt(0)
    s_barrier
    s_barrier
    ds_write_b128 v46, v[216:219] offset:40960
    ds_write_b128 v46, v[220:223] offset:45056
    s_waitcnt lgkmcnt(0)
    s_barrier
    ds_write_b128 v44, v[224:227] offset:0
    ds_write_b128 v44, v[228:231] offset:4096
    s_waitcnt lgkmcnt(0)
    s_barrier
    ds_write_b128 v44, v[232:235] offset:8192
    ds_write_b128 v44, v[236:239] offset:12288
    s_waitcnt lgkmcnt(0)
    s_barrier
    s_barrier
    s_barrier
    s_barrier
    s_barrier
    s_barrier
    s_barrier
    s_barrier
    s_waitcnt vmcnt(0)
    s_endpgm
L_end:
    s_endpgm
.section .rodata,"a"
.p2align 6
.amdhsa_kernel interleave_layers__sliding_local_dilated__dense_activation_mish__prompt_kernel
  .amdhsa_next_free_vgpr 252
  .amdhsa_next_free_sgpr 100
  .amdhsa_accum_offset 252
  .amdhsa_group_segment_fixed_size 0
  .amdhsa_kernarg_size 80
  .amdhsa_user_sgpr_count 2
  .amdhsa_user_sgpr_kernarg_segment_ptr 1
  .amdhsa_system_sgpr_workgroup_id_x 1
.end_amdhsa_kernel
```
